```python
import torch

def _softmax(x, axis=-1):
    return torch.softmax(x, dim=axis)
def _gelu(x):
    return torch.nn.functional.gelu(x, approximate="tanh")
def _silu(x):
    return torch.nn.functional.silu(x)
def _sigmoid(x):
    return torch.sigmoid(x)
def _layernorm(x, axis=-1, eps=1e-5):
    m = x.mean(dim=axis, keepdim=True)
    v = x.var(dim=axis, keepdim=True, unbiased=False)
    return (x - m) / torch.sqrt(v + eps)
def _scatter_add(tgt, idx, src, axis=0):
    return tgt.clone().index_add_(axis, idx, src)
def _segment_sum(src, seg, n):
    out = torch.zeros((n,) + src.shape[1:], dtype=src.dtype)
    return out.index_add_(0, seg, src)
def _pad(x, pw):
    flat = tuple(v for pair in reversed(pw) for v in pair)
    return torch.nn.functional.pad(x, flat)

kernel_name = 'gated_mix__ssm_conv_s5__softmax_full_mha__prompt'

def setup_inputs():

    _w = (lambda a: (lambda t: t.to(torch.bfloat16) if t.is_floating_point() else t)(torch.as_tensor(a)))
    def _A_setup():
        B, S, D = 1, 2048, 576
        P = D
        Lambda_re = -0.5 * (lambda _x: torch.exp(torch.as_tensor(_x)))((lambda *s: torch.randn(*s, dtype=torch.bfloat16) * 0.4)(P))
        Lambda_im = (lambda *s: torch.randn(*s, dtype=torch.bfloat16) * 0.8)(P) * 1.0
        B_re = (lambda *s: torch.randn(*s, dtype=torch.bfloat16) * 0.8)(P, D) * (D ** -0.5)
        B_im = (lambda *s: torch.randn(*s, dtype=torch.bfloat16) * 0.8)(P, D) * (D ** -0.5)
        C_re = (lambda *s: torch.randn(*s, dtype=torch.bfloat16) * 0.8)(D, P) * (P ** -0.5)
        C_im = (lambda *s: torch.randn(*s, dtype=torch.bfloat16) * 0.8)(D, P) * (P ** -0.5)
        log_dt = (lambda *s: torch.randn(*s, dtype=torch.bfloat16) * 0.4)(P) * 0.3 - 2.0
        Dskip = (lambda *s: torch.randn(*s, dtype=torch.bfloat16) * 0.1)(D)
        return {
            "x": _w((lambda *s: torch.randn(*s, dtype=torch.bfloat16) * 0.05)(B, S, D)),
            "Lambda_re": _w(Lambda_re),
            "Lambda_im": _w(Lambda_im),
            "B_re": _w(B_re),
            "B_im": _w(B_im),
            "C_re": _w(C_re),
            "C_im": _w(C_im),
            "log_dt": _w(log_dt),
            "Dskip": _w(Dskip),
        }
    _A_in = _A_setup()

    def _B_setup():
        B, S, D = 1, 2048, 576
        return {
            "x": _w((lambda *s: torch.randn(*s, dtype=torch.bfloat16) * 0.05)(B, S, D)),
            "wqkv": _w((lambda *s: torch.randn(*s, dtype=torch.bfloat16) * 0.8)(D, 3 * D)),
            "wo": _w((lambda *s: torch.randn(*s, dtype=torch.bfloat16) * 0.05)(D, D)),
        }
    _B_in = _B_setup()

    return {
        "A_x": _A_in["x"],
        "A_Lambda_re": _A_in["Lambda_re"],
        "A_Lambda_im": _A_in["Lambda_im"],
        "A_B_re": _A_in["B_re"],
        "A_B_im": _A_in["B_im"],
        "A_C_re": _A_in["C_re"],
        "A_C_im": _A_in["C_im"],
        "A_log_dt": _A_in["log_dt"],
        "A_Dskip": _A_in["Dskip"],
        "B_x": _B_in["x"],
        "B_wqkv": _B_in["wqkv"],
        "B_wo": _B_in["wo"],
        "gate_w": _w((lambda *s: torch.randn(*s, dtype=torch.bfloat16) * 0.05)(576) * 16.0),
    }

def reference(A_x, A_Lambda_re, A_Lambda_im, A_B_re, A_B_im, A_C_re, A_C_im, A_log_dt, A_Dskip, B_x, B_wqkv, B_wo, gate_w):
    def _A_ref(x, Lambda_re, Lambda_im, B_re, B_im, C_re, C_im, log_dt, Dskip):
        Bsz, L, H = x.shape
        Lam = Lambda_re + 1j * Lambda_im
        Bmat = B_re + 1j * B_im
        Cmat = C_re + 1j * C_im
        dt = torch.exp(log_dt)
        Lam_bar = torch.exp(dt * Lam)
        B_bar = ((Lam_bar - 1.0) / Lam)[:, None] * Bmat
        Bu = torch.einsum("bld,pd->blp", x + 0j, B_bar)
        h = torch.zeros_like(Bu[:, 0, :])
        hs = []
        for t in range(L):
            h = Lam_bar[None, :] * h + Bu[:, t, :]
            hs.append(h)
        hseq = torch.stack(hs, 1)
        y = 2.0 * torch.einsum("blp,dp->bld", hseq, Cmat).real + x * Dskip[None, None, :]
        return y

    def _B_ref(x, wqkv, wo):
        B, S, D = x.shape
        H = 32; Dh = D // H
        qkv = (lambda x, *d: x.permute(*d))((x @ wqkv).reshape(B, S, 3, H, Dh), 2, 0, 3, 1, 4)
        q, k, v = qkv[0], qkv[1], qkv[2]
        scale = Dh ** -0.5
        scores = torch.einsum("bhqd,bhkd->bhqk", q, k) * scale
        p = _softmax(scores, axis=-1)
        o = torch.einsum("bhqk,bhkd->bhqd", p, v)
        return (lambda x, *d: x.permute(*d))(o, 0, 2, 1, 3).reshape(B, S, D) @ wo

    x = A_x
    g = _sigmoid((x * gate_w).sum(-1, keepdims=True))
    a = _A_ref(x, A_Lambda_re, A_Lambda_im, A_B_re, A_B_im, A_C_re, A_C_im, A_log_dt, A_Dskip)
    b = _B_ref(x, B_wqkv, B_wo)
    return g * a + (1 - g) * b
```

```asm
; @launch kernel=k1_kernel grid=(256,1,1) block=(768,1,1) lds=163840
; @launch kernel=l2_kernel grid=(400,1,1) block=(512,1,1) lds=81920
.amdgcn_target "amdgcn-amd-amdhsa--gfx950"
.text
.globl k1_kernel
.p2align 8
.type k1_kernel,@function
k1_kernel:
  s_load_dwordx2 s[4:5], s[0:1], 120
  s_mov_b32 s6, 31457280
  s_mov_b32 s7, 0x00020000
  s_cmp_ge_u32 s2, 256
  s_cbranch_scc1 k1_exit
  s_load_dwordx2 s[8:9], s[0:1], 0
  s_load_dwordx2 s[12:13], s[0:1], 80
  v_lshrrev_b32 v1, 6, v0
  v_and_b32 v0, 63, v0
  v_readfirstlane_b32 s26, v1
  s_and_b32 s33, s2, 7
  s_lshr_b32 s34, s2, 3
  s_and_b32 s24, s33, 1
  s_lshl_b32 s24, s24, 3
  s_and_b32 s35, s34, 7
  s_add_u32 s24, s24, s35
  s_lshr_b32 s25, s33, 1
  s_lshl_b32 s25, s25, 2
  s_lshr_b32 s33, s34, 3
  s_add_u32 s25, s25, s33
  s_mul_i32 s35, s35, 2
  s_mul_i32 s33, s33, 1
  s_add_u32 s33, s33, s35
  s_mul_i32 s34, s33, 7282
  s_lshr_b32 s34, s34, 16
  s_mul_i32 s34, s34, 9
  s_sub_u32 s39, s33, s34
  s_lshr_b32 s44, s26, 2
  s_and_b32 s26, s26, 3
  s_lshl_b32 s29, s26, 12
  s_mul_i32 s32, s25, 216
  s_and_b32 s32, s32, 0xfffffff0
  s_sub_u32 s33, s25, 11
  s_lshl_b32 s33, s33, 2
  s_min_u32 s33, s33, 14
  s_lshl_b32 s34, s33, 6
  s_add_u32 s34, s34, 2304
  s_cmp_ge_u32 s25, 11
  s_cselect_b32 s36, 1, 0
  s_cselect_b32 s32, s34, s32
  s_cselect_b32 s37, s33, 0
  s_cmp_eq_u32 s44, 0
  s_cbranch_scc1 k1_compute
  s_lshl_b32 s33, s24, 7
  s_lshl_b32 s34, s26, 5
  s_add_u32 s33, s33, s34
  s_lshl_b32 s34, s26, 4
  s_add_u32 s35, s29, 16384
  s_mov_b64 s[40:41], -1
  s_cmp_eq_u32 s44, 2
  s_cselect_b32 s45, s36, 1
  s_cmp_eq_u32 s45, 0
  s_cmov_b32 s40, 0xf3ff3fff
  s_cmov_b32 s41, 0xfff3ff3f
  s_cmp_eq_u32 s44, 2
  s_cselect_b32 s23, s34, s33
  s_cselect_b32 s29, s35, s29
  s_cselect_b32 s45, 4, 3
  s_cselect_b32 s46, 2, 0
  s_cselect_b32 s47, 15, 7
  s_cselect_b32 s35, 0, 64
  s_cselect_b32 s34, s32, 0
  s_movk_i32 s22, 1152
  s_cmov_b32 s22, 3456
  s_movk_i32 s21, 8192
  s_cmov_b32 s21, 12800
  s_movk_i32 s31, 128
  s_cmov_b32 s31, 221184
  s_mov_b32 s18, 2359296
  s_cmov_b32 s18, 1990656
  s_mov_b32 s19, 0x00020000
  v_lshrrev_b32 v1, s45, v0
  v_add_u32 v1, s23, v1
  v_mul_u32_u24 v1, s22, v1
  v_add_u32 v1, s34, v1
  v_lshrrev_b32 v2, 4, v0
  v_lshlrev_b32 v2, s46, v2
  v_and_b32 v3, s47, v0
  v_xor_b32 v2, v2, v3
  v_lshlrev_b32 v2, 4, v2
  v_xor_b32 v3, s35, v2
  s_mul_i32 s33, s21, 2
  s_mul_i32 s34, s21, 3
  v_add_u32 v9, v1, v2
  v_add3_u32 v10, v1, v3, s21
  v_add3_u32 v11, v1, v2, s33
  v_add3_u32 v12, v1, v3, s34
  s_mul_i32 s30, s39, s31
  s_mul_i32 s38, s31, 9
  s_waitcnt lgkmcnt(0)
  s_cselect_b32 s16, s12, s8
  s_cselect_b32 s17, s13, s9
  s_add_u32 m0, s29, 0
  s_mov_b64 exec, s[40:41]
  buffer_load_dwordx4 v9, s[16:19], s30 offen offset:0 lds
  buffer_load_dwordx4 v10, s[16:19], s30 offen offset:1024 lds
  buffer_load_dwordx4 v11, s[16:19], s30 offen offset:2048 lds
  buffer_load_dwordx4 v12, s[16:19], s30 offen offset:3072 lds
  s_mov_b64 exec, -1
  s_add_u32 s30, s30, s31
  s_cmp_eq_u32 s30, s38
  s_cselect_b32 s30, 0, s30
  s_add_u32 m0, s29, 32768
  s_mov_b64 exec, s[40:41]
  buffer_load_dwordx4 v9, s[16:19], s30 offen offset:0 lds
  buffer_load_dwordx4 v10, s[16:19], s30 offen offset:1024 lds
  buffer_load_dwordx4 v11, s[16:19], s30 offen offset:2048 lds
  buffer_load_dwordx4 v12, s[16:19], s30 offen offset:3072 lds
  s_mov_b64 exec, -1
  s_add_u32 s30, s30, s31
  s_cmp_eq_u32 s30, s38
  s_cselect_b32 s30, 0, s30
  s_cmp_eq_u32 s44, 2
  s_cbranch_scc1 k1_wload
  v_and_b32 v1, 31, v0
  v_lshrrev_b32 v2, 2, v1
  v_and_b32 v2, 1, v2
  v_lshlrev_b32 v2, 5, v2
  v_lshrrev_b32 v3, 3, v1
  v_lshlrev_b32 v3, 2, v3
  v_add_u32 v2, v2, v3
  v_and_b32 v3, 3, v1
  v_add_u32 v2, v2, v3
  s_lshr_b32 s33, s25, 3
  s_lshl_b32 s33, s33, 6
  s_bfe_u32 s34, s25, 0x10002
  s_lshl_b32 s34, s34, 4
  s_add_u32 s33, s33, s34
  v_add_u32 v2, s33, v2
  v_lshrrev_b32 v3, 1, v2
  v_and_b32 v3, 7, v3
  v_lshrrev_b32 v4, 5, v0
  s_and_b32 s33, s25, 3
  s_lshl_b32 s34, s33, 1
  v_add_u32 v4, s34, v4
  v_xor_b32 v3, v3, v4
  v_lshlrev_b32 v3, 4, v3
  v_lshlrev_b32 v2, 7, v2
  v_add_u32 v13, v2, v3
  s_lshl_b32 s34, s24, 2
  s_lshr_b32 s35, s25, 2
  s_add_u32 s34, s34, s35
  s_mul_i32 s34, s34, 36
  s_add_u32 s34, s34, s33
  s_lshl_b32 s42, s34, 10
  s_add_u32 s42, s42, 16777216
  s_min_u32 s43, s26, 2
  v_lshlrev_b32 v28, 4, v0
  s_load_dwordx16 s[48:63], s[0:1], 8
  s_load_dwordx2 s[64:65], s[0:1], 88
  s_waitcnt vmcnt(4)
  s_barrier
  s_add_u32 m0, s29, 65536
  s_mov_b64 exec, s[40:41]
  buffer_load_dwordx4 v9, s[16:19], s30 offen offset:0 lds
  buffer_load_dwordx4 v10, s[16:19], s30 offen offset:1024 lds
  buffer_load_dwordx4 v11, s[16:19], s30 offen offset:2048 lds
  buffer_load_dwordx4 v12, s[16:19], s30 offen offset:3072 lds
  s_mov_b64 exec, -1
  s_add_u32 s30, s30, s31
  s_cmp_eq_u32 s30, s38
  s_cselect_b32 s30, 0, s30
  s_waitcnt vmcnt(4)
  s_waitcnt lgkmcnt(0)
  s_barrier
  s_add_u32 m0, s29, 98304
  s_mov_b64 exec, s[40:41]
  buffer_load_dwordx4 v9, s[16:19], s30 offen offset:0 lds
  buffer_load_dwordx4 v10, s[16:19], s30 offen offset:1024 lds
  buffer_load_dwordx4 v11, s[16:19], s30 offen offset:2048 lds
  buffer_load_dwordx4 v12, s[16:19], s30 offen offset:3072 lds
  s_mov_b64 exec, -1
  s_add_u32 s30, s30, s31
  s_cmp_eq_u32 s30, s38
  s_cselect_b32 s30, 0, s30
  s_waitcnt vmcnt(4)
  s_waitcnt lgkmcnt(0)
  s_barrier
  s_add_u32 m0, s29, 131072
  s_mov_b64 exec, s[40:41]
  buffer_load_dwordx4 v9, s[16:19], s30 offen offset:0 lds
  buffer_load_dwordx4 v10, s[16:19], s30 offen offset:1024 lds
  buffer_load_dwordx4 v11, s[16:19], s30 offen offset:2048 lds
  buffer_load_dwordx4 v12, s[16:19], s30 offen offset:3072 lds
  s_mov_b64 exec, -1
  s_add_u32 s30, s30, s31
  s_cmp_eq_u32 s30, s38
  s_cselect_b32 s30, 0, s30
  s_add_u32 s33, s43, 0
  s_sub_u32 s34, s33, 5
  s_cmp_ge_u32 s33, 5
  s_cselect_b32 s34, s34, s33
  s_mul_i32 s34, s34, 32768
  v_add_u32 v14, s34, v13
  ds_read_b128 v[16:19], v14
  s_add_u32 s33, s33, s39
  s_sub_u32 s34, s33, 9
  s_cmp_ge_u32 s33, 9
  s_cselect_b32 s33, s34, s33
  s_lshl_b32 s33, s33, 12
  s_add_u32 s33, s33, s42
  s_waitcnt lgkmcnt(0)
  buffer_store_dwordx4 v[16:19], v28, s[4:7], s33 offen sc1
  s_waitcnt vmcnt(5)
  s_waitcnt lgkmcnt(0)
  s_barrier
  s_add_u32 m0, s29, 0
  s_mov_b64 exec, s[40:41]
  buffer_load_dwordx4 v9, s[16:19], s30 offen offset:0 lds
  buffer_load_dwordx4 v10, s[16:19], s30 offen offset:1024 lds
  buffer_load_dwordx4 v11, s[16:19], s30 offen offset:2048 lds
  buffer_load_dwordx4 v12, s[16:19], s30 offen offset:3072 lds
  s_mov_b64 exec, -1
  s_add_u32 s30, s30, s31
  s_cmp_eq_u32 s30, s38
  s_cselect_b32 s30, 0, s30
  s_waitcnt vmcnt(5)
  s_waitcnt lgkmcnt(0)
  s_barrier
  s_add_u32 m0, s29, 32768
  s_mov_b64 exec, s[40:41]
  buffer_load_dwordx4 v9, s[16:19], s30 offen offset:0 lds
  buffer_load_dwordx4 v10, s[16:19], s30 offen offset:1024 lds
  buffer_load_dwordx4 v11, s[16:19], s30 offen offset:2048 lds
  buffer_load_dwordx4 v12, s[16:19], s30 offen offset:3072 lds
  s_mov_b64 exec, -1
  s_add_u32 s30, s30, s31
  s_cmp_eq_u32 s30, s38
  s_cselect_b32 s30, 0, s30
  s_waitcnt vmcnt(4)
  s_waitcnt lgkmcnt(0)
  s_barrier
  s_add_u32 m0, s29, 65536
  s_mov_b64 exec, s[40:41]
  buffer_load_dwordx4 v9, s[16:19], s30 offen offset:0 lds
  buffer_load_dwordx4 v10, s[16:19], s30 offen offset:1024 lds
  buffer_load_dwordx4 v11, s[16:19], s30 offen offset:2048 lds
  buffer_load_dwordx4 v12, s[16:19], s30 offen offset:3072 lds
  s_mov_b64 exec, -1
  s_add_u32 s30, s30, s31
  s_cmp_eq_u32 s30, s38
  s_cselect_b32 s30, 0, s30
  s_add_u32 s33, s43, 3
  s_sub_u32 s34, s33, 5
  s_cmp_ge_u32 s33, 5
  s_cselect_b32 s34, s34, s33
  s_mul_i32 s34, s34, 32768
  v_add_u32 v14, s34, v13
  ds_read_b128 v[16:19], v14
  s_add_u32 s33, s33, s39
  s_sub_u32 s34, s33, 9
  s_cmp_ge_u32 s33, 9
  s_cselect_b32 s33, s34, s33
  s_lshl_b32 s33, s33, 12
  s_add_u32 s33, s33, s42
  s_waitcnt lgkmcnt(0)
  buffer_store_dwordx4 v[16:19], v28, s[4:7], s33 offen sc1
  s_waitcnt vmcnt(5)
  s_waitcnt lgkmcnt(0)
  s_barrier
  s_add_u32 m0, s29, 98304
  s_mov_b64 exec, s[40:41]
  buffer_load_dwordx4 v9, s[16:19], s30 offen offset:0 lds
  buffer_load_dwordx4 v10, s[16:19], s30 offen offset:1024 lds
  buffer_load_dwordx4 v11, s[16:19], s30 offen offset:2048 lds
  buffer_load_dwordx4 v12, s[16:19], s30 offen offset:3072 lds
  s_mov_b64 exec, -1
  s_add_u32 s30, s30, s31
  s_cmp_eq_u32 s30, s38
  s_cselect_b32 s30, 0, s30
  s_waitcnt vmcnt(5)
  s_waitcnt lgkmcnt(0)
  s_barrier
  s_cmp_ge_u32 s2, 94
  s_cbranch_scc0 k1_xclr
  v_lshlrev_b32 v28, 4, v0
  v_lshrrev_b32 v32, 5, v0
  v_lshlrev_b32 v32, 4, v32
  v_and_b32 v33, 31, v0
  v_mul_u32_u24 v29, 1152, v33
  v_add_u32 v29, v29, v32
  s_lshl_b32 s69, s2, 2
  s_add_u32 s69, s69, s26
  s_sub_u32 s69, 1023, s69
  s_lshl_b32 s80, s69, 1
  s_mul_i32 s66, s80, 1821
  s_lshr_b32 s66, s66, 16
  s_mul_i32 s67, s66, 36
  s_sub_u32 s67, s80, s67
  s_lshl_b32 s67, s67, 5
  s_lshr_b32 s68, s66, 1
  s_mul_i32 s68, s68, 36864
  s_add_u32 s67, s67, s68
  s_bitcmp1_b32 s66, 0
  s_cselect_b32 s72, s54, s52
  s_cselect_b32 s73, s55, s53
  s_mov_b32 s74, 663552
  s_mov_b32 s75, 0x00020000
  buffer_load_dwordx4 v[20:23], v29, s[72:75], s67 offen
  buffer_load_dwordx4 v[24:27], v29, s[72:75], s67 offen offset:32
  s_waitcnt vmcnt(2)
  s_waitcnt lgkmcnt(0)
  s_barrier
  s_add_u32 s33, s43, 6
  s_sub_u32 s34, s33, 5
  s_cmp_ge_u32 s33, 5
  s_cselect_b32 s34, s34, s33
  s_mul_i32 s34, s34, 32768
  v_add_u32 v14, s34, v13
  ds_read_b128 v[16:19], v14
  s_add_u32 s33, s33, s39
  s_sub_u32 s34, s33, 9
  s_cmp_ge_u32 s33, 9
  s_cselect_b32 s33, s34, s33
  s_lshl_b32 s33, s33, 12
  s_add_u32 s33, s33, s42
  s_waitcnt lgkmcnt(0)
  buffer_store_dwordx4 v[16:19], v28, s[4:7], s33 offen sc1
  s_lshl_b32 s66, s80, 10
  s_add_u32 s66, s66, 19136512
  s_waitcnt vmcnt(2)
  buffer_store_dwordx4 v[20:23], v28, s[4:7], s66 offen sc1
  s_lshl_b32 s66, s80, 10
  s_add_u32 s66, s66, 19137536
  s_waitcnt vmcnt(2)
  buffer_store_dwordx4 v[24:27], v28, s[4:7], s66 offen sc1
  s_branch k1_end
k1_xclr:
  s_lshl_b32 s69, s2, 2
  s_add_u32 s69, s69, s26
  s_sub_u32 s66, s69, 148
  s_min_u32 s66, s66, 9
  s_lshl_b32 s66, s66, 6
  v_add_u32 v29, s66, v0
  v_lshlrev_b32 v32, 1, v29
  s_mov_b32 s72, s48
  s_mov_b32 s73, s49
  s_mov_b32 s74, 1152
  s_mov_b32 s75, 0x00020000
  buffer_load_ushort v20, v32, s[72:75], 0 offen
  s_mov_b32 s76, s50
  s_mov_b32 s77, s51
  s_mov_b32 s78, 1152
  s_mov_b32 s79, 0x00020000
  buffer_load_ushort v21, v32, s[76:79], 0 offen
  s_mov_b32 s72, s60
  s_mov_b32 s73, s61
  s_mov_b32 s74, 1152
  s_mov_b32 s75, 0x00020000
  buffer_load_ushort v22, v32, s[72:75], 0 offen
  s_waitcnt vmcnt(3)
  s_waitcnt lgkmcnt(0)
  s_barrier
  s_add_u32 s33, s43, 6
  s_sub_u32 s34, s33, 5
  s_cmp_ge_u32 s33, 5
  s_cselect_b32 s34, s34, s33
  s_mul_i32 s34, s34, 32768
  v_add_u32 v14, s34, v13
  ds_read_b128 v[16:19], v14
  s_add_u32 s33, s33, s39
  s_sub_u32 s34, s33, 9
  s_cmp_ge_u32 s33, 9
  s_cselect_b32 s33, s34, s33
  s_lshl_b32 s33, s33, 12
  s_add_u32 s33, s33, s42
  s_waitcnt lgkmcnt(0)
  buffer_store_dwordx4 v[16:19], v28, s[4:7], s33 offen sc1
  s_sub_u32 s66, s69, 148
  s_cmp_lt_u32 s66, 9
  s_cbranch_scc0 prep_lam_1
  s_waitcnt vmcnt(0)
  v_lshlrev_b32 v20, 16, v20
  v_lshlrev_b32 v21, 16, v21
  v_lshlrev_b32 v22, 16, v22
  v_mul_f32 v22, 0x3fb8aa3b, v22
  v_exp_f32 v22, v22
  s_nop 0
  v_cvt_pk_bf16_f32 v22, v22, v22
  v_lshlrev_b32 v22, 16, v22
  v_mul_f32 v32, v22, v20
  v_mul_f32 v33, v22, v21
  v_mul_f32 v32, 0x3fb8aa3b, v32
  v_mul_f32 v33, 0.15915494, v33
  v_exp_f32 v32, v32
  v_cos_f32 v34, v33
  v_sin_f32 v35, v33
  v_mul_f32 v24, v32, v34
  v_mul_f32 v25, v32, v35
  v_mul_f32 v32, v25, v25
  v_add_f32 v33, v24, v24
  v_fma_f32 v38, v24, v24, -v32
  v_mul_f32 v39, v33, v25
  v_mul_f32 v32, v39, v39
  v_add_f32 v33, v38, v38
  v_fma_f32 v38, v38, v38, -v32
  v_mul_f32 v39, v33, v39
  v_mul_f32 v32, v39, v39
  v_add_f32 v33, v38, v38
  v_fma_f32 v38, v38, v38, -v32
  v_mul_f32 v39, v33, v39
  v_mul_f32 v32, v39, v39
  v_add_f32 v33, v38, v38
  v_fma_f32 v38, v38, v38, -v32
  v_mul_f32 v39, v33, v39
  v_mul_f32 v32, v39, v39
  v_add_f32 v33, v38, v38
  v_fma_f32 v26, v38, v38, -v32
  v_mul_f32 v27, v33, v39
  v_mul_f32 v32, v27, v27
  v_add_f32 v33, v26, v26
  v_fma_f32 v36, v26, v26, -v32
  v_mul_f32 v37, v33, v27
  v_mul_f32 v32, v37, v37
  v_add_f32 v33, v36, v36
  v_fma_f32 v36, v36, v36, -v32
  v_mul_f32 v37, v33, v37
  v_lshlrev_b32 v32, 5, v29
  s_mov_b32 s66, 22036480
  buffer_store_dwordx4 v[24:27], v32, s[4:7], s66 offen sc1
  buffer_store_dwordx4 v[36:39], v32, s[4:7], s66 offen offset:16 sc1
prep_lam_1:
  s_lshl_b32 s69, s2, 2
  s_add_u32 s69, s69, s26
  s_cmp_lt_u32 s69, 154
  s_cbranch_scc0 prep_clr_2
  v_mov_b32 v32, 0
  v_mov_b32 v33, 0
  v_mov_b32 v34, 0
  v_mov_b32 v35, 0
  s_lshl_b32 s66, s69, 10
  s_add_u32 s67, s66, 22085632
  s_add_u32 s66, s66, 22134784
  s_cmp_lt_u32 s69, 144
  s_cselect_b32 s66, s67, s66
  buffer_store_dwordx4 v[32:35], v28, s[4:7], s66 offen sc1
prep_clr_2:
  s_branch k1_end
k1_wload:
  v_lshrrev_b32 v1, 3, v0
  v_and_b32 v1, 1, v1
  s_lshl_b32 s33, s25, 3
  s_lshl_b32 s34, s26, 1
  s_add_u32 s33, s33, s34
  v_add_u32 v1, s33, v1
  v_lshrrev_b32 v2, 1, v1
  v_and_b32 v3, 7, v0
  v_xor_b32 v2, v2, v3
  v_and_b32 v2, 7, v2
  v_lshlrev_b32 v2, 4, v2
  v_lshlrev_b32 v4, 7, v1
  v_add_u32 v13, v4, v2
  v_lshlrev_b32 v14, 4, v3
  v_add_u32 v128, 0x10000, v13
  v_add_u32 v129, 0x20000, v13
  s_load_dwordx2 s[20:21], s[0:1], 96
  s_mov_b32 s22, 1152
  s_mov_b32 s23, 0x00020000
  s_load_dwordx16 s[48:63], s[0:1], 8
  s_load_dwordx2 s[64:65], s[0:1], 88
  s_add_u32 s33, s39, 0
  s_sub_u32 s34, s33, 9
  s_cmp_ge_u32 s33, 9
  s_cselect_b32 s33, s34, s33
  s_lshl_b32 s33, s33, 7
  s_waitcnt lgkmcnt(0)
  buffer_load_dwordx4 v[52:55], v14, s[20:23], s33 offen
  s_add_u32 s33, s39, 1
  s_sub_u32 s34, s33, 9
  s_cmp_ge_u32 s33, 9
  s_cselect_b32 s33, s34, s33
  s_lshl_b32 s33, s33, 7
  buffer_load_dwordx4 v[56:59], v14, s[20:23], s33 offen
  s_add_u32 s33, s39, 2
  s_sub_u32 s34, s33, 9
  s_cmp_ge_u32 s33, 9
  s_cselect_b32 s33, s34, s33
  s_lshl_b32 s33, s33, 7
  buffer_load_dwordx4 v[60:63], v14, s[20:23], s33 offen
  s_add_u32 s33, s39, 3
  s_sub_u32 s34, s33, 9
  s_cmp_ge_u32 s33, 9
  s_cselect_b32 s33, s34, s33
  s_lshl_b32 s33, s33, 7
  buffer_load_dwordx4 v[64:67], v14, s[20:23], s33 offen
  s_add_u32 s33, s39, 4
  s_sub_u32 s34, s33, 9
  s_cmp_ge_u32 s33, 9
  s_cselect_b32 s33, s34, s33
  s_lshl_b32 s33, s33, 7
  buffer_load_dwordx4 v[68:71], v14, s[20:23], s33 offen
  s_add_u32 s33, s39, 5
  s_sub_u32 s34, s33, 9
  s_cmp_ge_u32 s33, 9
  s_cselect_b32 s33, s34, s33
  s_lshl_b32 s33, s33, 7
  buffer_load_dwordx4 v[72:75], v14, s[20:23], s33 offen
  s_add_u32 s33, s39, 6
  s_sub_u32 s34, s33, 9
  s_cmp_ge_u32 s33, 9
  s_cselect_b32 s33, s34, s33
  s_lshl_b32 s33, s33, 7
  buffer_load_dwordx4 v[76:79], v14, s[20:23], s33 offen
  s_add_u32 s33, s39, 7
  s_sub_u32 s34, s33, 9
  s_cmp_ge_u32 s33, 9
  s_cselect_b32 s33, s34, s33
  s_lshl_b32 s33, s33, 7
  buffer_load_dwordx4 v[80:83], v14, s[20:23], s33 offen
  s_add_u32 s33, s39, 8
  s_sub_u32 s34, s33, 9
  s_cmp_ge_u32 s33, 9
  s_cselect_b32 s33, s34, s33
  s_lshl_b32 s33, s33, 7
  buffer_load_dwordx4 v[84:87], v14, s[20:23], s33 offen
  s_waitcnt vmcnt(13)
  s_barrier
  s_add_u32 m0, s29, 65536
  s_mov_b64 exec, s[40:41]
  buffer_load_dwordx4 v9, s[16:19], s30 offen offset:0 lds
  buffer_load_dwordx4 v10, s[16:19], s30 offen offset:1024 lds
  buffer_load_dwordx4 v11, s[16:19], s30 offen offset:2048 lds
  buffer_load_dwordx4 v12, s[16:19], s30 offen offset:3072 lds
  s_mov_b64 exec, -1
  s_add_u32 s30, s30, s31
  s_cmp_eq_u32 s30, s38
  s_cselect_b32 s30, 0, s30
  s_waitcnt vmcnt(13)
  s_waitcnt lgkmcnt(0)
  s_barrier
  s_add_u32 m0, s29, 98304
  s_mov_b64 exec, s[40:41]
  buffer_load_dwordx4 v9, s[16:19], s30 offen offset:0 lds
  buffer_load_dwordx4 v10, s[16:19], s30 offen offset:1024 lds
  buffer_load_dwordx4 v11, s[16:19], s30 offen offset:2048 lds
  buffer_load_dwordx4 v12, s[16:19], s30 offen offset:3072 lds
  s_mov_b64 exec, -1
  s_add_u32 s30, s30, s31
  s_cmp_eq_u32 s30, s38
  s_cselect_b32 s30, 0, s30
  s_waitcnt vmcnt(4)
  s_waitcnt lgkmcnt(0)
  s_barrier
  s_add_u32 m0, s29, 131072
  s_mov_b64 exec, s[40:41]
  buffer_load_dwordx4 v9, s[16:19], s30 offen offset:0 lds
  buffer_load_dwordx4 v10, s[16:19], s30 offen offset:1024 lds
  buffer_load_dwordx4 v11, s[16:19], s30 offen offset:2048 lds
  buffer_load_dwordx4 v12, s[16:19], s30 offen offset:3072 lds
  s_mov_b64 exec, -1
  s_add_u32 s30, s30, s31
  s_cmp_eq_u32 s30, s38
  s_cselect_b32 s30, 0, s30
  ds_read_b128 v[16:19], v13 offset:0
  ds_read_b128 v[20:23], v13 offset:32768
  ds_read_b128 v[24:27], v128 offset:0
  s_waitcnt vmcnt(4)
  s_waitcnt lgkmcnt(0)
  s_barrier
  s_add_u32 m0, s29, 0
  s_mov_b64 exec, s[40:41]
  buffer_load_dwordx4 v9, s[16:19], s30 offen offset:0 lds
  buffer_load_dwordx4 v10, s[16:19], s30 offen offset:1024 lds
  buffer_load_dwordx4 v11, s[16:19], s30 offen offset:2048 lds
  buffer_load_dwordx4 v12, s[16:19], s30 offen offset:3072 lds
  s_mov_b64 exec, -1
  s_add_u32 s30, s30, s31
  s_cmp_eq_u32 s30, s38
  s_cselect_b32 s30, 0, s30
  s_waitcnt vmcnt(4)
  s_waitcnt lgkmcnt(0)
  s_barrier
  s_add_u32 m0, s29, 32768
  s_mov_b64 exec, s[40:41]
  buffer_load_dwordx4 v9, s[16:19], s30 offen offset:0 lds
  buffer_load_dwordx4 v10, s[16:19], s30 offen offset:1024 lds
  buffer_load_dwordx4 v11, s[16:19], s30 offen offset:2048 lds
  buffer_load_dwordx4 v12, s[16:19], s30 offen offset:3072 lds
  s_mov_b64 exec, -1
  s_add_u32 s30, s30, s31
  s_cmp_eq_u32 s30, s38
  s_cselect_b32 s30, 0, s30
  s_waitcnt vmcnt(4)
  s_waitcnt lgkmcnt(0)
  s_barrier
  s_add_u32 m0, s29, 65536
  s_mov_b64 exec, s[40:41]
  buffer_load_dwordx4 v9, s[16:19], s30 offen offset:0 lds
  buffer_load_dwordx4 v10, s[16:19], s30 offen offset:1024 lds
  buffer_load_dwordx4 v11, s[16:19], s30 offen offset:2048 lds
  buffer_load_dwordx4 v12, s[16:19], s30 offen offset:3072 lds
  s_mov_b64 exec, -1
  s_add_u32 s30, s30, s31
  s_cmp_eq_u32 s30, s38
  s_cselect_b32 s30, 0, s30
  ds_read_b128 v[28:31], v128 offset:32768
  ds_read_b128 v[32:35], v129 offset:0
  ds_read_b128 v[36:39], v13 offset:0
  s_waitcnt vmcnt(4)
  s_waitcnt lgkmcnt(0)
  s_barrier
  s_add_u32 m0, s29, 98304
  s_mov_b64 exec, s[40:41]
  buffer_load_dwordx4 v9, s[16:19], s30 offen offset:0 lds
  buffer_load_dwordx4 v10, s[16:19], s30 offen offset:1024 lds
  buffer_load_dwordx4 v11, s[16:19], s30 offen offset:2048 lds
  buffer_load_dwordx4 v12, s[16:19], s30 offen offset:3072 lds
  s_mov_b64 exec, -1
  s_add_u32 s30, s30, s31
  s_cmp_eq_u32 s30, s38
  s_cselect_b32 s30, 0, s30
  s_waitcnt vmcnt(4)
  s_waitcnt lgkmcnt(0)
  s_barrier
  s_cmp_lt_u32 s2, 162
  s_cbranch_scc0 k1_wp_cf_next
  v_lshlrev_b32 v99, 4, v0
  v_lshrrev_b32 v104, 5, v0
  v_lshlrev_b32 v104, 4, v104
  v_and_b32 v105, 31, v0
  v_mul_u32_u24 v100, 1152, v105
  v_add_u32 v100, v100, v104
  s_lshl_b32 s69, s2, 2
  s_add_u32 s69, s69, s26
  s_mul_i32 s66, s69, 1821
  s_lshr_b32 s66, s66, 16
  s_mul_i32 s67, s66, 36
  s_sub_u32 s67, s69, s67
  s_mul_i32 s80, s66, 72
  s_add_u32 s80, s80, s67
  s_lshl_b32 s67, s67, 5
  s_mul_i32 s68, s66, 36864
  s_add_u32 s68, s68, s67
  s_mov_b32 s72, s56
  s_mov_b32 s73, s57
  s_mov_b32 s74, 663552
  s_mov_b32 s75, 0x00020000
  s_mov_b32 s76, s58
  s_mov_b32 s77, s59
  s_mov_b32 s78, 663552
  s_mov_b32 s79, 0x00020000
  buffer_load_dwordx4 v[88:91], v100, s[72:75], s68 offen
  buffer_load_dwordx4 v[92:95], v100, s[76:79], s68 offen
  v_lshrrev_b32 v104, 5, v0
  v_lshlrev_b32 v104, 3, v104
  v_and_b32 v105, 7, v0
  v_add_u32 v104, v104, v105
  v_lshlrev_b32 v104, 1, v104
  s_mov_b32 s72, s48
  s_mov_b32 s73, s49
  s_mov_b32 s74, 1152
  s_mov_b32 s75, 0x00020000
  buffer_load_ushort v96, v104, s[72:75], s67 offen
  s_mov_b32 s76, s50
  s_mov_b32 s77, s51
  s_mov_b32 s78, 1152
  s_mov_b32 s79, 0x00020000
  buffer_load_ushort v97, v104, s[76:79], s67 offen
  s_mov_b32 s72, s60
  s_mov_b32 s73, s61
  s_mov_b32 s74, 1152
  s_mov_b32 s75, 0x00020000
  buffer_load_ushort v98, v104, s[72:75], s67 offen
  s_waitcnt vmcnt(5)
  s_waitcnt lgkmcnt(0)
  s_barrier
  ds_read_b128 v[40:43], v13 offset:32768
  ds_read_b128 v[44:47], v128 offset:0
  ds_read_b128 v[48:51], v128 offset:32768
  v_mov_b32 v1, 0
  v_mov_b32 v2, 0
  v_dot2c_f32_bf16 v1, v16, v52
  v_dot2c_f32_bf16 v2, v17, v53
  v_dot2c_f32_bf16 v1, v18, v54
  v_dot2c_f32_bf16 v2, v19, v55
  v_dot2c_f32_bf16 v1, v20, v56
  v_dot2c_f32_bf16 v2, v21, v57
  v_dot2c_f32_bf16 v1, v22, v58
  v_dot2c_f32_bf16 v2, v23, v59
  v_dot2c_f32_bf16 v1, v24, v60
  v_dot2c_f32_bf16 v2, v25, v61
  v_dot2c_f32_bf16 v1, v26, v62
  v_dot2c_f32_bf16 v2, v27, v63
  v_dot2c_f32_bf16 v1, v28, v64
  v_dot2c_f32_bf16 v2, v29, v65
  v_dot2c_f32_bf16 v1, v30, v66
  v_dot2c_f32_bf16 v2, v31, v67
  v_dot2c_f32_bf16 v1, v32, v68
  v_dot2c_f32_bf16 v2, v33, v69
  v_dot2c_f32_bf16 v1, v34, v70
  v_dot2c_f32_bf16 v2, v35, v71
  v_dot2c_f32_bf16 v1, v36, v72
  v_dot2c_f32_bf16 v2, v37, v73
  v_dot2c_f32_bf16 v1, v38, v74
  v_dot2c_f32_bf16 v2, v39, v75
  s_waitcnt lgkmcnt(2)
  v_dot2c_f32_bf16 v1, v40, v76
  v_dot2c_f32_bf16 v2, v41, v77
  v_dot2c_f32_bf16 v1, v42, v78
  v_dot2c_f32_bf16 v2, v43, v79
  s_waitcnt lgkmcnt(1)
  v_dot2c_f32_bf16 v1, v44, v80
  v_dot2c_f32_bf16 v2, v45, v81
  v_dot2c_f32_bf16 v1, v46, v82
  v_dot2c_f32_bf16 v2, v47, v83
  s_waitcnt lgkmcnt(0)
  v_dot2c_f32_bf16 v1, v48, v84
  v_dot2c_f32_bf16 v2, v49, v85
  v_dot2c_f32_bf16 v1, v50, v86
  v_dot2c_f32_bf16 v2, v51, v87
  s_nop 2
  v_add_f32 v1, v1, v2
  s_nop 1
  v_add_f32_dpp v1, v1, v1 quad_perm:[1,0,3,2] row_mask:0xf bank_mask:0xf
  s_nop 1
  v_add_f32_dpp v1, v1, v1 quad_perm:[2,3,0,1] row_mask:0xf bank_mask:0xf
  s_nop 1
  v_add_f32_dpp v1, v1, v1 row_half_mirror row_mask:0xf bank_mask:0xf
  v_mul_f32 v1, 0xbfb8aa3b, v1
  v_exp_f32 v1, v1
  s_nop 0
  v_add_f32 v1, 1.0, v1
  v_rcp_f32 v1, v1
  v_lshrrev_b32 v2, 3, v0
  v_lshlrev_b32 v2, 2, v2
  s_lshl_b32 s33, s24, 7
  s_lshl_b32 s34, s25, 3
  s_add_u32 s33, s33, s34
  s_lshl_b32 s34, s26, 1
  s_add_u32 s33, s33, s34
  s_lshl_b32 s33, s33, 2
  s_add_u32 s33, s33, 22020096
  s_mov_b32 exec_lo, 0x101
  s_mov_b32 exec_hi, 0
  buffer_store_dword v1, v2, s[4:7], s33 offen sc1
  s_mov_b64 exec, -1
  s_waitcnt vmcnt(3)
  v_lshlrev_b32 v96, 16, v96
  s_waitcnt vmcnt(2)
  v_lshlrev_b32 v97, 16, v97
  s_waitcnt vmcnt(1)
  v_lshlrev_b32 v98, 16, v98
  v_mul_f32 v98, 0x3fb8aa3b, v98
  v_exp_f32 v98, v98
  s_nop 0
  v_cvt_pk_bf16_f32 v98, v98, v98
  v_lshlrev_b32 v98, 16, v98
  v_mul_f32 v112, v98, v96
  v_mul_f32 v113, v98, v97
  v_mul_f32 v112, 0x3fb8aa3b, v112
  v_mul_f32 v113, 0.15915494, v113
  v_exp_f32 v112, v112
  v_cos_f32 v114, v113
  v_sin_f32 v115, v113
  v_mul_f32 v108, v112, v114
  v_mul_f32 v109, v112, v115
  v_add_f32 v112, -1.0, v108
  v_mul_f32 v113, v96, v96
  v_fmac_f32 v113, v97, v97
  v_rcp_f32 v113, v113
  v_mul_f32 v110, v112, v96
  v_fmac_f32 v110, v109, v97
  v_mul_f32 v111, v109, v96
  v_mul_f32 v114, v112, v97
  v_sub_f32 v111, v111, v114
  v_mul_f32 v110, v110, v113
  v_mul_f32 v111, v111, v113
  v_add_f32 v110, v110, v110
  v_add_f32 v111, v111, v111
  v_lshlrev_b32 v108, 16, v88
  v_lshlrev_b32 v109, 16, v92
  s_nop 1
  v_mul_f32_dpp v120, v111, v109 row_newbcast:0 row_mask:0xf bank_mask:0xf
  v_mul_f32_dpp v112, v110, v108 row_newbcast:0 row_mask:0xf bank_mask:0xf
  v_sub_f32 v112, v112, v120
  v_mul_f32_dpp v120, v111, v108 row_newbcast:0 row_mask:0xf bank_mask:0xf
  s_nop 1
  v_fmac_f32_dpp v120, v110, v109 row_newbcast:0 row_mask:0xf bank_mask:0xf
  v_and_b32 v108, 0xffff0000, v88
  v_and_b32 v109, 0xffff0000, v92
  s_nop 1
  v_mul_f32_dpp v121, v111, v109 row_newbcast:1 row_mask:0xf bank_mask:0xf
  v_mul_f32_dpp v113, v110, v108 row_newbcast:1 row_mask:0xf bank_mask:0xf
  v_sub_f32 v113, v113, v121
  v_mul_f32_dpp v121, v111, v108 row_newbcast:1 row_mask:0xf bank_mask:0xf
  s_nop 1
  v_fmac_f32_dpp v121, v110, v109 row_newbcast:1 row_mask:0xf bank_mask:0xf
  v_lshlrev_b32 v108, 16, v89
  v_lshlrev_b32 v109, 16, v93
  s_nop 1
  v_mul_f32_dpp v122, v111, v109 row_newbcast:2 row_mask:0xf bank_mask:0xf
  v_mul_f32_dpp v114, v110, v108 row_newbcast:2 row_mask:0xf bank_mask:0xf
  v_sub_f32 v114, v114, v122
  v_mul_f32_dpp v122, v111, v108 row_newbcast:2 row_mask:0xf bank_mask:0xf
  s_nop 1
  v_fmac_f32_dpp v122, v110, v109 row_newbcast:2 row_mask:0xf bank_mask:0xf
  v_and_b32 v108, 0xffff0000, v89
  v_and_b32 v109, 0xffff0000, v93
  s_nop 1
  v_mul_f32_dpp v123, v111, v109 row_newbcast:3 row_mask:0xf bank_mask:0xf
  v_mul_f32_dpp v115, v110, v108 row_newbcast:3 row_mask:0xf bank_mask:0xf
  v_sub_f32 v115, v115, v123
  v_mul_f32_dpp v123, v111, v108 row_newbcast:3 row_mask:0xf bank_mask:0xf
  s_nop 1
  v_fmac_f32_dpp v123, v110, v109 row_newbcast:3 row_mask:0xf bank_mask:0xf
  v_lshlrev_b32 v108, 16, v90
  v_lshlrev_b32 v109, 16, v94
  s_nop 1
  v_mul_f32_dpp v124, v111, v109 row_newbcast:4 row_mask:0xf bank_mask:0xf
  v_mul_f32_dpp v116, v110, v108 row_newbcast:4 row_mask:0xf bank_mask:0xf
  v_sub_f32 v116, v116, v124
  v_mul_f32_dpp v124, v111, v108 row_newbcast:4 row_mask:0xf bank_mask:0xf
  s_nop 1
  v_fmac_f32_dpp v124, v110, v109 row_newbcast:4 row_mask:0xf bank_mask:0xf
  v_and_b32 v108, 0xffff0000, v90
  v_and_b32 v109, 0xffff0000, v94
  s_nop 1
  v_mul_f32_dpp v125, v111, v109 row_newbcast:5 row_mask:0xf bank_mask:0xf
  v_mul_f32_dpp v117, v110, v108 row_newbcast:5 row_mask:0xf bank_mask:0xf
  v_sub_f32 v117, v117, v125
  v_mul_f32_dpp v125, v111, v108 row_newbcast:5 row_mask:0xf bank_mask:0xf
  s_nop 1
  v_fmac_f32_dpp v125, v110, v109 row_newbcast:5 row_mask:0xf bank_mask:0xf
  v_lshlrev_b32 v108, 16, v91
  v_lshlrev_b32 v109, 16, v95
  s_nop 1
  v_mul_f32_dpp v126, v111, v109 row_newbcast:6 row_mask:0xf bank_mask:0xf
  v_mul_f32_dpp v118, v110, v108 row_newbcast:6 row_mask:0xf bank_mask:0xf
  v_sub_f32 v118, v118, v126
  v_mul_f32_dpp v126, v111, v108 row_newbcast:6 row_mask:0xf bank_mask:0xf
  s_nop 1
  v_fmac_f32_dpp v126, v110, v109 row_newbcast:6 row_mask:0xf bank_mask:0xf
  v_and_b32 v108, 0xffff0000, v91
  v_and_b32 v109, 0xffff0000, v95
  s_nop 1
  v_mul_f32_dpp v127, v111, v109 row_newbcast:7 row_mask:0xf bank_mask:0xf
  v_mul_f32_dpp v119, v110, v108 row_newbcast:7 row_mask:0xf bank_mask:0xf
  v_sub_f32 v119, v119, v127
  v_mul_f32_dpp v127, v111, v108 row_newbcast:7 row_mask:0xf bank_mask:0xf
  s_nop 1
  v_fmac_f32_dpp v127, v110, v109 row_newbcast:7 row_mask:0xf bank_mask:0xf
  v_cvt_pk_bf16_f32 v88, v112, v113
  v_cvt_pk_bf16_f32 v92, -v120, -v121
  v_cvt_pk_bf16_f32 v89, v114, v115
  v_cvt_pk_bf16_f32 v93, -v122, -v123
  v_cvt_pk_bf16_f32 v90, v116, v117
  v_cvt_pk_bf16_f32 v94, -v124, -v125
  v_cvt_pk_bf16_f32 v91, v118, v119
  v_cvt_pk_bf16_f32 v95, -v126, -v127
  s_lshl_b32 s66, s80, 10
  s_add_u32 s66, s66, 20512768
  buffer_store_dwordx4 v[88:91], v99, s[4:7], s66 offen sc1
  s_lshl_b32 s66, s80, 10
  s_add_u32 s66, s66, 20549632
  buffer_store_dwordx4 v[92:95], v99, s[4:7], s66 offen sc1
  s_branch k1_end
k1_wp_cf_next:
  s_cmp_lt_u32 s2, 243
  s_cbranch_scc0 k1_wp_wf_next
  v_lshlrev_b32 v99, 4, v0
  s_lshl_b32 s69, s2, 2
  s_add_u32 s69, s69, s26
  s_sub_u32 s69, s69, 648
  s_mul_i32 s66, s69, 1821
  s_lshr_b32 s66, s66, 16
  s_mul_i32 s67, s66, 36
  s_sub_u32 s67, s69, s67
  s_mul_i32 s80, s66, 72
  s_add_u32 s80, s80, s67
  v_and_b32 v104, 31, v0
  v_lshlrev_b32 v104, 1, v104
  s_lshl_b32 s66, s66, 7
  v_add_u32 v104, s66, v104
  v_lshrrev_b32 v105, 5, v0
  s_mov_b32 s68, 82944
  s_cmp_lt_u32 s67, 32
  s_cselect_b32 s68, 4608, s68
  v_mul_lo_u32 v105, v105, s68
  v_add_u32 v101, v104, v105
  s_mul_i32 s66, s67, 20736
  s_sub_u32 s68, s67, 32
  s_mul_i32 s68, s68, 165888
  s_add_u32 s68, s68, 18432
  s_cmp_lt_u32 s67, 32
  s_cselect_b32 s66, s66, s68
  s_mov_b32 s72, s64
  s_mov_b32 s73, s65
  s_mov_b32 s74, 663552
  s_mov_b32 s75, 0x00020000
  s_cmp_lt_u32 s67, 32
  s_cbranch_scc0 prep_whi_4
  s_add_u32 s68, s66, 0
  buffer_load_ushort v112, v101, s[72:75], s68 offen
  buffer_load_ushort v120, v101, s[72:75], s68 offen offset:64
  s_add_u32 s68, s66, 1152
  buffer_load_ushort v113, v101, s[72:75], s68 offen
  buffer_load_ushort v121, v101, s[72:75], s68 offen offset:64
  s_add_u32 s68, s66, 2304
  buffer_load_ushort v114, v101, s[72:75], s68 offen
  buffer_load_ushort v122, v101, s[72:75], s68 offen offset:64
  s_add_u32 s68, s66, 3456
  buffer_load_ushort v115, v101, s[72:75], s68 offen
  buffer_load_ushort v123, v101, s[72:75], s68 offen offset:64
  s_add_u32 s68, s66, 9216
  buffer_load_ushort v116, v101, s[72:75], s68 offen
  buffer_load_ushort v124, v101, s[72:75], s68 offen offset:64
  s_add_u32 s68, s66, 10368
  buffer_load_ushort v117, v101, s[72:75], s68 offen
  buffer_load_ushort v125, v101, s[72:75], s68 offen offset:64
  s_add_u32 s68, s66, 11520
  buffer_load_ushort v118, v101, s[72:75], s68 offen
  buffer_load_ushort v126, v101, s[72:75], s68 offen offset:64
  s_add_u32 s68, s66, 12672
  buffer_load_ushort v119, v101, s[72:75], s68 offen
  buffer_load_ushort v127, v101, s[72:75], s68 offen offset:64
  s_branch prep_w_3
prep_whi_4:
  s_add_u32 s68, s66, 0
  buffer_load_ushort v112, v101, s[72:75], s68 offen
  buffer_load_ushort v120, v101, s[72:75], s68 offen offset:64
  s_add_u32 s68, s66, 1152
  buffer_load_ushort v113, v101, s[72:75], s68 offen
  buffer_load_ushort v121, v101, s[72:75], s68 offen offset:64
  s_add_u32 s68, s66, 20736
  buffer_load_ushort v114, v101, s[72:75], s68 offen
  buffer_load_ushort v122, v101, s[72:75], s68 offen offset:64
  s_add_u32 s68, s66, 21888
  buffer_load_ushort v115, v101, s[72:75], s68 offen
  buffer_load_ushort v123, v101, s[72:75], s68 offen offset:64
  s_add_u32 s68, s66, 41472
  buffer_load_ushort v116, v101, s[72:75], s68 offen
  buffer_load_ushort v124, v101, s[72:75], s68 offen offset:64
  s_add_u32 s68, s66, 42624
  buffer_load_ushort v117, v101, s[72:75], s68 offen
  buffer_load_ushort v125, v101, s[72:75], s68 offen offset:64
  s_add_u32 s68, s66, 62208
  buffer_load_ushort v118, v101, s[72:75], s68 offen
  buffer_load_ushort v126, v101, s[72:75], s68 offen offset:64
  s_add_u32 s68, s66, 63360
  buffer_load_ushort v119, v101, s[72:75], s68 offen
  buffer_load_ushort v127, v101, s[72:75], s68 offen offset:64
prep_w_3:
  s_waitcnt vmcnt(16)
  s_waitcnt lgkmcnt(0)
  s_barrier
  ds_read_b128 v[40:43], v13 offset:32768
  ds_read_b128 v[44:47], v128 offset:0
  ds_read_b128 v[48:51], v128 offset:32768
  v_mov_b32 v1, 0
  v_mov_b32 v2, 0
  v_dot2c_f32_bf16 v1, v16, v52
  v_dot2c_f32_bf16 v2, v17, v53
  v_dot2c_f32_bf16 v1, v18, v54
  v_dot2c_f32_bf16 v2, v19, v55
  v_dot2c_f32_bf16 v1, v20, v56
  v_dot2c_f32_bf16 v2, v21, v57
  v_dot2c_f32_bf16 v1, v22, v58
  v_dot2c_f32_bf16 v2, v23, v59
  v_dot2c_f32_bf16 v1, v24, v60
  v_dot2c_f32_bf16 v2, v25, v61
  v_dot2c_f32_bf16 v1, v26, v62
  v_dot2c_f32_bf16 v2, v27, v63
  v_dot2c_f32_bf16 v1, v28, v64
  v_dot2c_f32_bf16 v2, v29, v65
  v_dot2c_f32_bf16 v1, v30, v66
  v_dot2c_f32_bf16 v2, v31, v67
  v_dot2c_f32_bf16 v1, v32, v68
  v_dot2c_f32_bf16 v2, v33, v69
  v_dot2c_f32_bf16 v1, v34, v70
  v_dot2c_f32_bf16 v2, v35, v71
  v_dot2c_f32_bf16 v1, v36, v72
  v_dot2c_f32_bf16 v2, v37, v73
  v_dot2c_f32_bf16 v1, v38, v74
  v_dot2c_f32_bf16 v2, v39, v75
  s_waitcnt lgkmcnt(2)
  v_dot2c_f32_bf16 v1, v40, v76
  v_dot2c_f32_bf16 v2, v41, v77
  v_dot2c_f32_bf16 v1, v42, v78
  v_dot2c_f32_bf16 v2, v43, v79
  s_waitcnt lgkmcnt(1)
  v_dot2c_f32_bf16 v1, v44, v80
  v_dot2c_f32_bf16 v2, v45, v81
  v_dot2c_f32_bf16 v1, v46, v82
  v_dot2c_f32_bf16 v2, v47, v83
  s_waitcnt lgkmcnt(0)
  v_dot2c_f32_bf16 v1, v48, v84
  v_dot2c_f32_bf16 v2, v49, v85
  v_dot2c_f32_bf16 v1, v50, v86
  v_dot2c_f32_bf16 v2, v51, v87
  s_nop 2
  v_add_f32 v1, v1, v2
  s_nop 1
  v_add_f32_dpp v1, v1, v1 quad_perm:[1,0,3,2] row_mask:0xf bank_mask:0xf
  s_nop 1
  v_add_f32_dpp v1, v1, v1 quad_perm:[2,3,0,1] row_mask:0xf bank_mask:0xf
  s_nop 1
  v_add_f32_dpp v1, v1, v1 row_half_mirror row_mask:0xf bank_mask:0xf
  v_mul_f32 v1, 0xbfb8aa3b, v1
  v_exp_f32 v1, v1
  s_nop 0
  v_add_f32 v1, 1.0, v1
  v_rcp_f32 v1, v1
  v_lshrrev_b32 v2, 3, v0
  v_lshlrev_b32 v2, 2, v2
  s_lshl_b32 s33, s24, 7
  s_lshl_b32 s34, s25, 3
  s_add_u32 s33, s33, s34
  s_lshl_b32 s34, s26, 1
  s_add_u32 s33, s33, s34
  s_lshl_b32 s33, s33, 2
  s_add_u32 s33, s33, 22020096
  s_mov_b32 exec_lo, 0x101
  s_mov_b32 exec_hi, 0
  buffer_store_dword v1, v2, s[4:7], s33 offen sc1
  s_mov_b64 exec, -1
  s_waitcnt vmcnt(14)
  v_lshl_or_b32 v104, v113, 16, v112
  s_waitcnt vmcnt(10)
  v_lshl_or_b32 v105, v115, 16, v114
  s_waitcnt vmcnt(6)
  v_lshl_or_b32 v106, v117, 16, v116
  s_waitcnt vmcnt(2)
  v_lshl_or_b32 v107, v119, 16, v118
  s_lshl_b32 s66, s80, 10
  s_add_u32 s66, s66, 23068672
  buffer_store_dwordx4 v[104:107], v99, s[4:7], s66 offen sc1
  v_lshl_or_b32 v108, v121, 16, v120
  v_lshl_or_b32 v109, v123, 16, v122
  v_lshl_or_b32 v110, v125, 16, v124
  s_waitcnt vmcnt(2)
  v_lshl_or_b32 v111, v127, 16, v126
  s_lshl_b32 s66, s80, 10
  s_add_u32 s66, s66, 23105536
  buffer_store_dwordx4 v[108:111], v99, s[4:7], s66 offen sc1
  s_branch k1_end
k1_wp_wf_next:
  s_waitcnt vmcnt(0)
  s_waitcnt lgkmcnt(0)
  s_barrier
  ds_read_b128 v[40:43], v13 offset:32768
  ds_read_b128 v[44:47], v128 offset:0
  ds_read_b128 v[48:51], v128 offset:32768
  v_mov_b32 v1, 0
  v_mov_b32 v2, 0
  v_dot2c_f32_bf16 v1, v16, v52
  v_dot2c_f32_bf16 v2, v17, v53
  v_dot2c_f32_bf16 v1, v18, v54
  v_dot2c_f32_bf16 v2, v19, v55
  v_dot2c_f32_bf16 v1, v20, v56
  v_dot2c_f32_bf16 v2, v21, v57
  v_dot2c_f32_bf16 v1, v22, v58
  v_dot2c_f32_bf16 v2, v23, v59
  v_dot2c_f32_bf16 v1, v24, v60
  v_dot2c_f32_bf16 v2, v25, v61
  v_dot2c_f32_bf16 v1, v26, v62
  v_dot2c_f32_bf16 v2, v27, v63
  v_dot2c_f32_bf16 v1, v28, v64
  v_dot2c_f32_bf16 v2, v29, v65
  v_dot2c_f32_bf16 v1, v30, v66
  v_dot2c_f32_bf16 v2, v31, v67
  v_dot2c_f32_bf16 v1, v32, v68
  v_dot2c_f32_bf16 v2, v33, v69
  v_dot2c_f32_bf16 v1, v34, v70
  v_dot2c_f32_bf16 v2, v35, v71
  v_dot2c_f32_bf16 v1, v36, v72
  v_dot2c_f32_bf16 v2, v37, v73
  v_dot2c_f32_bf16 v1, v38, v74
  v_dot2c_f32_bf16 v2, v39, v75
  s_waitcnt lgkmcnt(2)
  v_dot2c_f32_bf16 v1, v40, v76
  v_dot2c_f32_bf16 v2, v41, v77
  v_dot2c_f32_bf16 v1, v42, v78
  v_dot2c_f32_bf16 v2, v43, v79
  s_waitcnt lgkmcnt(1)
  v_dot2c_f32_bf16 v1, v44, v80
  v_dot2c_f32_bf16 v2, v45, v81
  v_dot2c_f32_bf16 v1, v46, v82
  v_dot2c_f32_bf16 v2, v47, v83
  s_waitcnt lgkmcnt(0)
  v_dot2c_f32_bf16 v1, v48, v84
  v_dot2c_f32_bf16 v2, v49, v85
  v_dot2c_f32_bf16 v1, v50, v86
  v_dot2c_f32_bf16 v2, v51, v87
  s_nop 2
  v_add_f32 v1, v1, v2
  s_nop 1
  v_add_f32_dpp v1, v1, v1 quad_perm:[1,0,3,2] row_mask:0xf bank_mask:0xf
  s_nop 1
  v_add_f32_dpp v1, v1, v1 quad_perm:[2,3,0,1] row_mask:0xf bank_mask:0xf
  s_nop 1
  v_add_f32_dpp v1, v1, v1 row_half_mirror row_mask:0xf bank_mask:0xf
  v_mul_f32 v1, 0xbfb8aa3b, v1
  v_exp_f32 v1, v1
  s_nop 0
  v_add_f32 v1, 1.0, v1
  v_rcp_f32 v1, v1
  v_lshrrev_b32 v2, 3, v0
  v_lshlrev_b32 v2, 2, v2
  s_lshl_b32 s33, s24, 7
  s_lshl_b32 s34, s25, 3
  s_add_u32 s33, s33, s34
  s_lshl_b32 s34, s26, 1
  s_add_u32 s33, s33, s34
  s_lshl_b32 s33, s33, 2
  s_add_u32 s33, s33, 22020096
  s_mov_b32 exec_lo, 0x101
  s_mov_b32 exec_hi, 0
  buffer_store_dword v1, v2, s[4:7], s33 offen sc1
  s_mov_b64 exec, -1
  s_branch k1_end
k1_compute:
  s_and_b32 s27, s26, 1
  s_lshr_b32 s28, s26, 1
  v_and_b32 v1, 31, v0
  v_lshrrev_b32 v2, 5, v0
  v_lshrrev_b32 v3, 1, v1
  v_and_b32 v3, 7, v3
  v_xor_b32 v3, v3, v2
  v_lshlrev_b32 v3, 4, v3
  s_lshl_b32 s33, s27, 6
  v_add_u32 v4, s33, v1
  v_lshlrev_b32 v4, 7, v4
  v_add_u32 v106, v3, v4
  v_xor_b32 v107, 32, v106
  v_xor_b32 v108, 64, v106
  v_xor_b32 v109, 0x60, v106
  v_lshrrev_b32 v1, 4, v0
  v_and_b32 v1, 1, v1
  v_lshlrev_b32 v1, 2, v1
  v_and_b32 v2, 3, v0
  v_add_u32 v1, v1, v2
  v_lshrrev_b32 v2, 2, v0
  v_and_b32 v2, 3, v2
  v_lshrrev_b32 v3, 5, v0
  v_lshlrev_b32 v4, 3, v3
  v_add_u32 v4, v4, v2
  v_lshlrev_b32 v4, 8, v4
  v_add_u32 v4, 16384, v4
  s_cmp_eq_u32 s36, 1
  s_cbranch_scc1 k1_vaddr
  s_mul_i32 s37, s25, 3
  s_and_b32 s33, s25, 1
  s_lshl_b32 s33, s33, 3
  v_lshrrev_b32 v5, 2, v1
  v_mul_u32_u24 v5, 40, v5
  v_and_b32 v6, 1, v1
  v_lshlrev_b32 v6, 4, v6
  v_add_u32 v5, v5, v6
  v_lshrrev_b32 v6, 1, v1
  v_and_b32 v6, 1, v6
  v_lshlrev_b32 v6, 3, v6
  v_add_u32 v5, v5, v6
  v_add_u32 v5, s33, v5
  s_mul_i32 s34, s28, 144
  v_add_u32 v110, s34, v5
  v_add_u32 v111, 72, v110
  v_min_u32 v6, 2, v1
  v_mul_u32_u24 v6, 72, v6
  v_add_u32 v6, 32, v6
  v_add_u32 v6, s33, v6
  s_cmp_eq_u32 s28, 1
  s_cbranch_scc0 k1_swz
  v_mov_b32 v111, v6
  s_branch k1_swz
k1_vaddr:
  v_lshlrev_b32 v5, 3, v1
  s_lshl_b32 s34, s28, 7
  v_add_u32 v110, s34, v5
  v_add_u32 v111, 64, v110
k1_swz:
  v_lshlrev_b32 v2, 6, v2
  v_xor_b32 v110, v110, v2
  v_add_u32 v110, v110, v4
  v_xor_b32 v111, v111, v2
  v_add_u32 v111, v111, v4
  v_add_u32 v112, 0x10000, v106
  v_add_u32 v113, 0x10000, v107
  v_add_u32 v114, 0x10000, v108
  v_add_u32 v115, 0x10000, v109
  v_add_u32 v116, 0x10000, v110
  v_add_u32 v117, 0x10000, v111
  v_add_u32 v118, 0x20000, v106
  v_add_u32 v119, 0x20000, v107
  v_add_u32 v120, 0x20000, v108
  v_add_u32 v121, 0x20000, v109
  v_add_u32 v122, 0x20000, v110
  v_add_u32 v123, 0x20000, v111
  s_barrier
  ds_read_b128 v[74:77], v106 offset:0
  ds_read_b128 v[78:81], v106 offset:4096
  ds_read_b64_tr_b16 v[90:91], v110 offset:0
  ds_read_b64_tr_b16 v[92:93], v110 offset:1024
  ds_read_b64_tr_b16 v[94:95], v111 offset:0
  ds_read_b64_tr_b16 v[96:97], v111 offset:1024
  s_cmp_eq_u32 s36, 1
  s_cbranch_scc1 k1_vmain
  s_waitcnt lgkmcnt(0)
  v_mfma_f32_32x32x16_bf16 v[10:25], v[90:93], v[74:77], 0
  ds_read_b128 v[82:85], v107 offset:0
  ds_read_b128 v[86:89], v107 offset:4096
  v_mfma_f32_32x32x16_bf16 v[26:41], v[94:97], v[74:77], 0
  ds_read_b64_tr_b16 v[98:99], v110 offset:4096
  ds_read_b64_tr_b16 v[100:101], v110 offset:5120
  v_mfma_f32_32x32x16_bf16 v[42:57], v[90:93], v[78:81], 0
  ds_read_b64_tr_b16 v[102:103], v111 offset:4096
  ds_read_b64_tr_b16 v[104:105], v111 offset:5120
  v_mfma_f32_32x32x16_bf16 v[58:73], v[94:97], v[78:81], 0
  s_waitcnt lgkmcnt(0)
  v_mfma_f32_32x32x16_bf16 v[10:25], v[98:101], v[82:85], v[10:25]
  ds_read_b128 v[74:77], v108 offset:0
  ds_read_b128 v[78:81], v108 offset:4096
  v_mfma_f32_32x32x16_bf16 v[26:41], v[102:105], v[82:85], v[26:41]
  ds_read_b64_tr_b16 v[90:91], v110 offset:8192
  ds_read_b64_tr_b16 v[92:93], v110 offset:9216
  v_mfma_f32_32x32x16_bf16 v[42:57], v[98:101], v[86:89], v[42:57]
  ds_read_b64_tr_b16 v[94:95], v111 offset:8192
  ds_read_b64_tr_b16 v[96:97], v111 offset:9216
  v_mfma_f32_32x32x16_bf16 v[58:73], v[102:105], v[86:89], v[58:73]
  s_waitcnt lgkmcnt(0)
  v_mfma_f32_32x32x16_bf16 v[10:25], v[90:93], v[74:77], v[10:25]
  ds_read_b128 v[82:85], v109 offset:0
  ds_read_b128 v[86:89], v109 offset:4096
  v_mfma_f32_32x32x16_bf16 v[26:41], v[94:97], v[74:77], v[26:41]
  ds_read_b64_tr_b16 v[98:99], v110 offset:12288
  ds_read_b64_tr_b16 v[100:101], v110 offset:13312
  v_mfma_f32_32x32x16_bf16 v[42:57], v[90:93], v[78:81], v[42:57]
  ds_read_b64_tr_b16 v[102:103], v111 offset:12288
  ds_read_b64_tr_b16 v[104:105], v111 offset:13312
  v_mfma_f32_32x32x16_bf16 v[58:73], v[94:97], v[78:81], v[58:73]
  s_waitcnt lgkmcnt(0)
  s_barrier
  v_mfma_f32_32x32x16_bf16 v[10:25], v[98:101], v[82:85], v[10:25]
  ds_read_b128 v[74:77], v106 offset:32768
  ds_read_b128 v[78:81], v106 offset:36864
  v_mfma_f32_32x32x16_bf16 v[26:41], v[102:105], v[82:85], v[26:41]
  ds_read_b64_tr_b16 v[90:91], v110 offset:32768
  ds_read_b64_tr_b16 v[92:93], v110 offset:33792
  v_mfma_f32_32x32x16_bf16 v[42:57], v[98:101], v[86:89], v[42:57]
  ds_read_b64_tr_b16 v[94:95], v111 offset:32768
  ds_read_b64_tr_b16 v[96:97], v111 offset:33792
  v_mfma_f32_32x32x16_bf16 v[58:73], v[102:105], v[86:89], v[58:73]
  s_waitcnt lgkmcnt(0)
  v_mfma_f32_32x32x16_bf16 v[10:25], v[90:93], v[74:77], v[10:25]
  ds_read_b128 v[82:85], v107 offset:32768
  ds_read_b128 v[86:89], v107 offset:36864
  v_mfma_f32_32x32x16_bf16 v[26:41], v[94:97], v[74:77], v[26:41]
  ds_read_b64_tr_b16 v[98:99], v110 offset:36864
  ds_read_b64_tr_b16 v[100:101], v110 offset:37888
  v_mfma_f32_32x32x16_bf16 v[42:57], v[90:93], v[78:81], v[42:57]
  ds_read_b64_tr_b16 v[102:103], v111 offset:36864
  ds_read_b64_tr_b16 v[104:105], v111 offset:37888
  v_mfma_f32_32x32x16_bf16 v[58:73], v[94:97], v[78:81], v[58:73]
  s_waitcnt lgkmcnt(0)
  v_mfma_f32_32x32x16_bf16 v[10:25], v[98:101], v[82:85], v[10:25]
  ds_read_b128 v[74:77], v108 offset:32768
  ds_read_b128 v[78:81], v108 offset:36864
  v_mfma_f32_32x32x16_bf16 v[26:41], v[102:105], v[82:85], v[26:41]
  ds_read_b64_tr_b16 v[90:91], v110 offset:40960
  ds_read_b64_tr_b16 v[92:93], v110 offset:41984
  v_mfma_f32_32x32x16_bf16 v[42:57], v[98:101], v[86:89], v[42:57]
  ds_read_b64_tr_b16 v[94:95], v111 offset:40960
  ds_read_b64_tr_b16 v[96:97], v111 offset:41984
  v_mfma_f32_32x32x16_bf16 v[58:73], v[102:105], v[86:89], v[58:73]
  s_waitcnt lgkmcnt(0)
  v_mfma_f32_32x32x16_bf16 v[10:25], v[90:93], v[74:77], v[10:25]
  ds_read_b128 v[82:85], v109 offset:32768
  ds_read_b128 v[86:89], v109 offset:36864
  v_mfma_f32_32x32x16_bf16 v[26:41], v[94:97], v[74:77], v[26:41]
  ds_read_b64_tr_b16 v[98:99], v110 offset:45056
  ds_read_b64_tr_b16 v[100:101], v110 offset:46080
  v_mfma_f32_32x32x16_bf16 v[42:57], v[90:93], v[78:81], v[42:57]
  ds_read_b64_tr_b16 v[102:103], v111 offset:45056
  ds_read_b64_tr_b16 v[104:105], v111 offset:46080
  v_mfma_f32_32x32x16_bf16 v[58:73], v[94:97], v[78:81], v[58:73]
  s_waitcnt lgkmcnt(0)
  s_barrier
  v_mfma_f32_32x32x16_bf16 v[10:25], v[98:101], v[82:85], v[10:25]
  ds_read_b128 v[74:77], v112 offset:0
  ds_read_b128 v[78:81], v112 offset:4096
  v_mfma_f32_32x32x16_bf16 v[26:41], v[102:105], v[82:85], v[26:41]
  ds_read_b64_tr_b16 v[90:91], v116 offset:0
  ds_read_b64_tr_b16 v[92:93], v116 offset:1024
  v_mfma_f32_32x32x16_bf16 v[42:57], v[98:101], v[86:89], v[42:57]
  ds_read_b64_tr_b16 v[94:95], v117 offset:0
  ds_read_b64_tr_b16 v[96:97], v117 offset:1024
  v_mfma_f32_32x32x16_bf16 v[58:73], v[102:105], v[86:89], v[58:73]
  s_waitcnt lgkmcnt(0)
  v_mfma_f32_32x32x16_bf16 v[10:25], v[90:93], v[74:77], v[10:25]
  ds_read_b128 v[82:85], v113 offset:0
  ds_read_b128 v[86:89], v113 offset:4096
  v_mfma_f32_32x32x16_bf16 v[26:41], v[94:97], v[74:77], v[26:41]
  ds_read_b64_tr_b16 v[98:99], v116 offset:4096
  ds_read_b64_tr_b16 v[100:101], v116 offset:5120
  v_mfma_f32_32x32x16_bf16 v[42:57], v[90:93], v[78:81], v[42:57]
  ds_read_b64_tr_b16 v[102:103], v117 offset:4096
  ds_read_b64_tr_b16 v[104:105], v117 offset:5120
  v_mfma_f32_32x32x16_bf16 v[58:73], v[94:97], v[78:81], v[58:73]
  s_waitcnt lgkmcnt(0)
  v_mfma_f32_32x32x16_bf16 v[10:25], v[98:101], v[82:85], v[10:25]
  ds_read_b128 v[74:77], v114 offset:0
  ds_read_b128 v[78:81], v114 offset:4096
  v_mfma_f32_32x32x16_bf16 v[26:41], v[102:105], v[82:85], v[26:41]
  ds_read_b64_tr_b16 v[90:91], v116 offset:8192
  ds_read_b64_tr_b16 v[92:93], v116 offset:9216
  v_mfma_f32_32x32x16_bf16 v[42:57], v[98:101], v[86:89], v[42:57]
  ds_read_b64_tr_b16 v[94:95], v117 offset:8192
  ds_read_b64_tr_b16 v[96:97], v117 offset:9216
  v_mfma_f32_32x32x16_bf16 v[58:73], v[102:105], v[86:89], v[58:73]
  s_waitcnt lgkmcnt(0)
  v_mfma_f32_32x32x16_bf16 v[10:25], v[90:93], v[74:77], v[10:25]
  ds_read_b128 v[82:85], v115 offset:0
  ds_read_b128 v[86:89], v115 offset:4096
  v_mfma_f32_32x32x16_bf16 v[26:41], v[94:97], v[74:77], v[26:41]
  ds_read_b64_tr_b16 v[98:99], v116 offset:12288
  ds_read_b64_tr_b16 v[100:101], v116 offset:13312
  v_mfma_f32_32x32x16_bf16 v[42:57], v[90:93], v[78:81], v[42:57]
  ds_read_b64_tr_b16 v[102:103], v117 offset:12288
  ds_read_b64_tr_b16 v[104:105], v117 offset:13312
  v_mfma_f32_32x32x16_bf16 v[58:73], v[94:97], v[78:81], v[58:73]
  s_waitcnt lgkmcnt(0)
  s_barrier
  v_mfma_f32_32x32x16_bf16 v[10:25], v[98:101], v[82:85], v[10:25]
  ds_read_b128 v[74:77], v112 offset:32768
  ds_read_b128 v[78:81], v112 offset:36864
  v_mfma_f32_32x32x16_bf16 v[26:41], v[102:105], v[82:85], v[26:41]
  ds_read_b64_tr_b16 v[90:91], v116 offset:32768
  ds_read_b64_tr_b16 v[92:93], v116 offset:33792
  v_mfma_f32_32x32x16_bf16 v[42:57], v[98:101], v[86:89], v[42:57]
  ds_read_b64_tr_b16 v[94:95], v117 offset:32768
  ds_read_b64_tr_b16 v[96:97], v117 offset:33792
  v_mfma_f32_32x32x16_bf16 v[58:73], v[102:105], v[86:89], v[58:73]
  s_waitcnt lgkmcnt(0)
  v_mfma_f32_32x32x16_bf16 v[10:25], v[90:93], v[74:77], v[10:25]
  ds_read_b128 v[82:85], v113 offset:32768
  ds_read_b128 v[86:89], v113 offset:36864
  v_mfma_f32_32x32x16_bf16 v[26:41], v[94:97], v[74:77], v[26:41]
  ds_read_b64_tr_b16 v[98:99], v116 offset:36864
  ds_read_b64_tr_b16 v[100:101], v116 offset:37888
  v_mfma_f32_32x32x16_bf16 v[42:57], v[90:93], v[78:81], v[42:57]
  ds_read_b64_tr_b16 v[102:103], v117 offset:36864
  ds_read_b64_tr_b16 v[104:105], v117 offset:37888
  v_mfma_f32_32x32x16_bf16 v[58:73], v[94:97], v[78:81], v[58:73]
  s_waitcnt lgkmcnt(0)
  v_mfma_f32_32x32x16_bf16 v[10:25], v[98:101], v[82:85], v[10:25]
  ds_read_b128 v[74:77], v114 offset:32768
  ds_read_b128 v[78:81], v114 offset:36864
  v_mfma_f32_32x32x16_bf16 v[26:41], v[102:105], v[82:85], v[26:41]
  ds_read_b64_tr_b16 v[90:91], v116 offset:40960
  ds_read_b64_tr_b16 v[92:93], v116 offset:41984
  v_mfma_f32_32x32x16_bf16 v[42:57], v[98:101], v[86:89], v[42:57]
  ds_read_b64_tr_b16 v[94:95], v117 offset:40960
  ds_read_b64_tr_b16 v[96:97], v117 offset:41984
  v_mfma_f32_32x32x16_bf16 v[58:73], v[102:105], v[86:89], v[58:73]
  s_waitcnt lgkmcnt(0)
  v_mfma_f32_32x32x16_bf16 v[10:25], v[90:93], v[74:77], v[10:25]
  ds_read_b128 v[82:85], v115 offset:32768
  ds_read_b128 v[86:89], v115 offset:36864
  v_mfma_f32_32x32x16_bf16 v[26:41], v[94:97], v[74:77], v[26:41]
  ds_read_b64_tr_b16 v[98:99], v116 offset:45056
  ds_read_b64_tr_b16 v[100:101], v116 offset:46080
  v_mfma_f32_32x32x16_bf16 v[42:57], v[90:93], v[78:81], v[42:57]
  ds_read_b64_tr_b16 v[102:103], v117 offset:45056
  ds_read_b64_tr_b16 v[104:105], v117 offset:46080
  v_mfma_f32_32x32x16_bf16 v[58:73], v[94:97], v[78:81], v[58:73]
  s_waitcnt lgkmcnt(0)
  s_barrier
  v_mfma_f32_32x32x16_bf16 v[10:25], v[98:101], v[82:85], v[10:25]
  ds_read_b128 v[74:77], v118 offset:0
  ds_read_b128 v[78:81], v118 offset:4096
  v_mfma_f32_32x32x16_bf16 v[26:41], v[102:105], v[82:85], v[26:41]
  ds_read_b64_tr_b16 v[90:91], v122 offset:0
  ds_read_b64_tr_b16 v[92:93], v122 offset:1024
  v_mfma_f32_32x32x16_bf16 v[42:57], v[98:101], v[86:89], v[42:57]
  ds_read_b64_tr_b16 v[94:95], v123 offset:0
  ds_read_b64_tr_b16 v[96:97], v123 offset:1024
  v_mfma_f32_32x32x16_bf16 v[58:73], v[102:105], v[86:89], v[58:73]
  s_waitcnt lgkmcnt(0)
  v_mfma_f32_32x32x16_bf16 v[10:25], v[90:93], v[74:77], v[10:25]
  ds_read_b128 v[82:85], v119 offset:0
  ds_read_b128 v[86:89], v119 offset:4096
  v_mfma_f32_32x32x16_bf16 v[26:41], v[94:97], v[74:77], v[26:41]
  ds_read_b64_tr_b16 v[98:99], v122 offset:4096
  ds_read_b64_tr_b16 v[100:101], v122 offset:5120
  v_mfma_f32_32x32x16_bf16 v[42:57], v[90:93], v[78:81], v[42:57]
  ds_read_b64_tr_b16 v[102:103], v123 offset:4096
  ds_read_b64_tr_b16 v[104:105], v123 offset:5120
  v_mfma_f32_32x32x16_bf16 v[58:73], v[94:97], v[78:81], v[58:73]
  s_waitcnt lgkmcnt(0)
  v_mfma_f32_32x32x16_bf16 v[10:25], v[98:101], v[82:85], v[10:25]
  ds_read_b128 v[74:77], v120 offset:0
  ds_read_b128 v[78:81], v120 offset:4096
  v_mfma_f32_32x32x16_bf16 v[26:41], v[102:105], v[82:85], v[26:41]
  ds_read_b64_tr_b16 v[90:91], v122 offset:8192
  ds_read_b64_tr_b16 v[92:93], v122 offset:9216
  v_mfma_f32_32x32x16_bf16 v[42:57], v[98:101], v[86:89], v[42:57]
  ds_read_b64_tr_b16 v[94:95], v123 offset:8192
  ds_read_b64_tr_b16 v[96:97], v123 offset:9216
  v_mfma_f32_32x32x16_bf16 v[58:73], v[102:105], v[86:89], v[58:73]
  s_waitcnt lgkmcnt(0)
  v_mfma_f32_32x32x16_bf16 v[10:25], v[90:93], v[74:77], v[10:25]
  ds_read_b128 v[82:85], v121 offset:0
  ds_read_b128 v[86:89], v121 offset:4096
  v_mfma_f32_32x32x16_bf16 v[26:41], v[94:97], v[74:77], v[26:41]
  ds_read_b64_tr_b16 v[98:99], v122 offset:12288
  ds_read_b64_tr_b16 v[100:101], v122 offset:13312
  v_mfma_f32_32x32x16_bf16 v[42:57], v[90:93], v[78:81], v[42:57]
  ds_read_b64_tr_b16 v[102:103], v123 offset:12288
  ds_read_b64_tr_b16 v[104:105], v123 offset:13312
  v_mfma_f32_32x32x16_bf16 v[58:73], v[94:97], v[78:81], v[58:73]
  s_waitcnt lgkmcnt(0)
  s_barrier
  v_mfma_f32_32x32x16_bf16 v[10:25], v[98:101], v[82:85], v[10:25]
  ds_read_b128 v[74:77], v106 offset:0
  ds_read_b128 v[78:81], v106 offset:4096
  v_mfma_f32_32x32x16_bf16 v[26:41], v[102:105], v[82:85], v[26:41]
  ds_read_b64_tr_b16 v[90:91], v110 offset:0
  ds_read_b64_tr_b16 v[92:93], v110 offset:1024
  v_mfma_f32_32x32x16_bf16 v[42:57], v[98:101], v[86:89], v[42:57]
  ds_read_b64_tr_b16 v[94:95], v111 offset:0
  ds_read_b64_tr_b16 v[96:97], v111 offset:1024
  v_mfma_f32_32x32x16_bf16 v[58:73], v[102:105], v[86:89], v[58:73]
  s_waitcnt lgkmcnt(0)
  v_mfma_f32_32x32x16_bf16 v[10:25], v[90:93], v[74:77], v[10:25]
  ds_read_b128 v[82:85], v107 offset:0
  ds_read_b128 v[86:89], v107 offset:4096
  v_mfma_f32_32x32x16_bf16 v[26:41], v[94:97], v[74:77], v[26:41]
  ds_read_b64_tr_b16 v[98:99], v110 offset:4096
  ds_read_b64_tr_b16 v[100:101], v110 offset:5120
  v_mfma_f32_32x32x16_bf16 v[42:57], v[90:93], v[78:81], v[42:57]
  ds_read_b64_tr_b16 v[102:103], v111 offset:4096
  ds_read_b64_tr_b16 v[104:105], v111 offset:5120
  v_mfma_f32_32x32x16_bf16 v[58:73], v[94:97], v[78:81], v[58:73]
  s_waitcnt lgkmcnt(0)
  v_mfma_f32_32x32x16_bf16 v[10:25], v[98:101], v[82:85], v[10:25]
  ds_read_b128 v[74:77], v108 offset:0
  ds_read_b128 v[78:81], v108 offset:4096
  v_mfma_f32_32x32x16_bf16 v[26:41], v[102:105], v[82:85], v[26:41]
  ds_read_b64_tr_b16 v[90:91], v110 offset:8192
  ds_read_b64_tr_b16 v[92:93], v110 offset:9216
  v_mfma_f32_32x32x16_bf16 v[42:57], v[98:101], v[86:89], v[42:57]
  ds_read_b64_tr_b16 v[94:95], v111 offset:8192
  ds_read_b64_tr_b16 v[96:97], v111 offset:9216
  v_mfma_f32_32x32x16_bf16 v[58:73], v[102:105], v[86:89], v[58:73]
  s_waitcnt lgkmcnt(0)
  v_mfma_f32_32x32x16_bf16 v[10:25], v[90:93], v[74:77], v[10:25]
  ds_read_b128 v[82:85], v109 offset:0
  ds_read_b128 v[86:89], v109 offset:4096
  v_mfma_f32_32x32x16_bf16 v[26:41], v[94:97], v[74:77], v[26:41]
  ds_read_b64_tr_b16 v[98:99], v110 offset:12288
  ds_read_b64_tr_b16 v[100:101], v110 offset:13312
  v_mfma_f32_32x32x16_bf16 v[42:57], v[90:93], v[78:81], v[42:57]
  ds_read_b64_tr_b16 v[102:103], v111 offset:12288
  ds_read_b64_tr_b16 v[104:105], v111 offset:13312
  v_mfma_f32_32x32x16_bf16 v[58:73], v[94:97], v[78:81], v[58:73]
  s_waitcnt lgkmcnt(0)
  s_barrier
  v_mfma_f32_32x32x16_bf16 v[10:25], v[98:101], v[82:85], v[10:25]
  ds_read_b128 v[74:77], v106 offset:32768
  ds_read_b128 v[78:81], v106 offset:36864
  v_mfma_f32_32x32x16_bf16 v[26:41], v[102:105], v[82:85], v[26:41]
  ds_read_b64_tr_b16 v[90:91], v110 offset:32768
  ds_read_b64_tr_b16 v[92:93], v110 offset:33792
  v_mfma_f32_32x32x16_bf16 v[42:57], v[98:101], v[86:89], v[42:57]
  ds_read_b64_tr_b16 v[94:95], v111 offset:32768
  ds_read_b64_tr_b16 v[96:97], v111 offset:33792
  v_mfma_f32_32x32x16_bf16 v[58:73], v[102:105], v[86:89], v[58:73]
  s_waitcnt lgkmcnt(0)
  v_mfma_f32_32x32x16_bf16 v[10:25], v[90:93], v[74:77], v[10:25]
  ds_read_b128 v[82:85], v107 offset:32768
  ds_read_b128 v[86:89], v107 offset:36864
  v_mfma_f32_32x32x16_bf16 v[26:41], v[94:97], v[74:77], v[26:41]
  ds_read_b64_tr_b16 v[98:99], v110 offset:36864
  ds_read_b64_tr_b16 v[100:101], v110 offset:37888
  v_mfma_f32_32x32x16_bf16 v[42:57], v[90:93], v[78:81], v[42:57]
  ds_read_b64_tr_b16 v[102:103], v111 offset:36864
  ds_read_b64_tr_b16 v[104:105], v111 offset:37888
  v_mfma_f32_32x32x16_bf16 v[58:73], v[94:97], v[78:81], v[58:73]
  s_waitcnt lgkmcnt(0)
  v_mfma_f32_32x32x16_bf16 v[10:25], v[98:101], v[82:85], v[10:25]
  ds_read_b128 v[74:77], v108 offset:32768
  ds_read_b128 v[78:81], v108 offset:36864
  v_mfma_f32_32x32x16_bf16 v[26:41], v[102:105], v[82:85], v[26:41]
  ds_read_b64_tr_b16 v[90:91], v110 offset:40960
  ds_read_b64_tr_b16 v[92:93], v110 offset:41984
  v_mfma_f32_32x32x16_bf16 v[42:57], v[98:101], v[86:89], v[42:57]
  ds_read_b64_tr_b16 v[94:95], v111 offset:40960
  ds_read_b64_tr_b16 v[96:97], v111 offset:41984
  v_mfma_f32_32x32x16_bf16 v[58:73], v[102:105], v[86:89], v[58:73]
  s_waitcnt lgkmcnt(0)
  v_mfma_f32_32x32x16_bf16 v[10:25], v[90:93], v[74:77], v[10:25]
  ds_read_b128 v[82:85], v109 offset:32768
  ds_read_b128 v[86:89], v109 offset:36864
  v_mfma_f32_32x32x16_bf16 v[26:41], v[94:97], v[74:77], v[26:41]
  ds_read_b64_tr_b16 v[98:99], v110 offset:45056
  ds_read_b64_tr_b16 v[100:101], v110 offset:46080
  v_mfma_f32_32x32x16_bf16 v[42:57], v[90:93], v[78:81], v[42:57]
  ds_read_b64_tr_b16 v[102:103], v111 offset:45056
  ds_read_b64_tr_b16 v[104:105], v111 offset:46080
  v_mfma_f32_32x32x16_bf16 v[58:73], v[94:97], v[78:81], v[58:73]
  s_waitcnt lgkmcnt(0)
  s_barrier
  v_mfma_f32_32x32x16_bf16 v[10:25], v[98:101], v[82:85], v[10:25]
  ds_read_b128 v[74:77], v112 offset:0
  ds_read_b128 v[78:81], v112 offset:4096
  v_mfma_f32_32x32x16_bf16 v[26:41], v[102:105], v[82:85], v[26:41]
  ds_read_b64_tr_b16 v[90:91], v116 offset:0
  ds_read_b64_tr_b16 v[92:93], v116 offset:1024
  v_mfma_f32_32x32x16_bf16 v[42:57], v[98:101], v[86:89], v[42:57]
  ds_read_b64_tr_b16 v[94:95], v117 offset:0
  ds_read_b64_tr_b16 v[96:97], v117 offset:1024
  v_mfma_f32_32x32x16_bf16 v[58:73], v[102:105], v[86:89], v[58:73]
  s_waitcnt lgkmcnt(0)
  v_mfma_f32_32x32x16_bf16 v[10:25], v[90:93], v[74:77], v[10:25]
  ds_read_b128 v[82:85], v113 offset:0
  ds_read_b128 v[86:89], v113 offset:4096
  v_mfma_f32_32x32x16_bf16 v[26:41], v[94:97], v[74:77], v[26:41]
  ds_read_b64_tr_b16 v[98:99], v116 offset:4096
  ds_read_b64_tr_b16 v[100:101], v116 offset:5120
  v_mfma_f32_32x32x16_bf16 v[42:57], v[90:93], v[78:81], v[42:57]
  ds_read_b64_tr_b16 v[102:103], v117 offset:4096
  ds_read_b64_tr_b16 v[104:105], v117 offset:5120
  v_mfma_f32_32x32x16_bf16 v[58:73], v[94:97], v[78:81], v[58:73]
  s_waitcnt lgkmcnt(0)
  v_mfma_f32_32x32x16_bf16 v[10:25], v[98:101], v[82:85], v[10:25]
  ds_read_b128 v[74:77], v114 offset:0
  ds_read_b128 v[78:81], v114 offset:4096
  v_mfma_f32_32x32x16_bf16 v[26:41], v[102:105], v[82:85], v[26:41]
  ds_read_b64_tr_b16 v[90:91], v116 offset:8192
  ds_read_b64_tr_b16 v[92:93], v116 offset:9216
  v_mfma_f32_32x32x16_bf16 v[42:57], v[98:101], v[86:89], v[42:57]
  ds_read_b64_tr_b16 v[94:95], v117 offset:8192
  ds_read_b64_tr_b16 v[96:97], v117 offset:9216
  v_mfma_f32_32x32x16_bf16 v[58:73], v[102:105], v[86:89], v[58:73]
  s_waitcnt lgkmcnt(0)
  v_mfma_f32_32x32x16_bf16 v[10:25], v[90:93], v[74:77], v[10:25]
  ds_read_b128 v[82:85], v115 offset:0
  ds_read_b128 v[86:89], v115 offset:4096
  v_mfma_f32_32x32x16_bf16 v[26:41], v[94:97], v[74:77], v[26:41]
  ds_read_b64_tr_b16 v[98:99], v116 offset:12288
  ds_read_b64_tr_b16 v[100:101], v116 offset:13312
  v_mfma_f32_32x32x16_bf16 v[42:57], v[90:93], v[78:81], v[42:57]
  ds_read_b64_tr_b16 v[102:103], v117 offset:12288
  ds_read_b64_tr_b16 v[104:105], v117 offset:13312
  v_mfma_f32_32x32x16_bf16 v[58:73], v[94:97], v[78:81], v[58:73]
  s_waitcnt lgkmcnt(0)
  s_barrier
  v_mfma_f32_32x32x16_bf16 v[10:25], v[98:101], v[82:85], v[10:25]
  ds_read_b128 v[74:77], v112 offset:32768
  ds_read_b128 v[78:81], v112 offset:36864
  v_mfma_f32_32x32x16_bf16 v[26:41], v[102:105], v[82:85], v[26:41]
  ds_read_b64_tr_b16 v[90:91], v116 offset:32768
  ds_read_b64_tr_b16 v[92:93], v116 offset:33792
  v_mfma_f32_32x32x16_bf16 v[42:57], v[98:101], v[86:89], v[42:57]
  ds_read_b64_tr_b16 v[94:95], v117 offset:32768
  ds_read_b64_tr_b16 v[96:97], v117 offset:33792
  v_mfma_f32_32x32x16_bf16 v[58:73], v[102:105], v[86:89], v[58:73]
  s_waitcnt lgkmcnt(0)
  v_mfma_f32_32x32x16_bf16 v[10:25], v[90:93], v[74:77], v[10:25]
  ds_read_b128 v[82:85], v113 offset:32768
  ds_read_b128 v[86:89], v113 offset:36864
  v_mfma_f32_32x32x16_bf16 v[26:41], v[94:97], v[74:77], v[26:41]
  ds_read_b64_tr_b16 v[98:99], v116 offset:36864
  ds_read_b64_tr_b16 v[100:101], v116 offset:37888
  v_mfma_f32_32x32x16_bf16 v[42:57], v[90:93], v[78:81], v[42:57]
  ds_read_b64_tr_b16 v[102:103], v117 offset:36864
  ds_read_b64_tr_b16 v[104:105], v117 offset:37888
  v_mfma_f32_32x32x16_bf16 v[58:73], v[94:97], v[78:81], v[58:73]
  s_waitcnt lgkmcnt(0)
  v_mfma_f32_32x32x16_bf16 v[10:25], v[98:101], v[82:85], v[10:25]
  ds_read_b128 v[74:77], v114 offset:32768
  ds_read_b128 v[78:81], v114 offset:36864
  v_mfma_f32_32x32x16_bf16 v[26:41], v[102:105], v[82:85], v[26:41]
  ds_read_b64_tr_b16 v[90:91], v116 offset:40960
  ds_read_b64_tr_b16 v[92:93], v116 offset:41984
  v_mfma_f32_32x32x16_bf16 v[42:57], v[98:101], v[86:89], v[42:57]
  ds_read_b64_tr_b16 v[94:95], v117 offset:40960
  ds_read_b64_tr_b16 v[96:97], v117 offset:41984
  v_mfma_f32_32x32x16_bf16 v[58:73], v[102:105], v[86:89], v[58:73]
  s_waitcnt lgkmcnt(0)
  v_mfma_f32_32x32x16_bf16 v[10:25], v[90:93], v[74:77], v[10:25]
  ds_read_b128 v[82:85], v115 offset:32768
  ds_read_b128 v[86:89], v115 offset:36864
  v_mfma_f32_32x32x16_bf16 v[26:41], v[94:97], v[74:77], v[26:41]
  ds_read_b64_tr_b16 v[98:99], v116 offset:45056
  ds_read_b64_tr_b16 v[100:101], v116 offset:46080
  v_mfma_f32_32x32x16_bf16 v[42:57], v[90:93], v[78:81], v[42:57]
  ds_read_b64_tr_b16 v[102:103], v117 offset:45056
  ds_read_b64_tr_b16 v[104:105], v117 offset:46080
  v_mfma_f32_32x32x16_bf16 v[58:73], v[94:97], v[78:81], v[58:73]
  s_waitcnt lgkmcnt(0)
  v_mfma_f32_32x32x16_bf16 v[10:25], v[98:101], v[82:85], v[10:25]
  v_mfma_f32_32x32x16_bf16 v[26:41], v[102:105], v[82:85], v[26:41]
  v_mfma_f32_32x32x16_bf16 v[42:57], v[98:101], v[86:89], v[42:57]
  v_mfma_f32_32x32x16_bf16 v[58:73], v[102:105], v[86:89], v[58:73]
  v_lshlrev_b32 v1, 4, v0
  s_lshl_b32 s38, s28, 1
  s_add_u32 s38, s38, s37
  s_add_u32 s39, s38, 1
  s_cmp_ge_u32 s38, 32
  s_cbranch_scc1 k1_skip_5
  s_and_b32 s33, s38, 15
  s_lshl_b32 s33, s33, 17
  s_lshl_b32 s34, s24, 2
  s_lshl_b32 s35, s27, 1
  s_add_u32 s34, s34, s35
  s_add_u32 s34, s34, 0
  s_lshl_b32 s34, s34, 10
  s_add_u32 s33, s33, s34
  s_add_u32 s34, s33, 5242880
  s_add_u32 s33, s33, 0
  s_cmp_lt_u32 s38, 16
  s_cselect_b32 s33, s34, s33
  s_cselect_b32 s35, 0x3eae1a93, 1.0
  s_add_u32 s34, s33, 65536
  v_mul_f32 v10, s35, v10
  v_mul_f32 v11, s35, v11
  v_mul_f32 v12, s35, v12
  v_mul_f32 v13, s35, v13
  v_mul_f32 v14, s35, v14
  v_mul_f32 v15, s35, v15
  v_mul_f32 v16, s35, v16
  v_mul_f32 v17, s35, v17
  v_mul_f32 v18, s35, v18
  v_mul_f32 v19, s35, v19
  v_mul_f32 v20, s35, v20
  v_mul_f32 v21, s35, v21
  v_mul_f32 v22, s35, v22
  v_mul_f32 v23, s35, v23
  v_mul_f32 v24, s35, v24
  v_mul_f32 v25, s35, v25
  v_cvt_pk_bf16_f32 v74, v10, v11
  v_cvt_pk_bf16_f32 v75, v12, v13
  v_cvt_pk_bf16_f32 v76, v14, v15
  v_cvt_pk_bf16_f32 v77, v16, v17
  v_cvt_pk_bf16_f32 v78, v18, v19
  v_cvt_pk_bf16_f32 v79, v20, v21
  v_cvt_pk_bf16_f32 v80, v22, v23
  v_cvt_pk_bf16_f32 v81, v24, v25
  buffer_store_dwordx4 v[74:77], v1, s[4:7], s33 offen sc1
  buffer_store_dwordx4 v[78:81], v1, s[4:7], s34 offen sc1
k1_skip_5:
  s_cmp_ge_u32 s38, 32
  s_cbranch_scc1 k1_skip_6
  s_and_b32 s33, s38, 15
  s_lshl_b32 s33, s33, 17
  s_lshl_b32 s34, s24, 2
  s_lshl_b32 s35, s27, 1
  s_add_u32 s34, s34, s35
  s_add_u32 s34, s34, 1
  s_lshl_b32 s34, s34, 10
  s_add_u32 s33, s33, s34
  s_add_u32 s34, s33, 5242880
  s_add_u32 s33, s33, 0
  s_cmp_lt_u32 s38, 16
  s_cselect_b32 s33, s34, s33
  s_cselect_b32 s35, 0x3eae1a93, 1.0
  s_add_u32 s34, s33, 65536
  v_mul_f32 v42, s35, v42
  v_mul_f32 v43, s35, v43
  v_mul_f32 v44, s35, v44
  v_mul_f32 v45, s35, v45
  v_mul_f32 v46, s35, v46
  v_mul_f32 v47, s35, v47
  v_mul_f32 v48, s35, v48
  v_mul_f32 v49, s35, v49
  v_mul_f32 v50, s35, v50
  v_mul_f32 v51, s35, v51
  v_mul_f32 v52, s35, v52
  v_mul_f32 v53, s35, v53
  v_mul_f32 v54, s35, v54
  v_mul_f32 v55, s35, v55
  v_mul_f32 v56, s35, v56
  v_mul_f32 v57, s35, v57
  v_cvt_pk_bf16_f32 v74, v42, v43
  v_cvt_pk_bf16_f32 v75, v44, v45
  v_cvt_pk_bf16_f32 v76, v46, v47
  v_cvt_pk_bf16_f32 v77, v48, v49
  v_cvt_pk_bf16_f32 v78, v50, v51
  v_cvt_pk_bf16_f32 v79, v52, v53
  v_cvt_pk_bf16_f32 v80, v54, v55
  v_cvt_pk_bf16_f32 v81, v56, v57
  buffer_store_dwordx4 v[74:77], v1, s[4:7], s33 offen sc1
  buffer_store_dwordx4 v[78:81], v1, s[4:7], s34 offen sc1
k1_skip_6:
  s_cmp_eq_u32 s28, 1
  s_cbranch_scc1 k1_hi
  s_cmp_ge_u32 s39, 32
  s_cbranch_scc1 k1_skip_7
  s_and_b32 s33, s39, 15
  s_lshl_b32 s33, s33, 17
  s_lshl_b32 s34, s24, 2
  s_lshl_b32 s35, s27, 1
  s_add_u32 s34, s34, s35
  s_add_u32 s34, s34, 0
  s_lshl_b32 s34, s34, 10
  s_add_u32 s33, s33, s34
  s_add_u32 s34, s33, 5242880
  s_add_u32 s33, s33, 0
  s_cmp_lt_u32 s39, 16
  s_cselect_b32 s33, s34, s33
  s_cselect_b32 s35, 0x3eae1a93, 1.0
  s_add_u32 s34, s33, 65536
  v_mul_f32 v26, s35, v26
  v_mul_f32 v27, s35, v27
  v_mul_f32 v28, s35, v28
  v_mul_f32 v29, s35, v29
  v_mul_f32 v30, s35, v30
  v_mul_f32 v31, s35, v31
  v_mul_f32 v32, s35, v32
  v_mul_f32 v33, s35, v33
  v_mul_f32 v34, s35, v34
  v_mul_f32 v35, s35, v35
  v_mul_f32 v36, s35, v36
  v_mul_f32 v37, s35, v37
  v_mul_f32 v38, s35, v38
  v_mul_f32 v39, s35, v39
  v_mul_f32 v40, s35, v40
  v_mul_f32 v41, s35, v41
  v_cvt_pk_bf16_f32 v74, v26, v27
  v_cvt_pk_bf16_f32 v75, v28, v29
  v_cvt_pk_bf16_f32 v76, v30, v31
  v_cvt_pk_bf16_f32 v77, v32, v33
  v_cvt_pk_bf16_f32 v78, v34, v35
  v_cvt_pk_bf16_f32 v79, v36, v37
  v_cvt_pk_bf16_f32 v80, v38, v39
  v_cvt_pk_bf16_f32 v81, v40, v41
  buffer_store_dwordx4 v[74:77], v1, s[4:7], s33 offen sc1
  buffer_store_dwordx4 v[78:81], v1, s[4:7], s34 offen sc1
k1_skip_7:
  s_cmp_ge_u32 s39, 32
  s_cbranch_scc1 k1_skip_8
  s_and_b32 s33, s39, 15
  s_lshl_b32 s33, s33, 17
  s_lshl_b32 s34, s24, 2
  s_lshl_b32 s35, s27, 1
  s_add_u32 s34, s34, s35
  s_add_u32 s34, s34, 1
  s_lshl_b32 s34, s34, 10
  s_add_u32 s33, s33, s34
  s_add_u32 s34, s33, 5242880
  s_add_u32 s33, s33, 0
  s_cmp_lt_u32 s39, 16
  s_cselect_b32 s33, s34, s33
  s_cselect_b32 s35, 0x3eae1a93, 1.0
  s_add_u32 s34, s33, 65536
  v_mul_f32 v58, s35, v58
  v_mul_f32 v59, s35, v59
  v_mul_f32 v60, s35, v60
  v_mul_f32 v61, s35, v61
  v_mul_f32 v62, s35, v62
  v_mul_f32 v63, s35, v63
  v_mul_f32 v64, s35, v64
  v_mul_f32 v65, s35, v65
  v_mul_f32 v66, s35, v66
  v_mul_f32 v67, s35, v67
  v_mul_f32 v68, s35, v68
  v_mul_f32 v69, s35, v69
  v_mul_f32 v70, s35, v70
  v_mul_f32 v71, s35, v71
  v_mul_f32 v72, s35, v72
  v_mul_f32 v73, s35, v73
  v_cvt_pk_bf16_f32 v74, v58, v59
  v_cvt_pk_bf16_f32 v75, v60, v61
  v_cvt_pk_bf16_f32 v76, v62, v63
  v_cvt_pk_bf16_f32 v77, v64, v65
  v_cvt_pk_bf16_f32 v78, v66, v67
  v_cvt_pk_bf16_f32 v79, v68, v69
  v_cvt_pk_bf16_f32 v80, v70, v71
  v_cvt_pk_bf16_f32 v81, v72, v73
  buffer_store_dwordx4 v[74:77], v1, s[4:7], s33 offen sc1
  buffer_store_dwordx4 v[78:81], v1, s[4:7], s34 offen sc1
k1_skip_8:
  s_branch k1_cend
k1_hi:
  v_lshrrev_b32 v2, 5, v0
  v_add_u32 v2, s37, v2
  v_and_b32 v3, 15, v2
  v_lshlrev_b32 v3, 14, v3
  v_and_b32 v5, 31, v0
  v_lshlrev_b32 v5, 2, v5
  v_add_u32 v3, v3, v5
  s_lshl_b32 s34, s24, 9
  s_lshl_b32 s35, s27, 8
  s_add_u32 s34, s34, s35
  v_add_u32 v3, s34, v3
  v_cmp_gt_u32 vcc, 16, v2
  v_mov_b32 v5, 2097152
  v_mov_b32 v6, 7340032
  v_cndmask_b32 v5, v5, v6, vcc
  v_add_u32 v3, v3, v5
  v_mov_b32 v5, 1.0
  v_mov_b32 v6, 0x3eae1a93
  v_cndmask_b32 v4, v5, v6, vcc
  v_cmp_le_u32 vcc, 32, v2
  v_mov_b32 v5, 2146435072
  s_nop 0
  v_cndmask_b32 v3, v3, v5, vcc
  v_mul_f32 v26, v4, v26
  v_mul_f32 v27, v4, v27
  v_mul_f32 v28, v4, v28
  v_mul_f32 v29, v4, v29
  v_cvt_pk_bf16_f32 v74, v26, v27
  v_cvt_pk_bf16_f32 v75, v28, v29
  v_add_u32 v5, 8192, v3
  buffer_store_dword v74, v3, s[4:7], 0 offen offset:0 sc1
  buffer_store_dword v75, v5, s[4:7], 0 offen offset:0 sc1
  v_mul_f32 v58, v4, v58
  v_mul_f32 v59, v4, v59
  v_mul_f32 v60, v4, v60
  v_mul_f32 v61, v4, v61
  v_cvt_pk_bf16_f32 v76, v58, v59
  v_cvt_pk_bf16_f32 v77, v60, v61
  v_add_u32 v5, 8192, v3
  buffer_store_dword v76, v3, s[4:7], 0 offen offset:128 sc1
  buffer_store_dword v77, v5, s[4:7], 0 offen offset:128 sc1
  s_add_u32 s33, s37, 2
  v_mov_b32 v2, s33
  v_and_b32 v3, 15, v2
  v_lshlrev_b32 v3, 14, v3
  v_and_b32 v5, 31, v0
  v_lshlrev_b32 v5, 2, v5
  v_add_u32 v3, v3, v5
  s_lshl_b32 s34, s24, 9
  s_lshl_b32 s35, s27, 8
  s_add_u32 s34, s34, s35
  v_add_u32 v3, s34, v3
  v_cmp_gt_u32 vcc, 16, v2
  v_mov_b32 v5, 2097152
  v_mov_b32 v6, 7340032
  v_cndmask_b32 v5, v5, v6, vcc
  v_add_u32 v3, v3, v5
  v_mov_b32 v5, 1.0
  v_mov_b32 v6, 0x3eae1a93
  v_cndmask_b32 v4, v5, v6, vcc
  v_cmp_le_u32 vcc, 32, v2
  v_mov_b32 v5, 2146435072
  s_nop 0
  v_cndmask_b32 v3, v3, v5, vcc
  v_cmp_le_u32 vcc, 32, v0
  s_nop 1
  v_cndmask_b32 v3, v3, v5, vcc
  v_mul_f32 v30, v4, v30
  v_mul_f32 v31, v4, v31
  v_mul_f32 v32, v4, v32
  v_mul_f32 v33, v4, v33
  v_cvt_pk_bf16_f32 v74, v30, v31
  v_cvt_pk_bf16_f32 v75, v32, v33
  v_add_u32 v5, 8192, v3
  buffer_store_dword v74, v3, s[4:7], 0 offen offset:0 sc1
  buffer_store_dword v75, v5, s[4:7], 0 offen offset:0 sc1
  v_mul_f32 v62, v4, v62
  v_mul_f32 v63, v4, v63
  v_mul_f32 v64, v4, v64
  v_mul_f32 v65, v4, v65
  v_cvt_pk_bf16_f32 v76, v62, v63
  v_cvt_pk_bf16_f32 v77, v64, v65
  v_add_u32 v5, 8192, v3
  buffer_store_dword v76, v3, s[4:7], 0 offen offset:128 sc1
  buffer_store_dword v77, v5, s[4:7], 0 offen offset:128 sc1
  s_branch k1_cend
k1_vmain:
  s_waitcnt lgkmcnt(0)
  v_mfma_f32_32x32x16_bf16 v[10:25], v[74:77], v[90:93], 0
  ds_read_b128 v[82:85], v107 offset:0
  ds_read_b128 v[86:89], v107 offset:4096
  v_mfma_f32_32x32x16_bf16 v[26:41], v[74:77], v[94:97], 0
  ds_read_b64_tr_b16 v[98:99], v110 offset:4096
  ds_read_b64_tr_b16 v[100:101], v110 offset:5120
  v_mfma_f32_32x32x16_bf16 v[42:57], v[78:81], v[90:93], 0
  ds_read_b64_tr_b16 v[102:103], v111 offset:4096
  ds_read_b64_tr_b16 v[104:105], v111 offset:5120
  v_mfma_f32_32x32x16_bf16 v[58:73], v[78:81], v[94:97], 0
  s_waitcnt lgkmcnt(0)
  v_mfma_f32_32x32x16_bf16 v[10:25], v[82:85], v[98:101], v[10:25]
  ds_read_b128 v[74:77], v108 offset:0
  ds_read_b128 v[78:81], v108 offset:4096
  v_mfma_f32_32x32x16_bf16 v[26:41], v[82:85], v[102:105], v[26:41]
  ds_read_b64_tr_b16 v[90:91], v110 offset:8192
  ds_read_b64_tr_b16 v[92:93], v110 offset:9216
  v_mfma_f32_32x32x16_bf16 v[42:57], v[86:89], v[98:101], v[42:57]
  ds_read_b64_tr_b16 v[94:95], v111 offset:8192
  ds_read_b64_tr_b16 v[96:97], v111 offset:9216
  v_mfma_f32_32x32x16_bf16 v[58:73], v[86:89], v[102:105], v[58:73]
  s_waitcnt lgkmcnt(0)
  v_mfma_f32_32x32x16_bf16 v[10:25], v[74:77], v[90:93], v[10:25]
  ds_read_b128 v[82:85], v109 offset:0
  ds_read_b128 v[86:89], v109 offset:4096
  v_mfma_f32_32x32x16_bf16 v[26:41], v[74:77], v[94:97], v[26:41]
  ds_read_b64_tr_b16 v[98:99], v110 offset:12288
  ds_read_b64_tr_b16 v[100:101], v110 offset:13312
  v_mfma_f32_32x32x16_bf16 v[42:57], v[78:81], v[90:93], v[42:57]
  ds_read_b64_tr_b16 v[102:103], v111 offset:12288
  ds_read_b64_tr_b16 v[104:105], v111 offset:13312
  v_mfma_f32_32x32x16_bf16 v[58:73], v[78:81], v[94:97], v[58:73]
  s_waitcnt lgkmcnt(0)
  s_barrier
  v_mfma_f32_32x32x16_bf16 v[10:25], v[82:85], v[98:101], v[10:25]
  ds_read_b128 v[74:77], v106 offset:32768
  ds_read_b128 v[78:81], v106 offset:36864
  v_mfma_f32_32x32x16_bf16 v[26:41], v[82:85], v[102:105], v[26:41]
  ds_read_b64_tr_b16 v[90:91], v110 offset:32768
  ds_read_b64_tr_b16 v[92:93], v110 offset:33792
  v_mfma_f32_32x32x16_bf16 v[42:57], v[86:89], v[98:101], v[42:57]
  ds_read_b64_tr_b16 v[94:95], v111 offset:32768
  ds_read_b64_tr_b16 v[96:97], v111 offset:33792
  v_mfma_f32_32x32x16_bf16 v[58:73], v[86:89], v[102:105], v[58:73]
  s_waitcnt lgkmcnt(0)
  v_mfma_f32_32x32x16_bf16 v[10:25], v[74:77], v[90:93], v[10:25]
  ds_read_b128 v[82:85], v107 offset:32768
  ds_read_b128 v[86:89], v107 offset:36864
  v_mfma_f32_32x32x16_bf16 v[26:41], v[74:77], v[94:97], v[26:41]
  ds_read_b64_tr_b16 v[98:99], v110 offset:36864
  ds_read_b64_tr_b16 v[100:101], v110 offset:37888
  v_mfma_f32_32x32x16_bf16 v[42:57], v[78:81], v[90:93], v[42:57]
  ds_read_b64_tr_b16 v[102:103], v111 offset:36864
  ds_read_b64_tr_b16 v[104:105], v111 offset:37888
  v_mfma_f32_32x32x16_bf16 v[58:73], v[78:81], v[94:97], v[58:73]
  s_waitcnt lgkmcnt(0)
  v_mfma_f32_32x32x16_bf16 v[10:25], v[82:85], v[98:101], v[10:25]
  ds_read_b128 v[74:77], v108 offset:32768
  ds_read_b128 v[78:81], v108 offset:36864
  v_mfma_f32_32x32x16_bf16 v[26:41], v[82:85], v[102:105], v[26:41]
  ds_read_b64_tr_b16 v[90:91], v110 offset:40960
  ds_read_b64_tr_b16 v[92:93], v110 offset:41984
  v_mfma_f32_32x32x16_bf16 v[42:57], v[86:89], v[98:101], v[42:57]
  ds_read_b64_tr_b16 v[94:95], v111 offset:40960
  ds_read_b64_tr_b16 v[96:97], v111 offset:41984
  v_mfma_f32_32x32x16_bf16 v[58:73], v[86:89], v[102:105], v[58:73]
  s_waitcnt lgkmcnt(0)
  v_mfma_f32_32x32x16_bf16 v[10:25], v[74:77], v[90:93], v[10:25]
  ds_read_b128 v[82:85], v109 offset:32768
  ds_read_b128 v[86:89], v109 offset:36864
  v_mfma_f32_32x32x16_bf16 v[26:41], v[74:77], v[94:97], v[26:41]
  ds_read_b64_tr_b16 v[98:99], v110 offset:45056
  ds_read_b64_tr_b16 v[100:101], v110 offset:46080
  v_mfma_f32_32x32x16_bf16 v[42:57], v[78:81], v[90:93], v[42:57]
  ds_read_b64_tr_b16 v[102:103], v111 offset:45056
  ds_read_b64_tr_b16 v[104:105], v111 offset:46080
  v_mfma_f32_32x32x16_bf16 v[58:73], v[78:81], v[94:97], v[58:73]
  s_waitcnt lgkmcnt(0)
  s_barrier
  v_mfma_f32_32x32x16_bf16 v[10:25], v[82:85], v[98:101], v[10:25]
  ds_read_b128 v[74:77], v112 offset:0
  ds_read_b128 v[78:81], v112 offset:4096
  v_mfma_f32_32x32x16_bf16 v[26:41], v[82:85], v[102:105], v[26:41]
  ds_read_b64_tr_b16 v[90:91], v116 offset:0
  ds_read_b64_tr_b16 v[92:93], v116 offset:1024
  v_mfma_f32_32x32x16_bf16 v[42:57], v[86:89], v[98:101], v[42:57]
  ds_read_b64_tr_b16 v[94:95], v117 offset:0
  ds_read_b64_tr_b16 v[96:97], v117 offset:1024
  v_mfma_f32_32x32x16_bf16 v[58:73], v[86:89], v[102:105], v[58:73]
  s_waitcnt lgkmcnt(0)
  v_mfma_f32_32x32x16_bf16 v[10:25], v[74:77], v[90:93], v[10:25]
  ds_read_b128 v[82:85], v113 offset:0
  ds_read_b128 v[86:89], v113 offset:4096
  v_mfma_f32_32x32x16_bf16 v[26:41], v[74:77], v[94:97], v[26:41]
  ds_read_b64_tr_b16 v[98:99], v116 offset:4096
  ds_read_b64_tr_b16 v[100:101], v116 offset:5120
  v_mfma_f32_32x32x16_bf16 v[42:57], v[78:81], v[90:93], v[42:57]
  ds_read_b64_tr_b16 v[102:103], v117 offset:4096
  ds_read_b64_tr_b16 v[104:105], v117 offset:5120
  v_mfma_f32_32x32x16_bf16 v[58:73], v[78:81], v[94:97], v[58:73]
  s_waitcnt lgkmcnt(0)
  v_mfma_f32_32x32x16_bf16 v[10:25], v[82:85], v[98:101], v[10:25]
  ds_read_b128 v[74:77], v114 offset:0
  ds_read_b128 v[78:81], v114 offset:4096
  v_mfma_f32_32x32x16_bf16 v[26:41], v[82:85], v[102:105], v[26:41]
  ds_read_b64_tr_b16 v[90:91], v116 offset:8192
  ds_read_b64_tr_b16 v[92:93], v116 offset:9216
  v_mfma_f32_32x32x16_bf16 v[42:57], v[86:89], v[98:101], v[42:57]
  ds_read_b64_tr_b16 v[94:95], v117 offset:8192
  ds_read_b64_tr_b16 v[96:97], v117 offset:9216
  v_mfma_f32_32x32x16_bf16 v[58:73], v[86:89], v[102:105], v[58:73]
  s_waitcnt lgkmcnt(0)
  v_mfma_f32_32x32x16_bf16 v[10:25], v[74:77], v[90:93], v[10:25]
  ds_read_b128 v[82:85], v115 offset:0
  ds_read_b128 v[86:89], v115 offset:4096
  v_mfma_f32_32x32x16_bf16 v[26:41], v[74:77], v[94:97], v[26:41]
  ds_read_b64_tr_b16 v[98:99], v116 offset:12288
  ds_read_b64_tr_b16 v[100:101], v116 offset:13312
  v_mfma_f32_32x32x16_bf16 v[42:57], v[78:81], v[90:93], v[42:57]
  ds_read_b64_tr_b16 v[102:103], v117 offset:12288
  ds_read_b64_tr_b16 v[104:105], v117 offset:13312
  v_mfma_f32_32x32x16_bf16 v[58:73], v[78:81], v[94:97], v[58:73]
  s_waitcnt lgkmcnt(0)
  s_barrier
  v_mfma_f32_32x32x16_bf16 v[10:25], v[82:85], v[98:101], v[10:25]
  ds_read_b128 v[74:77], v112 offset:32768
  ds_read_b128 v[78:81], v112 offset:36864
  v_mfma_f32_32x32x16_bf16 v[26:41], v[82:85], v[102:105], v[26:41]
  ds_read_b64_tr_b16 v[90:91], v116 offset:32768
  ds_read_b64_tr_b16 v[92:93], v116 offset:33792
  v_mfma_f32_32x32x16_bf16 v[42:57], v[86:89], v[98:101], v[42:57]
  ds_read_b64_tr_b16 v[94:95], v117 offset:32768
  ds_read_b64_tr_b16 v[96:97], v117 offset:33792
  v_mfma_f32_32x32x16_bf16 v[58:73], v[86:89], v[102:105], v[58:73]
  s_waitcnt lgkmcnt(0)
  v_mfma_f32_32x32x16_bf16 v[10:25], v[74:77], v[90:93], v[10:25]
  ds_read_b128 v[82:85], v113 offset:32768
  ds_read_b128 v[86:89], v113 offset:36864
  v_mfma_f32_32x32x16_bf16 v[26:41], v[74:77], v[94:97], v[26:41]
  ds_read_b64_tr_b16 v[98:99], v116 offset:36864
  ds_read_b64_tr_b16 v[100:101], v116 offset:37888
  v_mfma_f32_32x32x16_bf16 v[42:57], v[78:81], v[90:93], v[42:57]
  ds_read_b64_tr_b16 v[102:103], v117 offset:36864
  ds_read_b64_tr_b16 v[104:105], v117 offset:37888
  v_mfma_f32_32x32x16_bf16 v[58:73], v[78:81], v[94:97], v[58:73]
  s_waitcnt lgkmcnt(0)
  v_mfma_f32_32x32x16_bf16 v[10:25], v[82:85], v[98:101], v[10:25]
  ds_read_b128 v[74:77], v114 offset:32768
  ds_read_b128 v[78:81], v114 offset:36864
  v_mfma_f32_32x32x16_bf16 v[26:41], v[82:85], v[102:105], v[26:41]
  ds_read_b64_tr_b16 v[90:91], v116 offset:40960
  ds_read_b64_tr_b16 v[92:93], v116 offset:41984
  v_mfma_f32_32x32x16_bf16 v[42:57], v[86:89], v[98:101], v[42:57]
  ds_read_b64_tr_b16 v[94:95], v117 offset:40960
  ds_read_b64_tr_b16 v[96:97], v117 offset:41984
  v_mfma_f32_32x32x16_bf16 v[58:73], v[86:89], v[102:105], v[58:73]
  s_waitcnt lgkmcnt(0)
  v_mfma_f32_32x32x16_bf16 v[10:25], v[74:77], v[90:93], v[10:25]
  ds_read_b128 v[82:85], v115 offset:32768
  ds_read_b128 v[86:89], v115 offset:36864
  v_mfma_f32_32x32x16_bf16 v[26:41], v[74:77], v[94:97], v[26:41]
  ds_read_b64_tr_b16 v[98:99], v116 offset:45056
  ds_read_b64_tr_b16 v[100:101], v116 offset:46080
  v_mfma_f32_32x32x16_bf16 v[42:57], v[78:81], v[90:93], v[42:57]
  ds_read_b64_tr_b16 v[102:103], v117 offset:45056
  ds_read_b64_tr_b16 v[104:105], v117 offset:46080
  v_mfma_f32_32x32x16_bf16 v[58:73], v[78:81], v[94:97], v[58:73]
  s_waitcnt lgkmcnt(0)
  s_barrier
  v_mfma_f32_32x32x16_bf16 v[10:25], v[82:85], v[98:101], v[10:25]
  ds_read_b128 v[74:77], v118 offset:0
  ds_read_b128 v[78:81], v118 offset:4096
  v_mfma_f32_32x32x16_bf16 v[26:41], v[82:85], v[102:105], v[26:41]
  ds_read_b64_tr_b16 v[90:91], v122 offset:0
  ds_read_b64_tr_b16 v[92:93], v122 offset:1024
  v_mfma_f32_32x32x16_bf16 v[42:57], v[86:89], v[98:101], v[42:57]
  ds_read_b64_tr_b16 v[94:95], v123 offset:0
  ds_read_b64_tr_b16 v[96:97], v123 offset:1024
  v_mfma_f32_32x32x16_bf16 v[58:73], v[86:89], v[102:105], v[58:73]
  s_waitcnt lgkmcnt(0)
  v_mfma_f32_32x32x16_bf16 v[10:25], v[74:77], v[90:93], v[10:25]
  ds_read_b128 v[82:85], v119 offset:0
  ds_read_b128 v[86:89], v119 offset:4096
  v_mfma_f32_32x32x16_bf16 v[26:41], v[74:77], v[94:97], v[26:41]
  ds_read_b64_tr_b16 v[98:99], v122 offset:4096
  ds_read_b64_tr_b16 v[100:101], v122 offset:5120
  v_mfma_f32_32x32x16_bf16 v[42:57], v[78:81], v[90:93], v[42:57]
  ds_read_b64_tr_b16 v[102:103], v123 offset:4096
  ds_read_b64_tr_b16 v[104:105], v123 offset:5120
  v_mfma_f32_32x32x16_bf16 v[58:73], v[78:81], v[94:97], v[58:73]
  s_waitcnt lgkmcnt(0)
  v_mfma_f32_32x32x16_bf16 v[10:25], v[82:85], v[98:101], v[10:25]
  ds_read_b128 v[74:77], v120 offset:0
  ds_read_b128 v[78:81], v120 offset:4096
  v_mfma_f32_32x32x16_bf16 v[26:41], v[82:85], v[102:105], v[26:41]
  ds_read_b64_tr_b16 v[90:91], v122 offset:8192
  ds_read_b64_tr_b16 v[92:93], v122 offset:9216
  v_mfma_f32_32x32x16_bf16 v[42:57], v[86:89], v[98:101], v[42:57]
  ds_read_b64_tr_b16 v[94:95], v123 offset:8192
  ds_read_b64_tr_b16 v[96:97], v123 offset:9216
  v_mfma_f32_32x32x16_bf16 v[58:73], v[86:89], v[102:105], v[58:73]
  s_waitcnt lgkmcnt(0)
  v_mfma_f32_32x32x16_bf16 v[10:25], v[74:77], v[90:93], v[10:25]
  ds_read_b128 v[82:85], v121 offset:0
  ds_read_b128 v[86:89], v121 offset:4096
  v_mfma_f32_32x32x16_bf16 v[26:41], v[74:77], v[94:97], v[26:41]
  ds_read_b64_tr_b16 v[98:99], v122 offset:12288
  ds_read_b64_tr_b16 v[100:101], v122 offset:13312
  v_mfma_f32_32x32x16_bf16 v[42:57], v[78:81], v[90:93], v[42:57]
  ds_read_b64_tr_b16 v[102:103], v123 offset:12288
  ds_read_b64_tr_b16 v[104:105], v123 offset:13312
  v_mfma_f32_32x32x16_bf16 v[58:73], v[78:81], v[94:97], v[58:73]
  s_waitcnt lgkmcnt(0)
  s_barrier
  v_mfma_f32_32x32x16_bf16 v[10:25], v[82:85], v[98:101], v[10:25]
  ds_read_b128 v[74:77], v106 offset:0
  ds_read_b128 v[78:81], v106 offset:4096
  v_mfma_f32_32x32x16_bf16 v[26:41], v[82:85], v[102:105], v[26:41]
  ds_read_b64_tr_b16 v[90:91], v110 offset:0
  ds_read_b64_tr_b16 v[92:93], v110 offset:1024
  v_mfma_f32_32x32x16_bf16 v[42:57], v[86:89], v[98:101], v[42:57]
  ds_read_b64_tr_b16 v[94:95], v111 offset:0
  ds_read_b64_tr_b16 v[96:97], v111 offset:1024
  v_mfma_f32_32x32x16_bf16 v[58:73], v[86:89], v[102:105], v[58:73]
  s_waitcnt lgkmcnt(0)
  v_mfma_f32_32x32x16_bf16 v[10:25], v[74:77], v[90:93], v[10:25]
  ds_read_b128 v[82:85], v107 offset:0
  ds_read_b128 v[86:89], v107 offset:4096
  v_mfma_f32_32x32x16_bf16 v[26:41], v[74:77], v[94:97], v[26:41]
  ds_read_b64_tr_b16 v[98:99], v110 offset:4096
  ds_read_b64_tr_b16 v[100:101], v110 offset:5120
  v_mfma_f32_32x32x16_bf16 v[42:57], v[78:81], v[90:93], v[42:57]
  ds_read_b64_tr_b16 v[102:103], v111 offset:4096
  ds_read_b64_tr_b16 v[104:105], v111 offset:5120
  v_mfma_f32_32x32x16_bf16 v[58:73], v[78:81], v[94:97], v[58:73]
  s_waitcnt lgkmcnt(0)
  v_mfma_f32_32x32x16_bf16 v[10:25], v[82:85], v[98:101], v[10:25]
  ds_read_b128 v[74:77], v108 offset:0
  ds_read_b128 v[78:81], v108 offset:4096
  v_mfma_f32_32x32x16_bf16 v[26:41], v[82:85], v[102:105], v[26:41]
  ds_read_b64_tr_b16 v[90:91], v110 offset:8192
  ds_read_b64_tr_b16 v[92:93], v110 offset:9216
  v_mfma_f32_32x32x16_bf16 v[42:57], v[86:89], v[98:101], v[42:57]
  ds_read_b64_tr_b16 v[94:95], v111 offset:8192
  ds_read_b64_tr_b16 v[96:97], v111 offset:9216
  v_mfma_f32_32x32x16_bf16 v[58:73], v[86:89], v[102:105], v[58:73]
  s_waitcnt lgkmcnt(0)
  v_mfma_f32_32x32x16_bf16 v[10:25], v[74:77], v[90:93], v[10:25]
  ds_read_b128 v[82:85], v109 offset:0
  ds_read_b128 v[86:89], v109 offset:4096
  v_mfma_f32_32x32x16_bf16 v[26:41], v[74:77], v[94:97], v[26:41]
  ds_read_b64_tr_b16 v[98:99], v110 offset:12288
  ds_read_b64_tr_b16 v[100:101], v110 offset:13312
  v_mfma_f32_32x32x16_bf16 v[42:57], v[78:81], v[90:93], v[42:57]
  ds_read_b64_tr_b16 v[102:103], v111 offset:12288
  ds_read_b64_tr_b16 v[104:105], v111 offset:13312
  v_mfma_f32_32x32x16_bf16 v[58:73], v[78:81], v[94:97], v[58:73]
  s_waitcnt lgkmcnt(0)
  s_barrier
  v_mfma_f32_32x32x16_bf16 v[10:25], v[82:85], v[98:101], v[10:25]
  ds_read_b128 v[74:77], v106 offset:32768
  ds_read_b128 v[78:81], v106 offset:36864
  v_mfma_f32_32x32x16_bf16 v[26:41], v[82:85], v[102:105], v[26:41]
  ds_read_b64_tr_b16 v[90:91], v110 offset:32768
  ds_read_b64_tr_b16 v[92:93], v110 offset:33792
  v_mfma_f32_32x32x16_bf16 v[42:57], v[86:89], v[98:101], v[42:57]
  ds_read_b64_tr_b16 v[94:95], v111 offset:32768
  ds_read_b64_tr_b16 v[96:97], v111 offset:33792
  v_mfma_f32_32x32x16_bf16 v[58:73], v[86:89], v[102:105], v[58:73]
  s_waitcnt lgkmcnt(0)
  v_mfma_f32_32x32x16_bf16 v[10:25], v[74:77], v[90:93], v[10:25]
  ds_read_b128 v[82:85], v107 offset:32768
  ds_read_b128 v[86:89], v107 offset:36864
  v_mfma_f32_32x32x16_bf16 v[26:41], v[74:77], v[94:97], v[26:41]
  ds_read_b64_tr_b16 v[98:99], v110 offset:36864
  ds_read_b64_tr_b16 v[100:101], v110 offset:37888
  v_mfma_f32_32x32x16_bf16 v[42:57], v[78:81], v[90:93], v[42:57]
  ds_read_b64_tr_b16 v[102:103], v111 offset:36864
  ds_read_b64_tr_b16 v[104:105], v111 offset:37888
  v_mfma_f32_32x32x16_bf16 v[58:73], v[78:81], v[94:97], v[58:73]
  s_waitcnt lgkmcnt(0)
  v_mfma_f32_32x32x16_bf16 v[10:25], v[82:85], v[98:101], v[10:25]
  ds_read_b128 v[74:77], v108 offset:32768
  ds_read_b128 v[78:81], v108 offset:36864
  v_mfma_f32_32x32x16_bf16 v[26:41], v[82:85], v[102:105], v[26:41]
  ds_read_b64_tr_b16 v[90:91], v110 offset:40960
  ds_read_b64_tr_b16 v[92:93], v110 offset:41984
  v_mfma_f32_32x32x16_bf16 v[42:57], v[86:89], v[98:101], v[42:57]
  ds_read_b64_tr_b16 v[94:95], v111 offset:40960
  ds_read_b64_tr_b16 v[96:97], v111 offset:41984
  v_mfma_f32_32x32x16_bf16 v[58:73], v[86:89], v[102:105], v[58:73]
  s_waitcnt lgkmcnt(0)
  v_mfma_f32_32x32x16_bf16 v[10:25], v[74:77], v[90:93], v[10:25]
  ds_read_b128 v[82:85], v109 offset:32768
  ds_read_b128 v[86:89], v109 offset:36864
  v_mfma_f32_32x32x16_bf16 v[26:41], v[74:77], v[94:97], v[26:41]
  ds_read_b64_tr_b16 v[98:99], v110 offset:45056
  ds_read_b64_tr_b16 v[100:101], v110 offset:46080
  v_mfma_f32_32x32x16_bf16 v[42:57], v[78:81], v[90:93], v[42:57]
  ds_read_b64_tr_b16 v[102:103], v111 offset:45056
  ds_read_b64_tr_b16 v[104:105], v111 offset:46080
  v_mfma_f32_32x32x16_bf16 v[58:73], v[78:81], v[94:97], v[58:73]
  s_waitcnt lgkmcnt(0)
  s_barrier
  v_mfma_f32_32x32x16_bf16 v[10:25], v[82:85], v[98:101], v[10:25]
  ds_read_b128 v[74:77], v112 offset:0
  ds_read_b128 v[78:81], v112 offset:4096
  v_mfma_f32_32x32x16_bf16 v[26:41], v[82:85], v[102:105], v[26:41]
  ds_read_b64_tr_b16 v[90:91], v116 offset:0
  ds_read_b64_tr_b16 v[92:93], v116 offset:1024
  v_mfma_f32_32x32x16_bf16 v[42:57], v[86:89], v[98:101], v[42:57]
  ds_read_b64_tr_b16 v[94:95], v117 offset:0
  ds_read_b64_tr_b16 v[96:97], v117 offset:1024
  v_mfma_f32_32x32x16_bf16 v[58:73], v[86:89], v[102:105], v[58:73]
  s_waitcnt lgkmcnt(0)
  v_mfma_f32_32x32x16_bf16 v[10:25], v[74:77], v[90:93], v[10:25]
  ds_read_b128 v[82:85], v113 offset:0
  ds_read_b128 v[86:89], v113 offset:4096
  v_mfma_f32_32x32x16_bf16 v[26:41], v[74:77], v[94:97], v[26:41]
  ds_read_b64_tr_b16 v[98:99], v116 offset:4096
  ds_read_b64_tr_b16 v[100:101], v116 offset:5120
  v_mfma_f32_32x32x16_bf16 v[42:57], v[78:81], v[90:93], v[42:57]
  ds_read_b64_tr_b16 v[102:103], v117 offset:4096
  ds_read_b64_tr_b16 v[104:105], v117 offset:5120
  v_mfma_f32_32x32x16_bf16 v[58:73], v[78:81], v[94:97], v[58:73]
  s_waitcnt lgkmcnt(0)
  v_mfma_f32_32x32x16_bf16 v[10:25], v[82:85], v[98:101], v[10:25]
  ds_read_b128 v[74:77], v114 offset:0
  ds_read_b128 v[78:81], v114 offset:4096
  v_mfma_f32_32x32x16_bf16 v[26:41], v[82:85], v[102:105], v[26:41]
  ds_read_b64_tr_b16 v[90:91], v116 offset:8192
  ds_read_b64_tr_b16 v[92:93], v116 offset:9216
  v_mfma_f32_32x32x16_bf16 v[42:57], v[86:89], v[98:101], v[42:57]
  ds_read_b64_tr_b16 v[94:95], v117 offset:8192
  ds_read_b64_tr_b16 v[96:97], v117 offset:9216
  v_mfma_f32_32x32x16_bf16 v[58:73], v[86:89], v[102:105], v[58:73]
  s_waitcnt lgkmcnt(0)
  v_mfma_f32_32x32x16_bf16 v[10:25], v[74:77], v[90:93], v[10:25]
  ds_read_b128 v[82:85], v115 offset:0
  ds_read_b128 v[86:89], v115 offset:4096
  v_mfma_f32_32x32x16_bf16 v[26:41], v[74:77], v[94:97], v[26:41]
  ds_read_b64_tr_b16 v[98:99], v116 offset:12288
  ds_read_b64_tr_b16 v[100:101], v116 offset:13312
  v_mfma_f32_32x32x16_bf16 v[42:57], v[78:81], v[90:93], v[42:57]
  ds_read_b64_tr_b16 v[102:103], v117 offset:12288
  ds_read_b64_tr_b16 v[104:105], v117 offset:13312
  v_mfma_f32_32x32x16_bf16 v[58:73], v[78:81], v[94:97], v[58:73]
  s_waitcnt lgkmcnt(0)
  s_barrier
  v_mfma_f32_32x32x16_bf16 v[10:25], v[82:85], v[98:101], v[10:25]
  ds_read_b128 v[74:77], v112 offset:32768
  ds_read_b128 v[78:81], v112 offset:36864
  v_mfma_f32_32x32x16_bf16 v[26:41], v[82:85], v[102:105], v[26:41]
  ds_read_b64_tr_b16 v[90:91], v116 offset:32768
  ds_read_b64_tr_b16 v[92:93], v116 offset:33792
  v_mfma_f32_32x32x16_bf16 v[42:57], v[86:89], v[98:101], v[42:57]
  ds_read_b64_tr_b16 v[94:95], v117 offset:32768
  ds_read_b64_tr_b16 v[96:97], v117 offset:33792
  v_mfma_f32_32x32x16_bf16 v[58:73], v[86:89], v[102:105], v[58:73]
  s_waitcnt lgkmcnt(0)
  v_mfma_f32_32x32x16_bf16 v[10:25], v[74:77], v[90:93], v[10:25]
  ds_read_b128 v[82:85], v113 offset:32768
  ds_read_b128 v[86:89], v113 offset:36864
  v_mfma_f32_32x32x16_bf16 v[26:41], v[74:77], v[94:97], v[26:41]
  ds_read_b64_tr_b16 v[98:99], v116 offset:36864
  ds_read_b64_tr_b16 v[100:101], v116 offset:37888
  v_mfma_f32_32x32x16_bf16 v[42:57], v[78:81], v[90:93], v[42:57]
  ds_read_b64_tr_b16 v[102:103], v117 offset:36864
  ds_read_b64_tr_b16 v[104:105], v117 offset:37888
  v_mfma_f32_32x32x16_bf16 v[58:73], v[78:81], v[94:97], v[58:73]
  s_waitcnt lgkmcnt(0)
  v_mfma_f32_32x32x16_bf16 v[10:25], v[82:85], v[98:101], v[10:25]
  ds_read_b128 v[74:77], v114 offset:32768
  ds_read_b128 v[78:81], v114 offset:36864
  v_mfma_f32_32x32x16_bf16 v[26:41], v[82:85], v[102:105], v[26:41]
  ds_read_b64_tr_b16 v[90:91], v116 offset:40960
  ds_read_b64_tr_b16 v[92:93], v116 offset:41984
  v_mfma_f32_32x32x16_bf16 v[42:57], v[86:89], v[98:101], v[42:57]
  ds_read_b64_tr_b16 v[94:95], v117 offset:40960
  ds_read_b64_tr_b16 v[96:97], v117 offset:41984
  v_mfma_f32_32x32x16_bf16 v[58:73], v[86:89], v[102:105], v[58:73]
  s_waitcnt lgkmcnt(0)
  v_mfma_f32_32x32x16_bf16 v[10:25], v[74:77], v[90:93], v[10:25]
  ds_read_b128 v[82:85], v115 offset:32768
  ds_read_b128 v[86:89], v115 offset:36864
  v_mfma_f32_32x32x16_bf16 v[26:41], v[74:77], v[94:97], v[26:41]
  ds_read_b64_tr_b16 v[98:99], v116 offset:45056
  ds_read_b64_tr_b16 v[100:101], v116 offset:46080
  v_mfma_f32_32x32x16_bf16 v[42:57], v[78:81], v[90:93], v[42:57]
  ds_read_b64_tr_b16 v[102:103], v117 offset:45056
  ds_read_b64_tr_b16 v[104:105], v117 offset:46080
  v_mfma_f32_32x32x16_bf16 v[58:73], v[78:81], v[94:97], v[58:73]
  s_waitcnt lgkmcnt(0)
  v_mfma_f32_32x32x16_bf16 v[10:25], v[82:85], v[98:101], v[10:25]
  v_mfma_f32_32x32x16_bf16 v[26:41], v[82:85], v[102:105], v[26:41]
  v_mfma_f32_32x32x16_bf16 v[42:57], v[86:89], v[98:101], v[42:57]
  v_mfma_f32_32x32x16_bf16 v[58:73], v[86:89], v[102:105], v[58:73]
  v_lshrrev_b32 v2, 5, v0
  v_mul_u32_u24 v2, 9216, v2
  v_and_b32 v1, 31, v0
  v_lshlrev_b32 v1, 4, v1
  v_add_u32 v1, v1, v2
  s_lshl_b32 s33, s24, 3
  s_lshl_b32 s34, s27, 2
  s_add_u32 s33, s33, s34
  s_mul_i32 s33, s33, 18432
  s_lshl_b32 s34, s28, 1
  s_add_u32 s34, s34, s37
  s_lshl_b32 s34, s34, 9
  s_add_u32 s33, s33, s34
  s_add_u32 s33, s33, 2359296
  v_cvt_pk_bf16_f32 v74, v10, v11
  v_cvt_pk_bf16_f32 v75, v12, v13
  v_cvt_pk_bf16_f32 v76, v14, v15
  v_cvt_pk_bf16_f32 v77, v16, v17
  v_cvt_pk_bf16_f32 v78, v18, v19
  v_cvt_pk_bf16_f32 v79, v20, v21
  v_cvt_pk_bf16_f32 v80, v22, v23
  v_cvt_pk_bf16_f32 v81, v24, v25
  s_add_u32 s34, s33, 0
  buffer_store_dwordx4 v[74:77], v1, s[4:7], s34 offen offset:0 sc1
  s_add_u32 s34, s33, 18432
  buffer_store_dwordx4 v[78:81], v1, s[4:7], s34 offen offset:0 sc1
  v_cvt_pk_bf16_f32 v82, v26, v27
  v_cvt_pk_bf16_f32 v83, v28, v29
  v_cvt_pk_bf16_f32 v84, v30, v31
  v_cvt_pk_bf16_f32 v85, v32, v33
  v_cvt_pk_bf16_f32 v86, v34, v35
  v_cvt_pk_bf16_f32 v87, v36, v37
  v_cvt_pk_bf16_f32 v88, v38, v39
  v_cvt_pk_bf16_f32 v89, v40, v41
  s_add_u32 s34, s33, 0
  buffer_store_dwordx4 v[82:85], v1, s[4:7], s34 offen offset:512 sc1
  s_add_u32 s34, s33, 18432
  buffer_store_dwordx4 v[86:89], v1, s[4:7], s34 offen offset:512 sc1
  v_cvt_pk_bf16_f32 v74, v42, v43
  v_cvt_pk_bf16_f32 v75, v44, v45
  v_cvt_pk_bf16_f32 v76, v46, v47
  v_cvt_pk_bf16_f32 v77, v48, v49
  v_cvt_pk_bf16_f32 v78, v50, v51
  v_cvt_pk_bf16_f32 v79, v52, v53
  v_cvt_pk_bf16_f32 v80, v54, v55
  v_cvt_pk_bf16_f32 v81, v56, v57
  s_add_u32 s34, s33, 36864
  buffer_store_dwordx4 v[74:77], v1, s[4:7], s34 offen offset:0 sc1
  s_add_u32 s34, s33, 55296
  buffer_store_dwordx4 v[78:81], v1, s[4:7], s34 offen offset:0 sc1
  v_cvt_pk_bf16_f32 v82, v58, v59
  v_cvt_pk_bf16_f32 v83, v60, v61
  v_cvt_pk_bf16_f32 v84, v62, v63
  v_cvt_pk_bf16_f32 v85, v64, v65
  v_cvt_pk_bf16_f32 v86, v66, v67
  v_cvt_pk_bf16_f32 v87, v68, v69
  v_cvt_pk_bf16_f32 v88, v70, v71
  v_cvt_pk_bf16_f32 v89, v72, v73
  s_add_u32 s34, s33, 36864
  buffer_store_dwordx4 v[82:85], v1, s[4:7], s34 offen offset:512 sc1
  s_add_u32 s34, s33, 55296
  buffer_store_dwordx4 v[86:89], v1, s[4:7], s34 offen offset:512 sc1
k1_cend:
  s_endpgm
k1_end:
  s_endpgm
k1_exit:
  s_endpgm
.globl l2_kernel
.p2align 8
.type l2_kernel,@function
l2_kernel:
  s_load_dwordx2 s[4:5], s[0:1], 120
  s_mov_b32 s6, 31457280
  s_mov_b32 s7, 0x00020000
  s_cmp_ge_u32 s2, 400
  s_cbranch_scc1 l2_exit
  s_cmp_ge_u32 s2, 256
  s_cbranch_scc1 l2_svc
  s_setprio 3
  s_and_b32 s20, s2, 7
  s_lshl_b32 s20, s20, 2
  s_lshr_b32 s21, s2, 3
  s_and_b32 s21, s21, 3
  s_add_u32 s8, s20, s21
  s_lshr_b32 s9, s2, 5
  v_lshrrev_b32 v112, 6, v0
  v_and_b32 v0, 63, v0
  v_readfirstlane_b32 s10, v112
  v_lshlrev_b32 v108, 4, v0
  s_nop 2
  s_and_b32 s11, s10, 3
  s_lshr_b32 s12, s10, 2
  s_lshr_b32 s20, s11, 1
  s_cmp_eq_u32 s20, s12
  s_cselect_b32 s36, 1, 0
  s_and_b32 s37, s11, 1
  s_mul_i32 s20, s12, 10240
  v_add_u32 v109, s20, v108
  v_and_b32 v112, 31, v0
  v_lshlrev_b32 v110, 2, v112
  v_lshrrev_b32 v113, 5, v0
  v_mul_u32_u24 v113, 18, v113
  v_add_u32 v113, v113, v112
  v_lshlrev_b32 v111, 4, v113
  v_add_u32 v111, s20, v111
  s_lshl_b32 s26, s9, 3
  s_lshl_b32 s21, s11, 1
  s_add_u32 s26, s26, s21
  s_lshl_b32 s20, s8, 16
  s_lshl_b32 s21, s26, 10
  s_add_u32 s20, s20, s21
  s_add_u32 s20, s20, 5242880
  s_waitcnt lgkmcnt(0)
  buffer_load_dwordx4 v[82:85], v108, s[4:7], s20 offen
  buffer_load_dwordx4 v[86:89], v108, s[4:7], s20 offen offset:1024
  s_lshl_b32 s20, s8, 13
  s_lshl_b32 s21, s26, 7
  s_add_u32 s20, s20, s21
  s_add_u32 s20, s20, 7340032
  buffer_load_dword v90, v110, s[4:7], s20 offen
  buffer_load_dword v92, v110, s[4:7], s20 offen offset:128
  s_add_u32 s20, s26, s12
  s_lshl_b32 s20, s20, 7
  s_add_u32 s20, s20, 22020096
  buffer_load_dword v114, v110, s[4:7], s20 offen
  s_lshl_b32 s20, s8, 16
  s_lshl_b32 s21, s12, 15
  s_add_u32 s20, s20, s21
  s_add_u32 s27, s20, 0
  s_lshl_b32 s20, s8, 13
  s_lshl_b32 s21, s12, 12
  s_add_u32 s20, s20, s21
  s_add_u32 s28, s20, 2097152
  s_mul_i32 s20, s8, 288
  s_mul_i32 s21, s12, 1179648
  s_add_u32 s20, s20, s21
  s_add_u32 s29, s20, 2359296
  s_add_u32 s30, s27, 1024
  s_add_u32 s31, s28, 128
  s_cmp_eq_u32 s37, 0
  s_cselect_b32 s22, s30, s29
  s_cselect_b32 s23, s31, s29
  s_mov_b32 s30, 147456
  s_cselect_b32 s15, 4096, s30
  s_cselect_b32 s16, 512, s30
  s_cselect_b64 vcc, -1, 0
  s_mul_i32 s17, s12, 10240
  s_mul_i32 s20, s37, 5120
  s_add_u32 s17, s17, s20
  v_add_u32 v2, 0, v0
  v_min_u32 v2, 287, v2
  v_mul_u32_u24 v3, 3641, v2
  v_lshrrev_b32 v3, 16, v3
  v_mul_u32_u24 v4, 8928, v3
  v_lshlrev_b32 v2, 4, v2
  v_add_u32 v2, v2, v4
  v_subrev_u32 v2, 0, v2
  v_cndmask_b32 v115, v2, v108, vcc
  v_add_u32 v2, 64, v0
  v_min_u32 v2, 287, v2
  v_mul_u32_u24 v3, 3641, v2
  v_lshrrev_b32 v3, 16, v3
  v_mul_u32_u24 v4, 8928, v3
  v_lshlrev_b32 v2, 4, v2
  v_add_u32 v2, v2, v4
  v_subrev_u32 v2, 1024, v2
  v_cndmask_b32 v116, v2, v108, vcc
  v_add_u32 v2, 128, v0
  v_min_u32 v2, 287, v2
  v_mul_u32_u24 v3, 3641, v2
  v_lshrrev_b32 v3, 16, v3
  v_mul_u32_u24 v4, 8928, v3
  v_lshlrev_b32 v2, 4, v2
  v_add_u32 v2, v2, v4
  v_subrev_u32 v2, 2048, v2
  v_cndmask_b32 v117, v2, v108, vcc
  v_add_u32 v2, 192, v0
  v_min_u32 v2, 287, v2
  v_mul_u32_u24 v3, 3641, v2
  v_lshrrev_b32 v3, 16, v3
  v_mul_u32_u24 v4, 8928, v3
  v_lshlrev_b32 v2, 4, v2
  v_add_u32 v2, v2, v4
  v_subrev_u32 v2, 3072, v2
  v_cndmask_b32 v118, v2, v108, vcc
  v_add_u32 v2, 256, v0
  v_min_u32 v2, 287, v2
  v_mul_u32_u24 v3, 3641, v2
  v_lshrrev_b32 v3, 16, v3
  v_mul_u32_u24 v4, 8928, v3
  v_lshlrev_b32 v2, 4, v2
  v_add_u32 v2, v2, v4
  v_subrev_u32 v2, 0, v2
  v_cndmask_b32 v119, v2, v108, vcc
  v_cmp_gt_u32 vcc, 32, v0
  v_mov_b32 v91, 0
  v_mov_b32 v93, 0
  v_mov_b32 v99, 0x3f803f80
  s_mov_b32 s19, 0
  s_mov_b32 s34, 0x3ffff
  s_mov_b32 s35, 0x3ffff
att_start:
  buffer_load_dwordx4 v[94:97], v108, s[4:7], s27 offen
  buffer_load_dword v98, v110, s[4:7], s28 offen
  s_mov_b32 s13, s22
  s_mov_b32 s14, s23
  s_cmp_eq_u32 s36, 0
  s_cbranch_scc1 att_nodma_1
  s_add_u32 m0, s17, 0
  s_nop 0
  buffer_load_dwordx4 v115, s[4:7], s13 offen lds
  buffer_load_dwordx4 v116, s[4:7], s13 offen offset:1024 lds
  buffer_load_dwordx4 v117, s[4:7], s13 offen offset:2048 lds
  buffer_load_dwordx4 v118, s[4:7], s13 offen offset:3072 lds
  s_add_u32 m0, s17, 4096
  s_add_u32 s13, s13, s15
  buffer_load_dwordx4 v119, s[4:7], s14 offen lds
  s_add_u32 s14, s14, s16
att_nodma_1:
  s_cmp_eq_u32 s36, 0
  s_cbranch_scc1 att_nodma_2
  s_add_u32 m0, s17, 20480
  s_nop 0
  buffer_load_dwordx4 v115, s[4:7], s13 offen lds
  buffer_load_dwordx4 v116, s[4:7], s13 offen offset:1024 lds
  buffer_load_dwordx4 v117, s[4:7], s13 offen offset:2048 lds
  buffer_load_dwordx4 v118, s[4:7], s13 offen offset:3072 lds
  s_add_u32 m0, s17, 24576
  s_add_u32 s13, s13, s15
  buffer_load_dwordx4 v119, s[4:7], s14 offen lds
  s_add_u32 s14, s14, s16
att_nodma_2:
  s_mul_i32 s20, s12, 10240
  v_add_u32 v113, s20, v110
  s_mov_b32 s18, 0
  v_cmp_gt_u32 vcc, 32, v0
  v_mov_b32 v74, 0
  v_mov_b32 v75, 0
  v_mov_b32 v76, 0
  v_mov_b32 v77, 0
  v_mov_b32 v78, 0
  v_mov_b32 v79, 0
  v_mov_b32 v80, 0
  v_mov_b32 v81, 0
  v_and_b32 v112, 31, v0
  v_cmp_eq_u32 s[24:25], 18, v112
  v_mov_b32 v112, 0x3f803f80
  s_nop 0
  v_cndmask_b32 v100, 0, v112, s[24:25]
  v_cndmask_b32 v104, 0, v112, s[24:25]
  v_cndmask_b32 v101, 0, v112, s[24:25]
  v_cndmask_b32 v105, 0, v112, s[24:25]
  v_cndmask_b32 v102, 0, v112, s[24:25]
  v_cndmask_b32 v106, 0, v112, s[24:25]
  v_cndmask_b32 v103, 0, v112, s[24:25]
  v_cndmask_b32 v107, 0, v112, s[24:25]
  s_waitcnt vmcnt(4)
  v_cndmask_b32 v90, 0, v90, vcc
  s_waitcnt vmcnt(3)
  v_cndmask_b32 v92, 0, v92, vcc
  s_waitcnt vmcnt(0)
  v_mfma_f32_32x32x8bf16_1k v[2:17], v[98:99], v[90:91], 0
  v_mfma_f32_32x32x16_bf16 v[2:17], v[94:97], v[82:85], v[2:17]
  v_mov_b32 v34, 0
  v_mov_b32 v50, 0
  v_mov_b32 v35, 0
  v_mov_b32 v51, 0
  v_mov_b32 v36, 0
  v_mov_b32 v52, 0
  v_mov_b32 v37, 0
  v_mov_b32 v53, 0
  v_mov_b32 v38, 0
  v_mov_b32 v54, 0
  v_mov_b32 v39, 0
  v_mov_b32 v55, 0
  v_mov_b32 v40, 0
  v_mov_b32 v56, 0
  v_mov_b32 v41, 0
  v_mov_b32 v57, 0
  v_mov_b32 v42, 0
  v_mov_b32 v58, 0
  v_mov_b32 v43, 0
  v_mov_b32 v59, 0
  v_mov_b32 v44, 0
  v_mov_b32 v60, 0
  v_mov_b32 v45, 0
  v_mov_b32 v61, 0
  v_mov_b32 v46, 0
  v_mov_b32 v62, 0
  v_mov_b32 v47, 0
  v_mov_b32 v63, 0
  v_mov_b32 v48, 0
  v_mov_b32 v64, 0
  v_mov_b32 v49, 0
  v_mov_b32 v65, 0
  s_waitcnt vmcnt(5)
  s_barrier
  s_setprio 3
  v_mfma_f32_32x32x8bf16_1k v[18:33], v[98:99], v[92:93], 0
  v_exp_f32 v2, v2
  v_exp_f32 v3, v3
  v_exp_f32 v4, v4
  v_cvt_pk_bf16_f32 v66, v2, v3
  v_exp_f32 v5, v5
  v_exp_f32 v6, v6
  v_mfma_f32_32x32x16_bf16 v[18:33], v[94:97], v[86:89], v[18:33]
  ds_read_b32 v98, v113 offset:4096
  ds_read_b128 v[94:97], v109 offset:0
  v_cvt_pk_bf16_f32 v67, v4, v5
  v_exp_f32 v7, v7
  v_exp_f32 v8, v8
  v_cvt_pk_bf16_f32 v68, v6, v7
  v_exp_f32 v9, v9
  v_exp_f32 v10, v10
  v_mfma_f32_32x32x16_bf16 v[50:65], v[100:103], v[74:77], v[50:65]
  v_cvt_pk_bf16_f32 v69, v8, v9
  v_exp_f32 v11, v11
  v_exp_f32 v12, v12
  v_cvt_pk_bf16_f32 v70, v10, v11
  v_exp_f32 v13, v13
  v_exp_f32 v14, v14
  v_mfma_f32_32x32x16_bf16 v[50:65], v[104:107], v[78:81], v[50:65]
  s_mov_b64 exec, s[34:35]
  ds_read_b128 v[100:103], v111 offset:5120
  ds_read_b128 v[104:107], v111 offset:5696
  s_mov_b64 exec, -1
  v_cvt_pk_bf16_f32 v71, v12, v13
  v_exp_f32 v15, v15
  v_exp_f32 v16, v16
  v_cvt_pk_bf16_f32 v72, v14, v15
  v_exp_f32 v17, v17
  s_nop 0
  v_cvt_pk_bf16_f32 v73, v16, v17
  s_waitcnt lgkmcnt(2)
  v_mfma_f32_32x32x8bf16_1k v[2:17], v[98:99], v[90:91], 0
  v_exp_f32 v18, v18
  v_exp_f32 v19, v19
  v_exp_f32 v20, v20
  v_cvt_pk_bf16_f32 v74, v18, v19
  v_exp_f32 v21, v21
  v_exp_f32 v22, v22
  v_mfma_f32_32x32x16_bf16 v[2:17], v[94:97], v[82:85], v[2:17]
  v_cvt_pk_bf16_f32 v75, v20, v21
  v_exp_f32 v23, v23
  v_exp_f32 v24, v24
  v_cvt_pk_bf16_f32 v76, v22, v23
  v_exp_f32 v25, v25
  v_exp_f32 v26, v26
  s_waitcnt lgkmcnt(0)
  v_mfma_f32_32x32x16_bf16 v[34:49], v[100:103], v[66:69], v[34:49]
  v_cvt_pk_bf16_f32 v77, v24, v25
  v_exp_f32 v27, v27
  v_exp_f32 v28, v28
  v_cvt_pk_bf16_f32 v78, v26, v27
  v_exp_f32 v29, v29
  v_exp_f32 v30, v30
  v_mfma_f32_32x32x16_bf16 v[34:49], v[104:107], v[70:73], v[34:49]
  v_cvt_pk_bf16_f32 v79, v28, v29
  v_exp_f32 v31, v31
  v_exp_f32 v32, v32
  v_cvt_pk_bf16_f32 v80, v30, v31
  v_exp_f32 v33, v33
  s_nop 0
  v_cvt_pk_bf16_f32 v81, v32, v33
  s_setprio 2
  v_mfma_f32_32x32x8bf16_1k v[18:33], v[98:99], v[92:93], 0
  v_exp_f32 v2, v2
  v_exp_f32 v3, v3
  v_exp_f32 v4, v4
  v_cvt_pk_bf16_f32 v66, v2, v3
  v_exp_f32 v5, v5
  v_exp_f32 v6, v6
  v_mfma_f32_32x32x16_bf16 v[18:33], v[94:97], v[86:89], v[18:33]
  ds_read_b32 v98, v113 offset:4224
  ds_read_b128 v[94:97], v109 offset:1024
  v_cvt_pk_bf16_f32 v67, v4, v5
  v_exp_f32 v7, v7
  v_exp_f32 v8, v8
  v_cvt_pk_bf16_f32 v68, v6, v7
  v_exp_f32 v9, v9
  v_exp_f32 v10, v10
  v_mfma_f32_32x32x16_bf16 v[50:65], v[100:103], v[74:77], v[50:65]
  v_cvt_pk_bf16_f32 v69, v8, v9
  v_exp_f32 v11, v11
  v_exp_f32 v12, v12
  v_cvt_pk_bf16_f32 v70, v10, v11
  v_exp_f32 v13, v13
  v_exp_f32 v14, v14
  v_mfma_f32_32x32x16_bf16 v[50:65], v[104:107], v[78:81], v[50:65]
  s_mov_b64 exec, s[34:35]
  ds_read_b128 v[100:103], v111 offset:6272
  ds_read_b128 v[104:107], v111 offset:6848
  s_mov_b64 exec, -1
  v_cvt_pk_bf16_f32 v71, v12, v13
  v_exp_f32 v15, v15
  v_exp_f32 v16, v16
  v_cvt_pk_bf16_f32 v72, v14, v15
  v_exp_f32 v17, v17
  s_nop 0
  v_cvt_pk_bf16_f32 v73, v16, v17
  s_waitcnt lgkmcnt(2)
  v_mfma_f32_32x32x8bf16_1k v[2:17], v[98:99], v[90:91], 0
  v_exp_f32 v18, v18
  v_exp_f32 v19, v19
  v_exp_f32 v20, v20
  v_cvt_pk_bf16_f32 v74, v18, v19
  v_exp_f32 v21, v21
  v_exp_f32 v22, v22
  v_mfma_f32_32x32x16_bf16 v[2:17], v[94:97], v[82:85], v[2:17]
  v_cvt_pk_bf16_f32 v75, v20, v21
  v_exp_f32 v23, v23
  v_exp_f32 v24, v24
  v_cvt_pk_bf16_f32 v76, v22, v23
  v_exp_f32 v25, v25
  v_exp_f32 v26, v26
  s_waitcnt lgkmcnt(0)
  v_mfma_f32_32x32x16_bf16 v[34:49], v[100:103], v[66:69], v[34:49]
  v_cvt_pk_bf16_f32 v77, v24, v25
  v_exp_f32 v27, v27
  v_exp_f32 v28, v28
  v_cvt_pk_bf16_f32 v78, v26, v27
  v_exp_f32 v29, v29
  v_exp_f32 v30, v30
  v_mfma_f32_32x32x16_bf16 v[34:49], v[104:107], v[70:73], v[34:49]
  v_cvt_pk_bf16_f32 v79, v28, v29
  v_exp_f32 v31, v31
  v_exp_f32 v32, v32
  v_cvt_pk_bf16_f32 v80, v30, v31
  v_exp_f32 v33, v33
  s_nop 0
  v_cvt_pk_bf16_f32 v81, v32, v33
  s_setprio 1
  v_mfma_f32_32x32x8bf16_1k v[18:33], v[98:99], v[92:93], 0
  v_exp_f32 v2, v2
  v_exp_f32 v3, v3
  v_exp_f32 v4, v4
  v_cvt_pk_bf16_f32 v66, v2, v3
  v_exp_f32 v5, v5
  v_exp_f32 v6, v6
  v_mfma_f32_32x32x16_bf16 v[18:33], v[94:97], v[86:89], v[18:33]
  ds_read_b32 v98, v113 offset:4352
  ds_read_b128 v[94:97], v109 offset:2048
  v_cvt_pk_bf16_f32 v67, v4, v5
  v_exp_f32 v7, v7
  v_exp_f32 v8, v8
  v_cvt_pk_bf16_f32 v68, v6, v7
  v_exp_f32 v9, v9
  v_exp_f32 v10, v10
  v_mfma_f32_32x32x16_bf16 v[50:65], v[100:103], v[74:77], v[50:65]
  v_cvt_pk_bf16_f32 v69, v8, v9
  v_exp_f32 v11, v11
  v_exp_f32 v12, v12
  v_cvt_pk_bf16_f32 v70, v10, v11
  v_exp_f32 v13, v13
  v_exp_f32 v14, v14
  v_mfma_f32_32x32x16_bf16 v[50:65], v[104:107], v[78:81], v[50:65]
  s_mov_b64 exec, s[34:35]
  ds_read_b128 v[100:103], v111 offset:7424
  ds_read_b128 v[104:107], v111 offset:8000
  s_mov_b64 exec, -1
  v_cvt_pk_bf16_f32 v71, v12, v13
  v_exp_f32 v15, v15
  v_exp_f32 v16, v16
  v_cvt_pk_bf16_f32 v72, v14, v15
  v_exp_f32 v17, v17
  s_nop 0
  v_cvt_pk_bf16_f32 v73, v16, v17
  s_waitcnt lgkmcnt(2)
  v_mfma_f32_32x32x8bf16_1k v[2:17], v[98:99], v[90:91], 0
  v_exp_f32 v18, v18
  v_exp_f32 v19, v19
  v_exp_f32 v20, v20
  v_cvt_pk_bf16_f32 v74, v18, v19
  v_exp_f32 v21, v21
  v_exp_f32 v22, v22
  v_mfma_f32_32x32x16_bf16 v[2:17], v[94:97], v[82:85], v[2:17]
  v_cvt_pk_bf16_f32 v75, v20, v21
  v_exp_f32 v23, v23
  v_exp_f32 v24, v24
  v_cvt_pk_bf16_f32 v76, v22, v23
  v_exp_f32 v25, v25
  v_exp_f32 v26, v26
  s_waitcnt lgkmcnt(0)
  v_mfma_f32_32x32x16_bf16 v[34:49], v[100:103], v[66:69], v[34:49]
  v_cvt_pk_bf16_f32 v77, v24, v25
  v_exp_f32 v27, v27
  v_exp_f32 v28, v28
  v_cvt_pk_bf16_f32 v78, v26, v27
  v_exp_f32 v29, v29
  v_exp_f32 v30, v30
  v_mfma_f32_32x32x16_bf16 v[34:49], v[104:107], v[70:73], v[34:49]
  v_cvt_pk_bf16_f32 v79, v28, v29
  v_exp_f32 v31, v31
  v_exp_f32 v32, v32
  v_cvt_pk_bf16_f32 v80, v30, v31
  v_exp_f32 v33, v33
  s_nop 0
  v_cvt_pk_bf16_f32 v81, v32, v33
  s_setprio 1
  v_mfma_f32_32x32x8bf16_1k v[18:33], v[98:99], v[92:93], 0
  v_exp_f32 v2, v2
  v_exp_f32 v3, v3
  v_exp_f32 v4, v4
  v_cvt_pk_bf16_f32 v66, v2, v3
  v_exp_f32 v5, v5
  v_exp_f32 v6, v6
  v_mfma_f32_32x32x16_bf16 v[18:33], v[94:97], v[86:89], v[18:33]
  ds_read_b32 v98, v113 offset:4480
  ds_read_b128 v[94:97], v109 offset:3072
  v_cvt_pk_bf16_f32 v67, v4, v5
  v_exp_f32 v7, v7
  v_exp_f32 v8, v8
  v_cvt_pk_bf16_f32 v68, v6, v7
  v_exp_f32 v9, v9
  v_exp_f32 v10, v10
  v_mfma_f32_32x32x16_bf16 v[50:65], v[100:103], v[74:77], v[50:65]
  v_cvt_pk_bf16_f32 v69, v8, v9
  v_exp_f32 v11, v11
  v_exp_f32 v12, v12
  v_cvt_pk_bf16_f32 v70, v10, v11
  v_exp_f32 v13, v13
  v_exp_f32 v14, v14
  v_mfma_f32_32x32x16_bf16 v[50:65], v[104:107], v[78:81], v[50:65]
  s_mov_b64 exec, s[34:35]
  ds_read_b128 v[100:103], v111 offset:8576
  ds_read_b128 v[104:107], v111 offset:9152
  s_mov_b64 exec, -1
  v_cvt_pk_bf16_f32 v71, v12, v13
  v_exp_f32 v15, v15
  v_exp_f32 v16, v16
  v_cvt_pk_bf16_f32 v72, v14, v15
  v_exp_f32 v17, v17
  s_nop 0
  v_cvt_pk_bf16_f32 v73, v16, v17
  s_waitcnt lgkmcnt(2)
  v_mfma_f32_32x32x8bf16_1k v[2:17], v[98:99], v[90:91], 0
  v_exp_f32 v18, v18
  v_exp_f32 v19, v19
  v_exp_f32 v20, v20
  v_cvt_pk_bf16_f32 v74, v18, v19
  v_exp_f32 v21, v21
  v_exp_f32 v22, v22
  v_mfma_f32_32x32x16_bf16 v[2:17], v[94:97], v[82:85], v[2:17]
  v_cvt_pk_bf16_f32 v75, v20, v21
  v_exp_f32 v23, v23
  v_exp_f32 v24, v24
  v_cvt_pk_bf16_f32 v76, v22, v23
  v_exp_f32 v25, v25
  v_exp_f32 v26, v26
  s_waitcnt lgkmcnt(0)
  v_mfma_f32_32x32x16_bf16 v[34:49], v[100:103], v[66:69], v[34:49]
  v_cvt_pk_bf16_f32 v77, v24, v25
  v_exp_f32 v27, v27
  v_exp_f32 v28, v28
  v_cvt_pk_bf16_f32 v78, v26, v27
  v_exp_f32 v29, v29
  v_exp_f32 v30, v30
  v_mfma_f32_32x32x16_bf16 v[34:49], v[104:107], v[70:73], v[34:49]
  v_cvt_pk_bf16_f32 v79, v28, v29
  v_exp_f32 v31, v31
  v_exp_f32 v32, v32
  v_cvt_pk_bf16_f32 v80, v30, v31
  v_exp_f32 v33, v33
  s_nop 0
  v_cvt_pk_bf16_f32 v81, v32, v33
  s_waitcnt vmcnt(0) lgkmcnt(0)
  s_barrier
  s_cmp_eq_u32 s36, 0
  s_cbranch_scc1 att_nodma_3
  s_add_u32 m0, s17, 0
  s_nop 0
  buffer_load_dwordx4 v115, s[4:7], s13 offen lds
  buffer_load_dwordx4 v116, s[4:7], s13 offen offset:1024 lds
  buffer_load_dwordx4 v117, s[4:7], s13 offen offset:2048 lds
  buffer_load_dwordx4 v118, s[4:7], s13 offen offset:3072 lds
  s_add_u32 m0, s17, 4096
  s_add_u32 s13, s13, s15
  buffer_load_dwordx4 v119, s[4:7], s14 offen lds
  s_add_u32 s14, s14, s16
att_nodma_3:
  s_setprio 3
  v_mfma_f32_32x32x8bf16_1k v[18:33], v[98:99], v[92:93], 0
  v_exp_f32 v2, v2
  v_exp_f32 v3, v3
  v_exp_f32 v4, v4
  v_cvt_pk_bf16_f32 v66, v2, v3
  v_exp_f32 v5, v5
  v_exp_f32 v6, v6
  v_mfma_f32_32x32x16_bf16 v[18:33], v[94:97], v[86:89], v[18:33]
  ds_read_b32 v98, v113 offset:24576
  ds_read_b128 v[94:97], v109 offset:20480
  v_cvt_pk_bf16_f32 v67, v4, v5
  v_exp_f32 v7, v7
  v_exp_f32 v8, v8
  v_cvt_pk_bf16_f32 v68, v6, v7
  v_exp_f32 v9, v9
  v_exp_f32 v10, v10
  v_mfma_f32_32x32x16_bf16 v[50:65], v[100:103], v[74:77], v[50:65]
  v_cvt_pk_bf16_f32 v69, v8, v9
  v_exp_f32 v11, v11
  v_exp_f32 v12, v12
  v_cvt_pk_bf16_f32 v70, v10, v11
  v_exp_f32 v13, v13
  v_exp_f32 v14, v14
  v_mfma_f32_32x32x16_bf16 v[50:65], v[104:107], v[78:81], v[50:65]
  s_mov_b64 exec, s[34:35]
  ds_read_b128 v[100:103], v111 offset:25600
  ds_read_b128 v[104:107], v111 offset:26176
  s_mov_b64 exec, -1
  v_cvt_pk_bf16_f32 v71, v12, v13
  v_exp_f32 v15, v15
  v_exp_f32 v16, v16
  v_cvt_pk_bf16_f32 v72, v14, v15
  v_exp_f32 v17, v17
  s_nop 0
  v_cvt_pk_bf16_f32 v73, v16, v17
  s_waitcnt lgkmcnt(2)
  v_mfma_f32_32x32x8bf16_1k v[2:17], v[98:99], v[90:91], 0
  v_exp_f32 v18, v18
  v_exp_f32 v19, v19
  v_exp_f32 v20, v20
  v_cvt_pk_bf16_f32 v74, v18, v19
  v_exp_f32 v21, v21
  v_exp_f32 v22, v22
  v_mfma_f32_32x32x16_bf16 v[2:17], v[94:97], v[82:85], v[2:17]
  v_cvt_pk_bf16_f32 v75, v20, v21
  v_exp_f32 v23, v23
  v_exp_f32 v24, v24
  v_cvt_pk_bf16_f32 v76, v22, v23
  v_exp_f32 v25, v25
  v_exp_f32 v26, v26
  s_waitcnt lgkmcnt(0)
  v_mfma_f32_32x32x16_bf16 v[34:49], v[100:103], v[66:69], v[34:49]
  v_cvt_pk_bf16_f32 v77, v24, v25
  v_exp_f32 v27, v27
  v_exp_f32 v28, v28
  v_cvt_pk_bf16_f32 v78, v26, v27
  v_exp_f32 v29, v29
  v_exp_f32 v30, v30
  v_mfma_f32_32x32x16_bf16 v[34:49], v[104:107], v[70:73], v[34:49]
  v_cvt_pk_bf16_f32 v79, v28, v29
  v_exp_f32 v31, v31
  v_exp_f32 v32, v32
  v_cvt_pk_bf16_f32 v80, v30, v31
  v_exp_f32 v33, v33
  s_nop 0
  v_cvt_pk_bf16_f32 v81, v32, v33
  s_setprio 2
  v_mfma_f32_32x32x8bf16_1k v[18:33], v[98:99], v[92:93], 0
  v_exp_f32 v2, v2
  v_exp_f32 v3, v3
  v_exp_f32 v4, v4
  v_cvt_pk_bf16_f32 v66, v2, v3
  v_exp_f32 v5, v5
  v_exp_f32 v6, v6
  v_mfma_f32_32x32x16_bf16 v[18:33], v[94:97], v[86:89], v[18:33]
  ds_read_b32 v98, v113 offset:24704
  ds_read_b128 v[94:97], v109 offset:21504
  v_cvt_pk_bf16_f32 v67, v4, v5
  v_exp_f32 v7, v7
  v_exp_f32 v8, v8
  v_cvt_pk_bf16_f32 v68, v6, v7
  v_exp_f32 v9, v9
  v_exp_f32 v10, v10
  v_mfma_f32_32x32x16_bf16 v[50:65], v[100:103], v[74:77], v[50:65]
  v_cvt_pk_bf16_f32 v69, v8, v9
  v_exp_f32 v11, v11
  v_exp_f32 v12, v12
  v_cvt_pk_bf16_f32 v70, v10, v11
  v_exp_f32 v13, v13
  v_exp_f32 v14, v14
  v_mfma_f32_32x32x16_bf16 v[50:65], v[104:107], v[78:81], v[50:65]
  s_mov_b64 exec, s[34:35]
  ds_read_b128 v[100:103], v111 offset:26752
  ds_read_b128 v[104:107], v111 offset:27328
  s_mov_b64 exec, -1
  v_cvt_pk_bf16_f32 v71, v12, v13
  v_exp_f32 v15, v15
  v_exp_f32 v16, v16
  v_cvt_pk_bf16_f32 v72, v14, v15
  v_exp_f32 v17, v17
  s_nop 0
  v_cvt_pk_bf16_f32 v73, v16, v17
  s_waitcnt lgkmcnt(2)
  v_mfma_f32_32x32x8bf16_1k v[2:17], v[98:99], v[90:91], 0
  v_exp_f32 v18, v18
  v_exp_f32 v19, v19
  v_exp_f32 v20, v20
  v_cvt_pk_bf16_f32 v74, v18, v19
  v_exp_f32 v21, v21
  v_exp_f32 v22, v22
  v_mfma_f32_32x32x16_bf16 v[2:17], v[94:97], v[82:85], v[2:17]
  v_cvt_pk_bf16_f32 v75, v20, v21
  v_exp_f32 v23, v23
  v_exp_f32 v24, v24
  v_cvt_pk_bf16_f32 v76, v22, v23
  v_exp_f32 v25, v25
  v_exp_f32 v26, v26
  s_waitcnt lgkmcnt(0)
  v_mfma_f32_32x32x16_bf16 v[34:49], v[100:103], v[66:69], v[34:49]
  v_cvt_pk_bf16_f32 v77, v24, v25
  v_exp_f32 v27, v27
  v_exp_f32 v28, v28
  v_cvt_pk_bf16_f32 v78, v26, v27
  v_exp_f32 v29, v29
  v_exp_f32 v30, v30
  v_mfma_f32_32x32x16_bf16 v[34:49], v[104:107], v[70:73], v[34:49]
  v_cvt_pk_bf16_f32 v79, v28, v29
  v_exp_f32 v31, v31
  v_exp_f32 v32, v32
  v_cvt_pk_bf16_f32 v80, v30, v31
  v_exp_f32 v33, v33
  s_nop 0
  v_cvt_pk_bf16_f32 v81, v32, v33
  s_setprio 1
  v_mfma_f32_32x32x8bf16_1k v[18:33], v[98:99], v[92:93], 0
  v_exp_f32 v2, v2
  v_exp_f32 v3, v3
  v_exp_f32 v4, v4
  v_cvt_pk_bf16_f32 v66, v2, v3
  v_exp_f32 v5, v5
  v_exp_f32 v6, v6
  v_mfma_f32_32x32x16_bf16 v[18:33], v[94:97], v[86:89], v[18:33]
  ds_read_b32 v98, v113 offset:24832
  ds_read_b128 v[94:97], v109 offset:22528
  v_cvt_pk_bf16_f32 v67, v4, v5
  v_exp_f32 v7, v7
  v_exp_f32 v8, v8
  v_cvt_pk_bf16_f32 v68, v6, v7
  v_exp_f32 v9, v9
  v_exp_f32 v10, v10
  v_mfma_f32_32x32x16_bf16 v[50:65], v[100:103], v[74:77], v[50:65]
  v_cvt_pk_bf16_f32 v69, v8, v9
  v_exp_f32 v11, v11
  v_exp_f32 v12, v12
  v_cvt_pk_bf16_f32 v70, v10, v11
  v_exp_f32 v13, v13
  v_exp_f32 v14, v14
  v_mfma_f32_32x32x16_bf16 v[50:65], v[104:107], v[78:81], v[50:65]
  s_mov_b64 exec, s[34:35]
  ds_read_b128 v[100:103], v111 offset:27904
  ds_read_b128 v[104:107], v111 offset:28480
  s_mov_b64 exec, -1
  v_cvt_pk_bf16_f32 v71, v12, v13
  v_exp_f32 v15, v15
  v_exp_f32 v16, v16
  v_cvt_pk_bf16_f32 v72, v14, v15
  v_exp_f32 v17, v17
  s_nop 0
  v_cvt_pk_bf16_f32 v73, v16, v17
  s_waitcnt lgkmcnt(2)
  v_mfma_f32_32x32x8bf16_1k v[2:17], v[98:99], v[90:91], 0
  v_exp_f32 v18, v18
  v_exp_f32 v19, v19
  v_exp_f32 v20, v20
  v_cvt_pk_bf16_f32 v74, v18, v19
  v_exp_f32 v21, v21
  v_exp_f32 v22, v22
  v_mfma_f32_32x32x16_bf16 v[2:17], v[94:97], v[82:85], v[2:17]
  v_cvt_pk_bf16_f32 v75, v20, v21
  v_exp_f32 v23, v23
  v_exp_f32 v24, v24
  v_cvt_pk_bf16_f32 v76, v22, v23
  v_exp_f32 v25, v25
  v_exp_f32 v26, v26
  s_waitcnt lgkmcnt(0)
  v_mfma_f32_32x32x16_bf16 v[34:49], v[100:103], v[66:69], v[34:49]
  v_cvt_pk_bf16_f32 v77, v24, v25
  v_exp_f32 v27, v27
  v_exp_f32 v28, v28
  v_cvt_pk_bf16_f32 v78, v26, v27
  v_exp_f32 v29, v29
  v_exp_f32 v30, v30
  v_mfma_f32_32x32x16_bf16 v[34:49], v[104:107], v[70:73], v[34:49]
  v_cvt_pk_bf16_f32 v79, v28, v29
  v_exp_f32 v31, v31
  v_exp_f32 v32, v32
  v_cvt_pk_bf16_f32 v80, v30, v31
  v_exp_f32 v33, v33
  s_nop 0
  v_cvt_pk_bf16_f32 v81, v32, v33
  s_setprio 1
  v_mfma_f32_32x32x8bf16_1k v[18:33], v[98:99], v[92:93], 0
  v_exp_f32 v2, v2
  v_exp_f32 v3, v3
  v_exp_f32 v4, v4
  v_cvt_pk_bf16_f32 v66, v2, v3
  v_exp_f32 v5, v5
  v_exp_f32 v6, v6
  v_mfma_f32_32x32x16_bf16 v[18:33], v[94:97], v[86:89], v[18:33]
  ds_read_b32 v98, v113 offset:24960
  ds_read_b128 v[94:97], v109 offset:23552
  v_cvt_pk_bf16_f32 v67, v4, v5
  v_exp_f32 v7, v7
  v_exp_f32 v8, v8
  v_cvt_pk_bf16_f32 v68, v6, v7
  v_exp_f32 v9, v9
  v_exp_f32 v10, v10
  v_mfma_f32_32x32x16_bf16 v[50:65], v[100:103], v[74:77], v[50:65]
  v_cvt_pk_bf16_f32 v69, v8, v9
  v_exp_f32 v11, v11
  v_exp_f32 v12, v12
  v_cvt_pk_bf16_f32 v70, v10, v11
  v_exp_f32 v13, v13
  v_exp_f32 v14, v14
  v_mfma_f32_32x32x16_bf16 v[50:65], v[104:107], v[78:81], v[50:65]
  s_mov_b64 exec, s[34:35]
  ds_read_b128 v[100:103], v111 offset:29056
  ds_read_b128 v[104:107], v111 offset:29632
  s_mov_b64 exec, -1
  v_cvt_pk_bf16_f32 v71, v12, v13
  v_exp_f32 v15, v15
  v_exp_f32 v16, v16
  v_cvt_pk_bf16_f32 v72, v14, v15
  v_exp_f32 v17, v17
  s_nop 0
  v_cvt_pk_bf16_f32 v73, v16, v17
  s_waitcnt lgkmcnt(2)
  v_mfma_f32_32x32x8bf16_1k v[2:17], v[98:99], v[90:91], 0
  v_exp_f32 v18, v18
  v_exp_f32 v19, v19
  v_exp_f32 v20, v20
  v_cvt_pk_bf16_f32 v74, v18, v19
  v_exp_f32 v21, v21
  v_exp_f32 v22, v22
  v_mfma_f32_32x32x16_bf16 v[2:17], v[94:97], v[82:85], v[2:17]
  v_cvt_pk_bf16_f32 v75, v20, v21
  v_exp_f32 v23, v23
  v_exp_f32 v24, v24
  v_cvt_pk_bf16_f32 v76, v22, v23
  v_exp_f32 v25, v25
  v_exp_f32 v26, v26
  s_waitcnt lgkmcnt(0)
  v_mfma_f32_32x32x16_bf16 v[34:49], v[100:103], v[66:69], v[34:49]
  v_cvt_pk_bf16_f32 v77, v24, v25
  v_exp_f32 v27, v27
  v_exp_f32 v28, v28
  v_cvt_pk_bf16_f32 v78, v26, v27
  v_exp_f32 v29, v29
  v_exp_f32 v30, v30
  v_mfma_f32_32x32x16_bf16 v[34:49], v[104:107], v[70:73], v[34:49]
  v_cvt_pk_bf16_f32 v79, v28, v29
  v_exp_f32 v31, v31
  v_exp_f32 v32, v32
  v_cvt_pk_bf16_f32 v80, v30, v31
  v_exp_f32 v33, v33
  s_nop 0
  v_cvt_pk_bf16_f32 v81, v32, v33
  s_waitcnt vmcnt(0) lgkmcnt(0)
  s_barrier
  s_cmp_eq_u32 s36, 0
  s_cbranch_scc1 att_nodma_4
  s_add_u32 m0, s17, 20480
  s_nop 0
  buffer_load_dwordx4 v115, s[4:7], s13 offen lds
  buffer_load_dwordx4 v116, s[4:7], s13 offen offset:1024 lds
  buffer_load_dwordx4 v117, s[4:7], s13 offen offset:2048 lds
  buffer_load_dwordx4 v118, s[4:7], s13 offen offset:3072 lds
  s_add_u32 m0, s17, 24576
  s_add_u32 s13, s13, s15
  buffer_load_dwordx4 v119, s[4:7], s14 offen lds
  s_add_u32 s14, s14, s16
att_nodma_4:
  s_setprio 3
  v_mfma_f32_32x32x8bf16_1k v[18:33], v[98:99], v[92:93], 0
  v_exp_f32 v2, v2
  v_exp_f32 v3, v3
  v_exp_f32 v4, v4
  v_cvt_pk_bf16_f32 v66, v2, v3
  v_exp_f32 v5, v5
  v_exp_f32 v6, v6
  v_mfma_f32_32x32x16_bf16 v[18:33], v[94:97], v[86:89], v[18:33]
  ds_read_b32 v98, v113 offset:4096
  ds_read_b128 v[94:97], v109 offset:0
  v_cvt_pk_bf16_f32 v67, v4, v5
  v_exp_f32 v7, v7
  v_exp_f32 v8, v8
  v_cvt_pk_bf16_f32 v68, v6, v7
  v_exp_f32 v9, v9
  v_exp_f32 v10, v10
  v_mfma_f32_32x32x16_bf16 v[50:65], v[100:103], v[74:77], v[50:65]
  v_cvt_pk_bf16_f32 v69, v8, v9
  v_exp_f32 v11, v11
  v_exp_f32 v12, v12
  v_cvt_pk_bf16_f32 v70, v10, v11
  v_exp_f32 v13, v13
  v_exp_f32 v14, v14
  v_mfma_f32_32x32x16_bf16 v[50:65], v[104:107], v[78:81], v[50:65]
  s_mov_b64 exec, s[34:35]
  ds_read_b128 v[100:103], v111 offset:5120
  ds_read_b128 v[104:107], v111 offset:5696
  s_mov_b64 exec, -1
  v_cvt_pk_bf16_f32 v71, v12, v13
  v_exp_f32 v15, v15
  v_exp_f32 v16, v16
  v_cvt_pk_bf16_f32 v72, v14, v15
  v_exp_f32 v17, v17
  s_nop 0
  v_cvt_pk_bf16_f32 v73, v16, v17
  s_waitcnt lgkmcnt(2)
  v_mfma_f32_32x32x8bf16_1k v[2:17], v[98:99], v[90:91], 0
  v_exp_f32 v18, v18
  v_exp_f32 v19, v19
  v_exp_f32 v20, v20
  v_cvt_pk_bf16_f32 v74, v18, v19
  v_exp_f32 v21, v21
  v_exp_f32 v22, v22
  v_mfma_f32_32x32x16_bf16 v[2:17], v[94:97], v[82:85], v[2:17]
  v_cvt_pk_bf16_f32 v75, v20, v21
  v_exp_f32 v23, v23
  v_exp_f32 v24, v24
  v_cvt_pk_bf16_f32 v76, v22, v23
  v_exp_f32 v25, v25
  v_exp_f32 v26, v26
  s_waitcnt lgkmcnt(0)
  v_mfma_f32_32x32x16_bf16 v[34:49], v[100:103], v[66:69], v[34:49]
  v_cvt_pk_bf16_f32 v77, v24, v25
  v_exp_f32 v27, v27
  v_exp_f32 v28, v28
  v_cvt_pk_bf16_f32 v78, v26, v27
  v_exp_f32 v29, v29
  v_exp_f32 v30, v30
  v_mfma_f32_32x32x16_bf16 v[34:49], v[104:107], v[70:73], v[34:49]
  v_cvt_pk_bf16_f32 v79, v28, v29
  v_exp_f32 v31, v31
  v_exp_f32 v32, v32
  v_cvt_pk_bf16_f32 v80, v30, v31
  v_exp_f32 v33, v33
  s_nop 0
  v_cvt_pk_bf16_f32 v81, v32, v33
  s_setprio 2
  v_mfma_f32_32x32x8bf16_1k v[18:33], v[98:99], v[92:93], 0
  v_exp_f32 v2, v2
  v_exp_f32 v3, v3
  v_exp_f32 v4, v4
  v_cvt_pk_bf16_f32 v66, v2, v3
  v_exp_f32 v5, v5
  v_exp_f32 v6, v6
  v_mfma_f32_32x32x16_bf16 v[18:33], v[94:97], v[86:89], v[18:33]
  ds_read_b32 v98, v113 offset:4224
  ds_read_b128 v[94:97], v109 offset:1024
  v_cvt_pk_bf16_f32 v67, v4, v5
  v_exp_f32 v7, v7
  v_exp_f32 v8, v8
  v_cvt_pk_bf16_f32 v68, v6, v7
  v_exp_f32 v9, v9
  v_exp_f32 v10, v10
  v_mfma_f32_32x32x16_bf16 v[50:65], v[100:103], v[74:77], v[50:65]
  v_cvt_pk_bf16_f32 v69, v8, v9
  v_exp_f32 v11, v11
  v_exp_f32 v12, v12
  v_cvt_pk_bf16_f32 v70, v10, v11
  v_exp_f32 v13, v13
  v_exp_f32 v14, v14
  v_mfma_f32_32x32x16_bf16 v[50:65], v[104:107], v[78:81], v[50:65]
  s_mov_b64 exec, s[34:35]
  ds_read_b128 v[100:103], v111 offset:6272
  ds_read_b128 v[104:107], v111 offset:6848
  s_mov_b64 exec, -1
  v_cvt_pk_bf16_f32 v71, v12, v13
  v_exp_f32 v15, v15
  v_exp_f32 v16, v16
  v_cvt_pk_bf16_f32 v72, v14, v15
  v_exp_f32 v17, v17
  s_nop 0
  v_cvt_pk_bf16_f32 v73, v16, v17
  s_waitcnt lgkmcnt(2)
  v_mfma_f32_32x32x8bf16_1k v[2:17], v[98:99], v[90:91], 0
  v_exp_f32 v18, v18
  v_exp_f32 v19, v19
  v_exp_f32 v20, v20
  v_cvt_pk_bf16_f32 v74, v18, v19
  v_exp_f32 v21, v21
  v_exp_f32 v22, v22
  v_mfma_f32_32x32x16_bf16 v[2:17], v[94:97], v[82:85], v[2:17]
  v_cvt_pk_bf16_f32 v75, v20, v21
  v_exp_f32 v23, v23
  v_exp_f32 v24, v24
  v_cvt_pk_bf16_f32 v76, v22, v23
  v_exp_f32 v25, v25
  v_exp_f32 v26, v26
  s_waitcnt lgkmcnt(0)
  v_mfma_f32_32x32x16_bf16 v[34:49], v[100:103], v[66:69], v[34:49]
  v_cvt_pk_bf16_f32 v77, v24, v25
  v_exp_f32 v27, v27
  v_exp_f32 v28, v28
  v_cvt_pk_bf16_f32 v78, v26, v27
  v_exp_f32 v29, v29
  v_exp_f32 v30, v30
  v_mfma_f32_32x32x16_bf16 v[34:49], v[104:107], v[70:73], v[34:49]
  v_cvt_pk_bf16_f32 v79, v28, v29
  v_exp_f32 v31, v31
  v_exp_f32 v32, v32
  v_cvt_pk_bf16_f32 v80, v30, v31
  v_exp_f32 v33, v33
  s_nop 0
  v_cvt_pk_bf16_f32 v81, v32, v33
  s_setprio 1
  v_mfma_f32_32x32x8bf16_1k v[18:33], v[98:99], v[92:93], 0
  v_exp_f32 v2, v2
  v_exp_f32 v3, v3
  v_exp_f32 v4, v4
  v_cvt_pk_bf16_f32 v66, v2, v3
  v_exp_f32 v5, v5
  v_exp_f32 v6, v6
  v_mfma_f32_32x32x16_bf16 v[18:33], v[94:97], v[86:89], v[18:33]
  ds_read_b32 v98, v113 offset:4352
  ds_read_b128 v[94:97], v109 offset:2048
  v_cvt_pk_bf16_f32 v67, v4, v5
  v_exp_f32 v7, v7
  v_exp_f32 v8, v8
  v_cvt_pk_bf16_f32 v68, v6, v7
  v_exp_f32 v9, v9
  v_exp_f32 v10, v10
  v_mfma_f32_32x32x16_bf16 v[50:65], v[100:103], v[74:77], v[50:65]
  v_cvt_pk_bf16_f32 v69, v8, v9
  v_exp_f32 v11, v11
  v_exp_f32 v12, v12
  v_cvt_pk_bf16_f32 v70, v10, v11
  v_exp_f32 v13, v13
  v_exp_f32 v14, v14
  v_mfma_f32_32x32x16_bf16 v[50:65], v[104:107], v[78:81], v[50:65]
  s_mov_b64 exec, s[34:35]
  ds_read_b128 v[100:103], v111 offset:7424
  ds_read_b128 v[104:107], v111 offset:8000
  s_mov_b64 exec, -1
  v_cvt_pk_bf16_f32 v71, v12, v13
  v_exp_f32 v15, v15
  v_exp_f32 v16, v16
  v_cvt_pk_bf16_f32 v72, v14, v15
  v_exp_f32 v17, v17
  s_nop 0
  v_cvt_pk_bf16_f32 v73, v16, v17
  s_waitcnt lgkmcnt(2)
  v_mfma_f32_32x32x8bf16_1k v[2:17], v[98:99], v[90:91], 0
  v_exp_f32 v18, v18
  v_exp_f32 v19, v19
  v_exp_f32 v20, v20
  v_cvt_pk_bf16_f32 v74, v18, v19
  v_exp_f32 v21, v21
  v_exp_f32 v22, v22
  v_mfma_f32_32x32x16_bf16 v[2:17], v[94:97], v[82:85], v[2:17]
  v_cvt_pk_bf16_f32 v75, v20, v21
  v_exp_f32 v23, v23
  v_exp_f32 v24, v24
  v_cvt_pk_bf16_f32 v76, v22, v23
  v_exp_f32 v25, v25
  v_exp_f32 v26, v26
  s_waitcnt lgkmcnt(0)
  v_mfma_f32_32x32x16_bf16 v[34:49], v[100:103], v[66:69], v[34:49]
  v_cvt_pk_bf16_f32 v77, v24, v25
  v_exp_f32 v27, v27
  v_exp_f32 v28, v28
  v_cvt_pk_bf16_f32 v78, v26, v27
  v_exp_f32 v29, v29
  v_exp_f32 v30, v30
  v_mfma_f32_32x32x16_bf16 v[34:49], v[104:107], v[70:73], v[34:49]
  v_cvt_pk_bf16_f32 v79, v28, v29
  v_exp_f32 v31, v31
  v_exp_f32 v32, v32
  v_cvt_pk_bf16_f32 v80, v30, v31
  v_exp_f32 v33, v33
  s_nop 0
  v_cvt_pk_bf16_f32 v81, v32, v33
  s_setprio 1
  v_mfma_f32_32x32x8bf16_1k v[18:33], v[98:99], v[92:93], 0
  v_exp_f32 v2, v2
  v_exp_f32 v3, v3
  v_exp_f32 v4, v4
  v_cvt_pk_bf16_f32 v66, v2, v3
  v_exp_f32 v5, v5
  v_exp_f32 v6, v6
  v_mfma_f32_32x32x16_bf16 v[18:33], v[94:97], v[86:89], v[18:33]
  ds_read_b32 v98, v113 offset:4480
  ds_read_b128 v[94:97], v109 offset:3072
  v_cvt_pk_bf16_f32 v67, v4, v5
  v_exp_f32 v7, v7
  v_exp_f32 v8, v8
  v_cvt_pk_bf16_f32 v68, v6, v7
  v_exp_f32 v9, v9
  v_exp_f32 v10, v10
  v_mfma_f32_32x32x16_bf16 v[50:65], v[100:103], v[74:77], v[50:65]
  v_cvt_pk_bf16_f32 v69, v8, v9
  v_exp_f32 v11, v11
  v_exp_f32 v12, v12
  v_cvt_pk_bf16_f32 v70, v10, v11
  v_exp_f32 v13, v13
  v_exp_f32 v14, v14
  v_mfma_f32_32x32x16_bf16 v[50:65], v[104:107], v[78:81], v[50:65]
  s_mov_b64 exec, s[34:35]
  ds_read_b128 v[100:103], v111 offset:8576
  ds_read_b128 v[104:107], v111 offset:9152
  s_mov_b64 exec, -1
  v_cvt_pk_bf16_f32 v71, v12, v13
  v_exp_f32 v15, v15
  v_exp_f32 v16, v16
  v_cvt_pk_bf16_f32 v72, v14, v15
  v_exp_f32 v17, v17
  s_nop 0
  v_cvt_pk_bf16_f32 v73, v16, v17
  s_waitcnt lgkmcnt(2)
  v_mfma_f32_32x32x8bf16_1k v[2:17], v[98:99], v[90:91], 0
  v_exp_f32 v18, v18
  v_exp_f32 v19, v19
  v_exp_f32 v20, v20
  v_cvt_pk_bf16_f32 v74, v18, v19
  v_exp_f32 v21, v21
  v_exp_f32 v22, v22
  v_mfma_f32_32x32x16_bf16 v[2:17], v[94:97], v[82:85], v[2:17]
  v_cvt_pk_bf16_f32 v75, v20, v21
  v_exp_f32 v23, v23
  v_exp_f32 v24, v24
  v_cvt_pk_bf16_f32 v76, v22, v23
  v_exp_f32 v25, v25
  v_exp_f32 v26, v26
  s_waitcnt lgkmcnt(0)
  v_mfma_f32_32x32x16_bf16 v[34:49], v[100:103], v[66:69], v[34:49]
  v_cvt_pk_bf16_f32 v77, v24, v25
  v_exp_f32 v27, v27
  v_exp_f32 v28, v28
  v_cvt_pk_bf16_f32 v78, v26, v27
  v_exp_f32 v29, v29
  v_exp_f32 v30, v30
  v_mfma_f32_32x32x16_bf16 v[34:49], v[104:107], v[70:73], v[34:49]
  v_cvt_pk_bf16_f32 v79, v28, v29
  v_exp_f32 v31, v31
  v_exp_f32 v32, v32
  v_cvt_pk_bf16_f32 v80, v30, v31
  v_exp_f32 v33, v33
  s_nop 0
  v_cvt_pk_bf16_f32 v81, v32, v33
  s_waitcnt vmcnt(0) lgkmcnt(0)
  s_barrier
  s_cmp_eq_u32 s36, 0
  s_cbranch_scc1 att_nodma_5
  s_add_u32 m0, s17, 0
  s_nop 0
  buffer_load_dwordx4 v115, s[4:7], s13 offen lds
  buffer_load_dwordx4 v116, s[4:7], s13 offen offset:1024 lds
  buffer_load_dwordx4 v117, s[4:7], s13 offen offset:2048 lds
  buffer_load_dwordx4 v118, s[4:7], s13 offen offset:3072 lds
  s_add_u32 m0, s17, 4096
  s_add_u32 s13, s13, s15
  buffer_load_dwordx4 v119, s[4:7], s14 offen lds
  s_add_u32 s14, s14, s16
att_nodma_5:
  s_setprio 3
  v_mfma_f32_32x32x8bf16_1k v[18:33], v[98:99], v[92:93], 0
  v_exp_f32 v2, v2
  v_exp_f32 v3, v3
  v_exp_f32 v4, v4
  v_cvt_pk_bf16_f32 v66, v2, v3
  v_exp_f32 v5, v5
  v_exp_f32 v6, v6
  v_mfma_f32_32x32x16_bf16 v[18:33], v[94:97], v[86:89], v[18:33]
  ds_read_b32 v98, v113 offset:24576
  ds_read_b128 v[94:97], v109 offset:20480
  v_cvt_pk_bf16_f32 v67, v4, v5
  v_exp_f32 v7, v7
  v_exp_f32 v8, v8
  v_cvt_pk_bf16_f32 v68, v6, v7
  v_exp_f32 v9, v9
  v_exp_f32 v10, v10
  v_mfma_f32_32x32x16_bf16 v[50:65], v[100:103], v[74:77], v[50:65]
  v_cvt_pk_bf16_f32 v69, v8, v9
  v_exp_f32 v11, v11
  v_exp_f32 v12, v12
  v_cvt_pk_bf16_f32 v70, v10, v11
  v_exp_f32 v13, v13
  v_exp_f32 v14, v14
  v_mfma_f32_32x32x16_bf16 v[50:65], v[104:107], v[78:81], v[50:65]
  s_mov_b64 exec, s[34:35]
  ds_read_b128 v[100:103], v111 offset:25600
  ds_read_b128 v[104:107], v111 offset:26176
  s_mov_b64 exec, -1
  v_cvt_pk_bf16_f32 v71, v12, v13
  v_exp_f32 v15, v15
  v_exp_f32 v16, v16
  v_cvt_pk_bf16_f32 v72, v14, v15
  v_exp_f32 v17, v17
  s_nop 0
  v_cvt_pk_bf16_f32 v73, v16, v17
  s_waitcnt lgkmcnt(2)
  v_mfma_f32_32x32x8bf16_1k v[2:17], v[98:99], v[90:91], 0
  v_exp_f32 v18, v18
  v_exp_f32 v19, v19
  v_exp_f32 v20, v20
  v_cvt_pk_bf16_f32 v74, v18, v19
  v_exp_f32 v21, v21
  v_exp_f32 v22, v22
  v_mfma_f32_32x32x16_bf16 v[2:17], v[94:97], v[82:85], v[2:17]
  v_cvt_pk_bf16_f32 v75, v20, v21
  v_exp_f32 v23, v23
  v_exp_f32 v24, v24
  v_cvt_pk_bf16_f32 v76, v22, v23
  v_exp_f32 v25, v25
  v_exp_f32 v26, v26
  s_waitcnt lgkmcnt(0)
  v_mfma_f32_32x32x16_bf16 v[34:49], v[100:103], v[66:69], v[34:49]
  v_cvt_pk_bf16_f32 v77, v24, v25
  v_exp_f32 v27, v27
  v_exp_f32 v28, v28
  v_cvt_pk_bf16_f32 v78, v26, v27
  v_exp_f32 v29, v29
  v_exp_f32 v30, v30
  v_mfma_f32_32x32x16_bf16 v[34:49], v[104:107], v[70:73], v[34:49]
  v_cvt_pk_bf16_f32 v79, v28, v29
  v_exp_f32 v31, v31
  v_exp_f32 v32, v32
  v_cvt_pk_bf16_f32 v80, v30, v31
  v_exp_f32 v33, v33
  s_nop 0
  v_cvt_pk_bf16_f32 v81, v32, v33
  s_setprio 2
  v_mfma_f32_32x32x8bf16_1k v[18:33], v[98:99], v[92:93], 0
  v_exp_f32 v2, v2
  v_exp_f32 v3, v3
  v_exp_f32 v4, v4
  v_cvt_pk_bf16_f32 v66, v2, v3
  v_exp_f32 v5, v5
  v_exp_f32 v6, v6
  v_mfma_f32_32x32x16_bf16 v[18:33], v[94:97], v[86:89], v[18:33]
  ds_read_b32 v98, v113 offset:24704
  ds_read_b128 v[94:97], v109 offset:21504
  v_cvt_pk_bf16_f32 v67, v4, v5
  v_exp_f32 v7, v7
  v_exp_f32 v8, v8
  v_cvt_pk_bf16_f32 v68, v6, v7
  v_exp_f32 v9, v9
  v_exp_f32 v10, v10
  v_mfma_f32_32x32x16_bf16 v[50:65], v[100:103], v[74:77], v[50:65]
  v_cvt_pk_bf16_f32 v69, v8, v9
  v_exp_f32 v11, v11
  v_exp_f32 v12, v12
  v_cvt_pk_bf16_f32 v70, v10, v11
  v_exp_f32 v13, v13
  v_exp_f32 v14, v14
  v_mfma_f32_32x32x16_bf16 v[50:65], v[104:107], v[78:81], v[50:65]
  s_mov_b64 exec, s[34:35]
  ds_read_b128 v[100:103], v111 offset:26752
  ds_read_b128 v[104:107], v111 offset:27328
  s_mov_b64 exec, -1
  v_cvt_pk_bf16_f32 v71, v12, v13
  v_exp_f32 v15, v15
  v_exp_f32 v16, v16
  v_cvt_pk_bf16_f32 v72, v14, v15
  v_exp_f32 v17, v17
  s_nop 0
  v_cvt_pk_bf16_f32 v73, v16, v17
  s_waitcnt lgkmcnt(2)
  v_mfma_f32_32x32x8bf16_1k v[2:17], v[98:99], v[90:91], 0
  v_exp_f32 v18, v18
  v_exp_f32 v19, v19
  v_exp_f32 v20, v20
  v_cvt_pk_bf16_f32 v74, v18, v19
  v_exp_f32 v21, v21
  v_exp_f32 v22, v22
  v_mfma_f32_32x32x16_bf16 v[2:17], v[94:97], v[82:85], v[2:17]
  v_cvt_pk_bf16_f32 v75, v20, v21
  v_exp_f32 v23, v23
  v_exp_f32 v24, v24
  v_cvt_pk_bf16_f32 v76, v22, v23
  v_exp_f32 v25, v25
  v_exp_f32 v26, v26
  s_waitcnt lgkmcnt(0)
  v_mfma_f32_32x32x16_bf16 v[34:49], v[100:103], v[66:69], v[34:49]
  v_cvt_pk_bf16_f32 v77, v24, v25
  v_exp_f32 v27, v27
  v_exp_f32 v28, v28
  v_cvt_pk_bf16_f32 v78, v26, v27
  v_exp_f32 v29, v29
  v_exp_f32 v30, v30
  v_mfma_f32_32x32x16_bf16 v[34:49], v[104:107], v[70:73], v[34:49]
  v_cvt_pk_bf16_f32 v79, v28, v29
  v_exp_f32 v31, v31
  v_exp_f32 v32, v32
  v_cvt_pk_bf16_f32 v80, v30, v31
  v_exp_f32 v33, v33
  s_nop 0
  v_cvt_pk_bf16_f32 v81, v32, v33
  s_setprio 1
  v_mfma_f32_32x32x8bf16_1k v[18:33], v[98:99], v[92:93], 0
  v_exp_f32 v2, v2
  v_exp_f32 v3, v3
  v_exp_f32 v4, v4
  v_cvt_pk_bf16_f32 v66, v2, v3
  v_exp_f32 v5, v5
  v_exp_f32 v6, v6
  v_mfma_f32_32x32x16_bf16 v[18:33], v[94:97], v[86:89], v[18:33]
  ds_read_b32 v98, v113 offset:24832
  ds_read_b128 v[94:97], v109 offset:22528
  v_cvt_pk_bf16_f32 v67, v4, v5
  v_exp_f32 v7, v7
  v_exp_f32 v8, v8
  v_cvt_pk_bf16_f32 v68, v6, v7
  v_exp_f32 v9, v9
  v_exp_f32 v10, v10
  v_mfma_f32_32x32x16_bf16 v[50:65], v[100:103], v[74:77], v[50:65]
  v_cvt_pk_bf16_f32 v69, v8, v9
  v_exp_f32 v11, v11
  v_exp_f32 v12, v12
  v_cvt_pk_bf16_f32 v70, v10, v11
  v_exp_f32 v13, v13
  v_exp_f32 v14, v14
  v_mfma_f32_32x32x16_bf16 v[50:65], v[104:107], v[78:81], v[50:65]
  s_mov_b64 exec, s[34:35]
  ds_read_b128 v[100:103], v111 offset:27904
  ds_read_b128 v[104:107], v111 offset:28480
  s_mov_b64 exec, -1
  v_cvt_pk_bf16_f32 v71, v12, v13
  v_exp_f32 v15, v15
  v_exp_f32 v16, v16
  v_cvt_pk_bf16_f32 v72, v14, v15
  v_exp_f32 v17, v17
  s_nop 0
  v_cvt_pk_bf16_f32 v73, v16, v17
  s_waitcnt lgkmcnt(2)
  v_mfma_f32_32x32x8bf16_1k v[2:17], v[98:99], v[90:91], 0
  v_exp_f32 v18, v18
  v_exp_f32 v19, v19
  v_exp_f32 v20, v20
  v_cvt_pk_bf16_f32 v74, v18, v19
  v_exp_f32 v21, v21
  v_exp_f32 v22, v22
  v_mfma_f32_32x32x16_bf16 v[2:17], v[94:97], v[82:85], v[2:17]
  v_cvt_pk_bf16_f32 v75, v20, v21
  v_exp_f32 v23, v23
  v_exp_f32 v24, v24
  v_cvt_pk_bf16_f32 v76, v22, v23
  v_exp_f32 v25, v25
  v_exp_f32 v26, v26
  s_waitcnt lgkmcnt(0)
  v_mfma_f32_32x32x16_bf16 v[34:49], v[100:103], v[66:69], v[34:49]
  v_cvt_pk_bf16_f32 v77, v24, v25
  v_exp_f32 v27, v27
  v_exp_f32 v28, v28
  v_cvt_pk_bf16_f32 v78, v26, v27
  v_exp_f32 v29, v29
  v_exp_f32 v30, v30
  v_mfma_f32_32x32x16_bf16 v[34:49], v[104:107], v[70:73], v[34:49]
  v_cvt_pk_bf16_f32 v79, v28, v29
  v_exp_f32 v31, v31
  v_exp_f32 v32, v32
  v_cvt_pk_bf16_f32 v80, v30, v31
  v_exp_f32 v33, v33
  s_nop 0
  v_cvt_pk_bf16_f32 v81, v32, v33
  s_setprio 1
  v_mfma_f32_32x32x8bf16_1k v[18:33], v[98:99], v[92:93], 0
  v_exp_f32 v2, v2
  v_exp_f32 v3, v3
  v_exp_f32 v4, v4
  v_cvt_pk_bf16_f32 v66, v2, v3
  v_exp_f32 v5, v5
  v_exp_f32 v6, v6
  v_mfma_f32_32x32x16_bf16 v[18:33], v[94:97], v[86:89], v[18:33]
  ds_read_b32 v98, v113 offset:24960
  ds_read_b128 v[94:97], v109 offset:23552
  v_cvt_pk_bf16_f32 v67, v4, v5
  v_exp_f32 v7, v7
  v_exp_f32 v8, v8
  v_cvt_pk_bf16_f32 v68, v6, v7
  v_exp_f32 v9, v9
  v_exp_f32 v10, v10
  v_mfma_f32_32x32x16_bf16 v[50:65], v[100:103], v[74:77], v[50:65]
  v_cvt_pk_bf16_f32 v69, v8, v9
  v_exp_f32 v11, v11
  v_exp_f32 v12, v12
  v_cvt_pk_bf16_f32 v70, v10, v11
  v_exp_f32 v13, v13
  v_exp_f32 v14, v14
  v_mfma_f32_32x32x16_bf16 v[50:65], v[104:107], v[78:81], v[50:65]
  s_mov_b64 exec, s[34:35]
  ds_read_b128 v[100:103], v111 offset:29056
  ds_read_b128 v[104:107], v111 offset:29632
  s_mov_b64 exec, -1
  v_cvt_pk_bf16_f32 v71, v12, v13
  v_exp_f32 v15, v15
  v_exp_f32 v16, v16
  v_cvt_pk_bf16_f32 v72, v14, v15
  v_exp_f32 v17, v17
  s_nop 0
  v_cvt_pk_bf16_f32 v73, v16, v17
  s_waitcnt lgkmcnt(2)
  v_mfma_f32_32x32x8bf16_1k v[2:17], v[98:99], v[90:91], 0
  v_exp_f32 v18, v18
  v_exp_f32 v19, v19
  v_exp_f32 v20, v20
  v_cvt_pk_bf16_f32 v74, v18, v19
  v_exp_f32 v21, v21
  v_exp_f32 v22, v22
  v_mfma_f32_32x32x16_bf16 v[2:17], v[94:97], v[82:85], v[2:17]
  v_cvt_pk_bf16_f32 v75, v20, v21
  v_exp_f32 v23, v23
  v_exp_f32 v24, v24
  v_cvt_pk_bf16_f32 v76, v22, v23
  v_exp_f32 v25, v25
  v_exp_f32 v26, v26
  s_waitcnt lgkmcnt(0)
  v_mfma_f32_32x32x16_bf16 v[34:49], v[100:103], v[66:69], v[34:49]
  v_cvt_pk_bf16_f32 v77, v24, v25
  v_exp_f32 v27, v27
  v_exp_f32 v28, v28
  v_cvt_pk_bf16_f32 v78, v26, v27
  v_exp_f32 v29, v29
  v_exp_f32 v30, v30
  v_mfma_f32_32x32x16_bf16 v[34:49], v[104:107], v[70:73], v[34:49]
  v_cvt_pk_bf16_f32 v79, v28, v29
  v_exp_f32 v31, v31
  v_exp_f32 v32, v32
  v_cvt_pk_bf16_f32 v80, v30, v31
  v_exp_f32 v33, v33
  s_nop 0
  v_cvt_pk_bf16_f32 v81, v32, v33
  s_waitcnt vmcnt(0) lgkmcnt(0)
  s_barrier
  s_cmp_eq_u32 s36, 0
  s_cbranch_scc1 att_nodma_6
  s_add_u32 m0, s17, 20480
  s_nop 0
  buffer_load_dwordx4 v115, s[4:7], s13 offen lds
  buffer_load_dwordx4 v116, s[4:7], s13 offen offset:1024 lds
  buffer_load_dwordx4 v117, s[4:7], s13 offen offset:2048 lds
  buffer_load_dwordx4 v118, s[4:7], s13 offen offset:3072 lds
  s_add_u32 m0, s17, 24576
  s_add_u32 s13, s13, s15
  buffer_load_dwordx4 v119, s[4:7], s14 offen lds
  s_add_u32 s14, s14, s16
att_nodma_6:
  s_setprio 3
  v_mfma_f32_32x32x8bf16_1k v[18:33], v[98:99], v[92:93], 0
  v_exp_f32 v2, v2
  v_exp_f32 v3, v3
  v_exp_f32 v4, v4
  v_cvt_pk_bf16_f32 v66, v2, v3
  v_exp_f32 v5, v5
  v_exp_f32 v6, v6
  v_mfma_f32_32x32x16_bf16 v[18:33], v[94:97], v[86:89], v[18:33]
  ds_read_b32 v98, v113 offset:4096
  ds_read_b128 v[94:97], v109 offset:0
  v_cvt_pk_bf16_f32 v67, v4, v5
  v_exp_f32 v7, v7
  v_exp_f32 v8, v8
  v_cvt_pk_bf16_f32 v68, v6, v7
  v_exp_f32 v9, v9
  v_exp_f32 v10, v10
  v_mfma_f32_32x32x16_bf16 v[50:65], v[100:103], v[74:77], v[50:65]
  v_cvt_pk_bf16_f32 v69, v8, v9
  v_exp_f32 v11, v11
  v_exp_f32 v12, v12
  v_cvt_pk_bf16_f32 v70, v10, v11
  v_exp_f32 v13, v13
  v_exp_f32 v14, v14
  v_mfma_f32_32x32x16_bf16 v[50:65], v[104:107], v[78:81], v[50:65]
  s_mov_b64 exec, s[34:35]
  ds_read_b128 v[100:103], v111 offset:5120
  ds_read_b128 v[104:107], v111 offset:5696
  s_mov_b64 exec, -1
  v_cvt_pk_bf16_f32 v71, v12, v13
  v_exp_f32 v15, v15
  v_exp_f32 v16, v16
  v_cvt_pk_bf16_f32 v72, v14, v15
  v_exp_f32 v17, v17
  s_nop 0
  v_cvt_pk_bf16_f32 v73, v16, v17
  s_waitcnt lgkmcnt(2)
  v_mfma_f32_32x32x8bf16_1k v[2:17], v[98:99], v[90:91], 0
  v_exp_f32 v18, v18
  v_exp_f32 v19, v19
  v_exp_f32 v20, v20
  v_cvt_pk_bf16_f32 v74, v18, v19
  v_exp_f32 v21, v21
  v_exp_f32 v22, v22
  v_mfma_f32_32x32x16_bf16 v[2:17], v[94:97], v[82:85], v[2:17]
  v_cvt_pk_bf16_f32 v75, v20, v21
  v_exp_f32 v23, v23
  v_exp_f32 v24, v24
  v_cvt_pk_bf16_f32 v76, v22, v23
  v_exp_f32 v25, v25
  v_exp_f32 v26, v26
  s_waitcnt lgkmcnt(0)
  v_mfma_f32_32x32x16_bf16 v[34:49], v[100:103], v[66:69], v[34:49]
  v_cvt_pk_bf16_f32 v77, v24, v25
  v_exp_f32 v27, v27
  v_exp_f32 v28, v28
  v_cvt_pk_bf16_f32 v78, v26, v27
  v_exp_f32 v29, v29
  v_exp_f32 v30, v30
  v_mfma_f32_32x32x16_bf16 v[34:49], v[104:107], v[70:73], v[34:49]
  v_cvt_pk_bf16_f32 v79, v28, v29
  v_exp_f32 v31, v31
  v_exp_f32 v32, v32
  v_cvt_pk_bf16_f32 v80, v30, v31
  v_exp_f32 v33, v33
  s_nop 0
  v_cvt_pk_bf16_f32 v81, v32, v33
  s_setprio 2
  v_mfma_f32_32x32x8bf16_1k v[18:33], v[98:99], v[92:93], 0
  v_exp_f32 v2, v2
  v_exp_f32 v3, v3
  v_exp_f32 v4, v4
  v_cvt_pk_bf16_f32 v66, v2, v3
  v_exp_f32 v5, v5
  v_exp_f32 v6, v6
  v_mfma_f32_32x32x16_bf16 v[18:33], v[94:97], v[86:89], v[18:33]
  ds_read_b32 v98, v113 offset:4224
  ds_read_b128 v[94:97], v109 offset:1024
  v_cvt_pk_bf16_f32 v67, v4, v5
  v_exp_f32 v7, v7
  v_exp_f32 v8, v8
  v_cvt_pk_bf16_f32 v68, v6, v7
  v_exp_f32 v9, v9
  v_exp_f32 v10, v10
  v_mfma_f32_32x32x16_bf16 v[50:65], v[100:103], v[74:77], v[50:65]
  v_cvt_pk_bf16_f32 v69, v8, v9
  v_exp_f32 v11, v11
  v_exp_f32 v12, v12
  v_cvt_pk_bf16_f32 v70, v10, v11
  v_exp_f32 v13, v13
  v_exp_f32 v14, v14
  v_mfma_f32_32x32x16_bf16 v[50:65], v[104:107], v[78:81], v[50:65]
  s_mov_b64 exec, s[34:35]
  ds_read_b128 v[100:103], v111 offset:6272
  ds_read_b128 v[104:107], v111 offset:6848
  s_mov_b64 exec, -1
  v_cvt_pk_bf16_f32 v71, v12, v13
  v_exp_f32 v15, v15
  v_exp_f32 v16, v16
  v_cvt_pk_bf16_f32 v72, v14, v15
  v_exp_f32 v17, v17
  s_nop 0
  v_cvt_pk_bf16_f32 v73, v16, v17
  s_waitcnt lgkmcnt(2)
  v_mfma_f32_32x32x8bf16_1k v[2:17], v[98:99], v[90:91], 0
  v_exp_f32 v18, v18
  v_exp_f32 v19, v19
  v_exp_f32 v20, v20
  v_cvt_pk_bf16_f32 v74, v18, v19
  v_exp_f32 v21, v21
  v_exp_f32 v22, v22
  v_mfma_f32_32x32x16_bf16 v[2:17], v[94:97], v[82:85], v[2:17]
  v_cvt_pk_bf16_f32 v75, v20, v21
  v_exp_f32 v23, v23
  v_exp_f32 v24, v24
  v_cvt_pk_bf16_f32 v76, v22, v23
  v_exp_f32 v25, v25
  v_exp_f32 v26, v26
  s_waitcnt lgkmcnt(0)
  v_mfma_f32_32x32x16_bf16 v[34:49], v[100:103], v[66:69], v[34:49]
  v_cvt_pk_bf16_f32 v77, v24, v25
  v_exp_f32 v27, v27
  v_exp_f32 v28, v28
  v_cvt_pk_bf16_f32 v78, v26, v27
  v_exp_f32 v29, v29
  v_exp_f32 v30, v30
  v_mfma_f32_32x32x16_bf16 v[34:49], v[104:107], v[70:73], v[34:49]
  v_cvt_pk_bf16_f32 v79, v28, v29
  v_exp_f32 v31, v31
  v_exp_f32 v32, v32
  v_cvt_pk_bf16_f32 v80, v30, v31
  v_exp_f32 v33, v33
  s_nop 0
  v_cvt_pk_bf16_f32 v81, v32, v33
  s_setprio 1
  v_mfma_f32_32x32x8bf16_1k v[18:33], v[98:99], v[92:93], 0
  v_exp_f32 v2, v2
  v_exp_f32 v3, v3
  v_exp_f32 v4, v4
  v_cvt_pk_bf16_f32 v66, v2, v3
  v_exp_f32 v5, v5
  v_exp_f32 v6, v6
  v_mfma_f32_32x32x16_bf16 v[18:33], v[94:97], v[86:89], v[18:33]
  ds_read_b32 v98, v113 offset:4352
  ds_read_b128 v[94:97], v109 offset:2048
  v_cvt_pk_bf16_f32 v67, v4, v5
  v_exp_f32 v7, v7
  v_exp_f32 v8, v8
  v_cvt_pk_bf16_f32 v68, v6, v7
  v_exp_f32 v9, v9
  v_exp_f32 v10, v10
  v_mfma_f32_32x32x16_bf16 v[50:65], v[100:103], v[74:77], v[50:65]
  v_cvt_pk_bf16_f32 v69, v8, v9
  v_exp_f32 v11, v11
  v_exp_f32 v12, v12
  v_cvt_pk_bf16_f32 v70, v10, v11
  v_exp_f32 v13, v13
  v_exp_f32 v14, v14
  v_mfma_f32_32x32x16_bf16 v[50:65], v[104:107], v[78:81], v[50:65]
  s_mov_b64 exec, s[34:35]
  ds_read_b128 v[100:103], v111 offset:7424
  ds_read_b128 v[104:107], v111 offset:8000
  s_mov_b64 exec, -1
  v_cvt_pk_bf16_f32 v71, v12, v13
  v_exp_f32 v15, v15
  v_exp_f32 v16, v16
  v_cvt_pk_bf16_f32 v72, v14, v15
  v_exp_f32 v17, v17
  s_nop 0
  v_cvt_pk_bf16_f32 v73, v16, v17
  s_waitcnt lgkmcnt(2)
  v_mfma_f32_32x32x8bf16_1k v[2:17], v[98:99], v[90:91], 0
  v_exp_f32 v18, v18
  v_exp_f32 v19, v19
  v_exp_f32 v20, v20
  v_cvt_pk_bf16_f32 v74, v18, v19
  v_exp_f32 v21, v21
  v_exp_f32 v22, v22
  v_mfma_f32_32x32x16_bf16 v[2:17], v[94:97], v[82:85], v[2:17]
  v_cvt_pk_bf16_f32 v75, v20, v21
  v_exp_f32 v23, v23
  v_exp_f32 v24, v24
  v_cvt_pk_bf16_f32 v76, v22, v23
  v_exp_f32 v25, v25
  v_exp_f32 v26, v26
  s_waitcnt lgkmcnt(0)
  v_mfma_f32_32x32x16_bf16 v[34:49], v[100:103], v[66:69], v[34:49]
  v_cvt_pk_bf16_f32 v77, v24, v25
  v_exp_f32 v27, v27
  v_exp_f32 v28, v28
  v_cvt_pk_bf16_f32 v78, v26, v27
  v_exp_f32 v29, v29
  v_exp_f32 v30, v30
  v_mfma_f32_32x32x16_bf16 v[34:49], v[104:107], v[70:73], v[34:49]
  v_cvt_pk_bf16_f32 v79, v28, v29
  v_exp_f32 v31, v31
  v_exp_f32 v32, v32
  v_cvt_pk_bf16_f32 v80, v30, v31
  v_exp_f32 v33, v33
  s_nop 0
  v_cvt_pk_bf16_f32 v81, v32, v33
  s_setprio 1
  v_mfma_f32_32x32x8bf16_1k v[18:33], v[98:99], v[92:93], 0
  v_exp_f32 v2, v2
  v_exp_f32 v3, v3
  v_exp_f32 v4, v4
  v_cvt_pk_bf16_f32 v66, v2, v3
  v_exp_f32 v5, v5
  v_exp_f32 v6, v6
  v_mfma_f32_32x32x16_bf16 v[18:33], v[94:97], v[86:89], v[18:33]
  ds_read_b32 v98, v113 offset:4480
  ds_read_b128 v[94:97], v109 offset:3072
  v_cvt_pk_bf16_f32 v67, v4, v5
  v_exp_f32 v7, v7
  v_exp_f32 v8, v8
  v_cvt_pk_bf16_f32 v68, v6, v7
  v_exp_f32 v9, v9
  v_exp_f32 v10, v10
  v_mfma_f32_32x32x16_bf16 v[50:65], v[100:103], v[74:77], v[50:65]
  v_cvt_pk_bf16_f32 v69, v8, v9
  v_exp_f32 v11, v11
  v_exp_f32 v12, v12
  v_cvt_pk_bf16_f32 v70, v10, v11
  v_exp_f32 v13, v13
  v_exp_f32 v14, v14
  v_mfma_f32_32x32x16_bf16 v[50:65], v[104:107], v[78:81], v[50:65]
  s_mov_b64 exec, s[34:35]
  ds_read_b128 v[100:103], v111 offset:8576
  ds_read_b128 v[104:107], v111 offset:9152
  s_mov_b64 exec, -1
  v_cvt_pk_bf16_f32 v71, v12, v13
  v_exp_f32 v15, v15
  v_exp_f32 v16, v16
  v_cvt_pk_bf16_f32 v72, v14, v15
  v_exp_f32 v17, v17
  s_nop 0
  v_cvt_pk_bf16_f32 v73, v16, v17
  s_waitcnt lgkmcnt(2)
  v_mfma_f32_32x32x8bf16_1k v[2:17], v[98:99], v[90:91], 0
  v_exp_f32 v18, v18
  v_exp_f32 v19, v19
  v_exp_f32 v20, v20
  v_cvt_pk_bf16_f32 v74, v18, v19
  v_exp_f32 v21, v21
  v_exp_f32 v22, v22
  v_mfma_f32_32x32x16_bf16 v[2:17], v[94:97], v[82:85], v[2:17]
  v_cvt_pk_bf16_f32 v75, v20, v21
  v_exp_f32 v23, v23
  v_exp_f32 v24, v24
  v_cvt_pk_bf16_f32 v76, v22, v23
  v_exp_f32 v25, v25
  v_exp_f32 v26, v26
  s_waitcnt lgkmcnt(0)
  v_mfma_f32_32x32x16_bf16 v[34:49], v[100:103], v[66:69], v[34:49]
  v_cvt_pk_bf16_f32 v77, v24, v25
  v_exp_f32 v27, v27
  v_exp_f32 v28, v28
  v_cvt_pk_bf16_f32 v78, v26, v27
  v_exp_f32 v29, v29
  v_exp_f32 v30, v30
  v_mfma_f32_32x32x16_bf16 v[34:49], v[104:107], v[70:73], v[34:49]
  v_cvt_pk_bf16_f32 v79, v28, v29
  v_exp_f32 v31, v31
  v_exp_f32 v32, v32
  v_cvt_pk_bf16_f32 v80, v30, v31
  v_exp_f32 v33, v33
  s_nop 0
  v_cvt_pk_bf16_f32 v81, v32, v33
  s_waitcnt vmcnt(0) lgkmcnt(0)
  s_barrier
  s_cmp_eq_u32 s36, 0
  s_cbranch_scc1 att_nodma_7
  s_add_u32 m0, s17, 0
  s_nop 0
  buffer_load_dwordx4 v115, s[4:7], s13 offen lds
  buffer_load_dwordx4 v116, s[4:7], s13 offen offset:1024 lds
  buffer_load_dwordx4 v117, s[4:7], s13 offen offset:2048 lds
  buffer_load_dwordx4 v118, s[4:7], s13 offen offset:3072 lds
  s_add_u32 m0, s17, 4096
  s_add_u32 s13, s13, s15
  buffer_load_dwordx4 v119, s[4:7], s14 offen lds
  s_add_u32 s14, s14, s16
att_nodma_7:
  s_setprio 3
  v_mfma_f32_32x32x8bf16_1k v[18:33], v[98:99], v[92:93], 0
  v_exp_f32 v2, v2
  v_exp_f32 v3, v3
  v_exp_f32 v4, v4
  v_cvt_pk_bf16_f32 v66, v2, v3
  v_exp_f32 v5, v5
  v_exp_f32 v6, v6
  v_mfma_f32_32x32x16_bf16 v[18:33], v[94:97], v[86:89], v[18:33]
  ds_read_b32 v98, v113 offset:24576
  ds_read_b128 v[94:97], v109 offset:20480
  v_cvt_pk_bf16_f32 v67, v4, v5
  v_exp_f32 v7, v7
  v_exp_f32 v8, v8
  v_cvt_pk_bf16_f32 v68, v6, v7
  v_exp_f32 v9, v9
  v_exp_f32 v10, v10
  v_mfma_f32_32x32x16_bf16 v[50:65], v[100:103], v[74:77], v[50:65]
  v_cvt_pk_bf16_f32 v69, v8, v9
  v_exp_f32 v11, v11
  v_exp_f32 v12, v12
  v_cvt_pk_bf16_f32 v70, v10, v11
  v_exp_f32 v13, v13
  v_exp_f32 v14, v14
  v_mfma_f32_32x32x16_bf16 v[50:65], v[104:107], v[78:81], v[50:65]
  s_mov_b64 exec, s[34:35]
  ds_read_b128 v[100:103], v111 offset:25600
  ds_read_b128 v[104:107], v111 offset:26176
  s_mov_b64 exec, -1
  v_cvt_pk_bf16_f32 v71, v12, v13
  v_exp_f32 v15, v15
  v_exp_f32 v16, v16
  v_cvt_pk_bf16_f32 v72, v14, v15
  v_exp_f32 v17, v17
  s_nop 0
  v_cvt_pk_bf16_f32 v73, v16, v17
  s_waitcnt lgkmcnt(2)
  v_mfma_f32_32x32x8bf16_1k v[2:17], v[98:99], v[90:91], 0
  v_exp_f32 v18, v18
  v_exp_f32 v19, v19
  v_exp_f32 v20, v20
  v_cvt_pk_bf16_f32 v74, v18, v19
  v_exp_f32 v21, v21
  v_exp_f32 v22, v22
  v_mfma_f32_32x32x16_bf16 v[2:17], v[94:97], v[82:85], v[2:17]
  v_cvt_pk_bf16_f32 v75, v20, v21
  v_exp_f32 v23, v23
  v_exp_f32 v24, v24
  v_cvt_pk_bf16_f32 v76, v22, v23
  v_exp_f32 v25, v25
  v_exp_f32 v26, v26
  s_waitcnt lgkmcnt(0)
  v_mfma_f32_32x32x16_bf16 v[34:49], v[100:103], v[66:69], v[34:49]
  v_cvt_pk_bf16_f32 v77, v24, v25
  v_exp_f32 v27, v27
  v_exp_f32 v28, v28
  v_cvt_pk_bf16_f32 v78, v26, v27
  v_exp_f32 v29, v29
  v_exp_f32 v30, v30
  v_mfma_f32_32x32x16_bf16 v[34:49], v[104:107], v[70:73], v[34:49]
  v_cvt_pk_bf16_f32 v79, v28, v29
  v_exp_f32 v31, v31
  v_exp_f32 v32, v32
  v_cvt_pk_bf16_f32 v80, v30, v31
  v_exp_f32 v33, v33
  s_nop 0
  v_cvt_pk_bf16_f32 v81, v32, v33
  s_setprio 2
  v_mfma_f32_32x32x8bf16_1k v[18:33], v[98:99], v[92:93], 0
  v_exp_f32 v2, v2
  v_exp_f32 v3, v3
  v_exp_f32 v4, v4
  v_cvt_pk_bf16_f32 v66, v2, v3
  v_exp_f32 v5, v5
  v_exp_f32 v6, v6
  v_mfma_f32_32x32x16_bf16 v[18:33], v[94:97], v[86:89], v[18:33]
  ds_read_b32 v98, v113 offset:24704
  ds_read_b128 v[94:97], v109 offset:21504
  v_cvt_pk_bf16_f32 v67, v4, v5
  v_exp_f32 v7, v7
  v_exp_f32 v8, v8
  v_cvt_pk_bf16_f32 v68, v6, v7
  v_exp_f32 v9, v9
  v_exp_f32 v10, v10
  v_mfma_f32_32x32x16_bf16 v[50:65], v[100:103], v[74:77], v[50:65]
  v_cvt_pk_bf16_f32 v69, v8, v9
  v_exp_f32 v11, v11
  v_exp_f32 v12, v12
  v_cvt_pk_bf16_f32 v70, v10, v11
  v_exp_f32 v13, v13
  v_exp_f32 v14, v14
  v_mfma_f32_32x32x16_bf16 v[50:65], v[104:107], v[78:81], v[50:65]
  s_mov_b64 exec, s[34:35]
  ds_read_b128 v[100:103], v111 offset:26752
  ds_read_b128 v[104:107], v111 offset:27328
  s_mov_b64 exec, -1
  v_cvt_pk_bf16_f32 v71, v12, v13
  v_exp_f32 v15, v15
  v_exp_f32 v16, v16
  v_cvt_pk_bf16_f32 v72, v14, v15
  v_exp_f32 v17, v17
  s_nop 0
  v_cvt_pk_bf16_f32 v73, v16, v17
  s_waitcnt lgkmcnt(2)
  v_mfma_f32_32x32x8bf16_1k v[2:17], v[98:99], v[90:91], 0
  v_exp_f32 v18, v18
  v_exp_f32 v19, v19
  v_exp_f32 v20, v20
  v_cvt_pk_bf16_f32 v74, v18, v19
  v_exp_f32 v21, v21
  v_exp_f32 v22, v22
  v_mfma_f32_32x32x16_bf16 v[2:17], v[94:97], v[82:85], v[2:17]
  v_cvt_pk_bf16_f32 v75, v20, v21
  v_exp_f32 v23, v23
  v_exp_f32 v24, v24
  v_cvt_pk_bf16_f32 v76, v22, v23
  v_exp_f32 v25, v25
  v_exp_f32 v26, v26
  s_waitcnt lgkmcnt(0)
  v_mfma_f32_32x32x16_bf16 v[34:49], v[100:103], v[66:69], v[34:49]
  v_cvt_pk_bf16_f32 v77, v24, v25
  v_exp_f32 v27, v27
  v_exp_f32 v28, v28
  v_cvt_pk_bf16_f32 v78, v26, v27
  v_exp_f32 v29, v29
  v_exp_f32 v30, v30
  v_mfma_f32_32x32x16_bf16 v[34:49], v[104:107], v[70:73], v[34:49]
  v_cvt_pk_bf16_f32 v79, v28, v29
  v_exp_f32 v31, v31
  v_exp_f32 v32, v32
  v_cvt_pk_bf16_f32 v80, v30, v31
  v_exp_f32 v33, v33
  s_nop 0
  v_cvt_pk_bf16_f32 v81, v32, v33
  s_setprio 1
  v_mfma_f32_32x32x8bf16_1k v[18:33], v[98:99], v[92:93], 0
  v_exp_f32 v2, v2
  v_exp_f32 v3, v3
  v_exp_f32 v4, v4
  v_cvt_pk_bf16_f32 v66, v2, v3
  v_exp_f32 v5, v5
  v_exp_f32 v6, v6
  v_mfma_f32_32x32x16_bf16 v[18:33], v[94:97], v[86:89], v[18:33]
  ds_read_b32 v98, v113 offset:24832
  ds_read_b128 v[94:97], v109 offset:22528
  v_cvt_pk_bf16_f32 v67, v4, v5
  v_exp_f32 v7, v7
  v_exp_f32 v8, v8
  v_cvt_pk_bf16_f32 v68, v6, v7
  v_exp_f32 v9, v9
  v_exp_f32 v10, v10
  v_mfma_f32_32x32x16_bf16 v[50:65], v[100:103], v[74:77], v[50:65]
  v_cvt_pk_bf16_f32 v69, v8, v9
  v_exp_f32 v11, v11
  v_exp_f32 v12, v12
  v_cvt_pk_bf16_f32 v70, v10, v11
  v_exp_f32 v13, v13
  v_exp_f32 v14, v14
  v_mfma_f32_32x32x16_bf16 v[50:65], v[104:107], v[78:81], v[50:65]
  s_mov_b64 exec, s[34:35]
  ds_read_b128 v[100:103], v111 offset:27904
  ds_read_b128 v[104:107], v111 offset:28480
  s_mov_b64 exec, -1
  v_cvt_pk_bf16_f32 v71, v12, v13
  v_exp_f32 v15, v15
  v_exp_f32 v16, v16
  v_cvt_pk_bf16_f32 v72, v14, v15
  v_exp_f32 v17, v17
  s_nop 0
  v_cvt_pk_bf16_f32 v73, v16, v17
  s_waitcnt lgkmcnt(2)
  v_mfma_f32_32x32x8bf16_1k v[2:17], v[98:99], v[90:91], 0
  v_exp_f32 v18, v18
  v_exp_f32 v19, v19
  v_exp_f32 v20, v20
  v_cvt_pk_bf16_f32 v74, v18, v19
  v_exp_f32 v21, v21
  v_exp_f32 v22, v22
  v_mfma_f32_32x32x16_bf16 v[2:17], v[94:97], v[82:85], v[2:17]
  v_cvt_pk_bf16_f32 v75, v20, v21
  v_exp_f32 v23, v23
  v_exp_f32 v24, v24
  v_cvt_pk_bf16_f32 v76, v22, v23
  v_exp_f32 v25, v25
  v_exp_f32 v26, v26
  s_waitcnt lgkmcnt(0)
  v_mfma_f32_32x32x16_bf16 v[34:49], v[100:103], v[66:69], v[34:49]
  v_cvt_pk_bf16_f32 v77, v24, v25
  v_exp_f32 v27, v27
  v_exp_f32 v28, v28
  v_cvt_pk_bf16_f32 v78, v26, v27
  v_exp_f32 v29, v29
  v_exp_f32 v30, v30
  v_mfma_f32_32x32x16_bf16 v[34:49], v[104:107], v[70:73], v[34:49]
  v_cvt_pk_bf16_f32 v79, v28, v29
  v_exp_f32 v31, v31
  v_exp_f32 v32, v32
  v_cvt_pk_bf16_f32 v80, v30, v31
  v_exp_f32 v33, v33
  s_nop 0
  v_cvt_pk_bf16_f32 v81, v32, v33
  s_setprio 1
  v_mfma_f32_32x32x8bf16_1k v[18:33], v[98:99], v[92:93], 0
  v_exp_f32 v2, v2
  v_exp_f32 v3, v3
  v_exp_f32 v4, v4
  v_cvt_pk_bf16_f32 v66, v2, v3
  v_exp_f32 v5, v5
  v_exp_f32 v6, v6
  v_mfma_f32_32x32x16_bf16 v[18:33], v[94:97], v[86:89], v[18:33]
  ds_read_b32 v98, v113 offset:24960
  ds_read_b128 v[94:97], v109 offset:23552
  v_cvt_pk_bf16_f32 v67, v4, v5
  v_exp_f32 v7, v7
  v_exp_f32 v8, v8
  v_cvt_pk_bf16_f32 v68, v6, v7
  v_exp_f32 v9, v9
  v_exp_f32 v10, v10
  v_mfma_f32_32x32x16_bf16 v[50:65], v[100:103], v[74:77], v[50:65]
  v_cvt_pk_bf16_f32 v69, v8, v9
  v_exp_f32 v11, v11
  v_exp_f32 v12, v12
  v_cvt_pk_bf16_f32 v70, v10, v11
  v_exp_f32 v13, v13
  v_exp_f32 v14, v14
  v_mfma_f32_32x32x16_bf16 v[50:65], v[104:107], v[78:81], v[50:65]
  s_mov_b64 exec, s[34:35]
  ds_read_b128 v[100:103], v111 offset:29056
  ds_read_b128 v[104:107], v111 offset:29632
  s_mov_b64 exec, -1
  v_cvt_pk_bf16_f32 v71, v12, v13
  v_exp_f32 v15, v15
  v_exp_f32 v16, v16
  v_cvt_pk_bf16_f32 v72, v14, v15
  v_exp_f32 v17, v17
  s_nop 0
  v_cvt_pk_bf16_f32 v73, v16, v17
  s_waitcnt lgkmcnt(2)
  v_mfma_f32_32x32x8bf16_1k v[2:17], v[98:99], v[90:91], 0
  v_exp_f32 v18, v18
  v_exp_f32 v19, v19
  v_exp_f32 v20, v20
  v_cvt_pk_bf16_f32 v74, v18, v19
  v_exp_f32 v21, v21
  v_exp_f32 v22, v22
  v_mfma_f32_32x32x16_bf16 v[2:17], v[94:97], v[82:85], v[2:17]
  v_cvt_pk_bf16_f32 v75, v20, v21
  v_exp_f32 v23, v23
  v_exp_f32 v24, v24
  v_cvt_pk_bf16_f32 v76, v22, v23
  v_exp_f32 v25, v25
  v_exp_f32 v26, v26
  s_waitcnt lgkmcnt(0)
  v_mfma_f32_32x32x16_bf16 v[34:49], v[100:103], v[66:69], v[34:49]
  v_cvt_pk_bf16_f32 v77, v24, v25
  v_exp_f32 v27, v27
  v_exp_f32 v28, v28
  v_cvt_pk_bf16_f32 v78, v26, v27
  v_exp_f32 v29, v29
  v_exp_f32 v30, v30
  v_mfma_f32_32x32x16_bf16 v[34:49], v[104:107], v[70:73], v[34:49]
  v_cvt_pk_bf16_f32 v79, v28, v29
  v_exp_f32 v31, v31
  v_exp_f32 v32, v32
  v_cvt_pk_bf16_f32 v80, v30, v31
  v_exp_f32 v33, v33
  s_nop 0
  v_cvt_pk_bf16_f32 v81, v32, v33
  s_waitcnt vmcnt(0) lgkmcnt(0)
  s_barrier
  s_cmp_eq_u32 s36, 0
  s_cbranch_scc1 att_nodma_8
  s_add_u32 m0, s17, 20480
  s_nop 0
  buffer_load_dwordx4 v115, s[4:7], s13 offen lds
  buffer_load_dwordx4 v116, s[4:7], s13 offen offset:1024 lds
  buffer_load_dwordx4 v117, s[4:7], s13 offen offset:2048 lds
  buffer_load_dwordx4 v118, s[4:7], s13 offen offset:3072 lds
  s_add_u32 m0, s17, 24576
  s_add_u32 s13, s13, s15
  buffer_load_dwordx4 v119, s[4:7], s14 offen lds
  s_add_u32 s14, s14, s16
att_nodma_8:
  s_setprio 3
  v_mfma_f32_32x32x8bf16_1k v[18:33], v[98:99], v[92:93], 0
  v_exp_f32 v2, v2
  v_exp_f32 v3, v3
  v_exp_f32 v4, v4
  v_cvt_pk_bf16_f32 v66, v2, v3
  v_exp_f32 v5, v5
  v_exp_f32 v6, v6
  v_mfma_f32_32x32x16_bf16 v[18:33], v[94:97], v[86:89], v[18:33]
  ds_read_b32 v98, v113 offset:4096
  ds_read_b128 v[94:97], v109 offset:0
  v_cvt_pk_bf16_f32 v67, v4, v5
  v_exp_f32 v7, v7
  v_exp_f32 v8, v8
  v_cvt_pk_bf16_f32 v68, v6, v7
  v_exp_f32 v9, v9
  v_exp_f32 v10, v10
  v_mfma_f32_32x32x16_bf16 v[50:65], v[100:103], v[74:77], v[50:65]
  v_cvt_pk_bf16_f32 v69, v8, v9
  v_exp_f32 v11, v11
  v_exp_f32 v12, v12
  v_cvt_pk_bf16_f32 v70, v10, v11
  v_exp_f32 v13, v13
  v_exp_f32 v14, v14
  v_mfma_f32_32x32x16_bf16 v[50:65], v[104:107], v[78:81], v[50:65]
  s_mov_b64 exec, s[34:35]
  ds_read_b128 v[100:103], v111 offset:5120
  ds_read_b128 v[104:107], v111 offset:5696
  s_mov_b64 exec, -1
  v_cvt_pk_bf16_f32 v71, v12, v13
  v_exp_f32 v15, v15
  v_exp_f32 v16, v16
  v_cvt_pk_bf16_f32 v72, v14, v15
  v_exp_f32 v17, v17
  s_nop 0
  v_cvt_pk_bf16_f32 v73, v16, v17
  s_waitcnt lgkmcnt(2)
  v_mfma_f32_32x32x8bf16_1k v[2:17], v[98:99], v[90:91], 0
  v_exp_f32 v18, v18
  v_exp_f32 v19, v19
  v_exp_f32 v20, v20
  v_cvt_pk_bf16_f32 v74, v18, v19
  v_exp_f32 v21, v21
  v_exp_f32 v22, v22
  v_mfma_f32_32x32x16_bf16 v[2:17], v[94:97], v[82:85], v[2:17]
  v_cvt_pk_bf16_f32 v75, v20, v21
  v_exp_f32 v23, v23
  v_exp_f32 v24, v24
  v_cvt_pk_bf16_f32 v76, v22, v23
  v_exp_f32 v25, v25
  v_exp_f32 v26, v26
  s_waitcnt lgkmcnt(0)
  v_mfma_f32_32x32x16_bf16 v[34:49], v[100:103], v[66:69], v[34:49]
  v_cvt_pk_bf16_f32 v77, v24, v25
  v_exp_f32 v27, v27
  v_exp_f32 v28, v28
  v_cvt_pk_bf16_f32 v78, v26, v27
  v_exp_f32 v29, v29
  v_exp_f32 v30, v30
  v_mfma_f32_32x32x16_bf16 v[34:49], v[104:107], v[70:73], v[34:49]
  v_cvt_pk_bf16_f32 v79, v28, v29
  v_exp_f32 v31, v31
  v_exp_f32 v32, v32
  v_cvt_pk_bf16_f32 v80, v30, v31
  v_exp_f32 v33, v33
  s_nop 0
  v_cvt_pk_bf16_f32 v81, v32, v33
  s_setprio 2
  v_mfma_f32_32x32x8bf16_1k v[18:33], v[98:99], v[92:93], 0
  v_exp_f32 v2, v2
  v_exp_f32 v3, v3
  v_exp_f32 v4, v4
  v_cvt_pk_bf16_f32 v66, v2, v3
  v_exp_f32 v5, v5
  v_exp_f32 v6, v6
  v_mfma_f32_32x32x16_bf16 v[18:33], v[94:97], v[86:89], v[18:33]
  ds_read_b32 v98, v113 offset:4224
  ds_read_b128 v[94:97], v109 offset:1024
  v_cvt_pk_bf16_f32 v67, v4, v5
  v_exp_f32 v7, v7
  v_exp_f32 v8, v8
  v_cvt_pk_bf16_f32 v68, v6, v7
  v_exp_f32 v9, v9
  v_exp_f32 v10, v10
  v_mfma_f32_32x32x16_bf16 v[50:65], v[100:103], v[74:77], v[50:65]
  v_cvt_pk_bf16_f32 v69, v8, v9
  v_exp_f32 v11, v11
  v_exp_f32 v12, v12
  v_cvt_pk_bf16_f32 v70, v10, v11
  v_exp_f32 v13, v13
  v_exp_f32 v14, v14
  v_mfma_f32_32x32x16_bf16 v[50:65], v[104:107], v[78:81], v[50:65]
  s_mov_b64 exec, s[34:35]
  ds_read_b128 v[100:103], v111 offset:6272
  ds_read_b128 v[104:107], v111 offset:6848
  s_mov_b64 exec, -1
  v_cvt_pk_bf16_f32 v71, v12, v13
  v_exp_f32 v15, v15
  v_exp_f32 v16, v16
  v_cvt_pk_bf16_f32 v72, v14, v15
  v_exp_f32 v17, v17
  s_nop 0
  v_cvt_pk_bf16_f32 v73, v16, v17
  s_waitcnt lgkmcnt(2)
  v_mfma_f32_32x32x8bf16_1k v[2:17], v[98:99], v[90:91], 0
  v_exp_f32 v18, v18
  v_exp_f32 v19, v19
  v_exp_f32 v20, v20
  v_cvt_pk_bf16_f32 v74, v18, v19
  v_exp_f32 v21, v21
  v_exp_f32 v22, v22
  v_mfma_f32_32x32x16_bf16 v[2:17], v[94:97], v[82:85], v[2:17]
  v_cvt_pk_bf16_f32 v75, v20, v21
  v_exp_f32 v23, v23
  v_exp_f32 v24, v24
  v_cvt_pk_bf16_f32 v76, v22, v23
  v_exp_f32 v25, v25
  v_exp_f32 v26, v26
  s_waitcnt lgkmcnt(0)
  v_mfma_f32_32x32x16_bf16 v[34:49], v[100:103], v[66:69], v[34:49]
  v_cvt_pk_bf16_f32 v77, v24, v25
  v_exp_f32 v27, v27
  v_exp_f32 v28, v28
  v_cvt_pk_bf16_f32 v78, v26, v27
  v_exp_f32 v29, v29
  v_exp_f32 v30, v30
  v_mfma_f32_32x32x16_bf16 v[34:49], v[104:107], v[70:73], v[34:49]
  v_cvt_pk_bf16_f32 v79, v28, v29
  v_exp_f32 v31, v31
  v_exp_f32 v32, v32
  v_cvt_pk_bf16_f32 v80, v30, v31
  v_exp_f32 v33, v33
  s_nop 0
  v_cvt_pk_bf16_f32 v81, v32, v33
  s_setprio 1
  v_mfma_f32_32x32x8bf16_1k v[18:33], v[98:99], v[92:93], 0
  v_exp_f32 v2, v2
  v_exp_f32 v3, v3
  v_exp_f32 v4, v4
  v_cvt_pk_bf16_f32 v66, v2, v3
  v_exp_f32 v5, v5
  v_exp_f32 v6, v6
  v_mfma_f32_32x32x16_bf16 v[18:33], v[94:97], v[86:89], v[18:33]
  ds_read_b32 v98, v113 offset:4352
  ds_read_b128 v[94:97], v109 offset:2048
  v_cvt_pk_bf16_f32 v67, v4, v5
  v_exp_f32 v7, v7
  v_exp_f32 v8, v8
  v_cvt_pk_bf16_f32 v68, v6, v7
  v_exp_f32 v9, v9
  v_exp_f32 v10, v10
  v_mfma_f32_32x32x16_bf16 v[50:65], v[100:103], v[74:77], v[50:65]
  v_cvt_pk_bf16_f32 v69, v8, v9
  v_exp_f32 v11, v11
  v_exp_f32 v12, v12
  v_cvt_pk_bf16_f32 v70, v10, v11
  v_exp_f32 v13, v13
  v_exp_f32 v14, v14
  v_mfma_f32_32x32x16_bf16 v[50:65], v[104:107], v[78:81], v[50:65]
  s_mov_b64 exec, s[34:35]
  ds_read_b128 v[100:103], v111 offset:7424
  ds_read_b128 v[104:107], v111 offset:8000
  s_mov_b64 exec, -1
  v_cvt_pk_bf16_f32 v71, v12, v13
  v_exp_f32 v15, v15
  v_exp_f32 v16, v16
  v_cvt_pk_bf16_f32 v72, v14, v15
  v_exp_f32 v17, v17
  s_nop 0
  v_cvt_pk_bf16_f32 v73, v16, v17
  s_waitcnt lgkmcnt(2)
  v_mfma_f32_32x32x8bf16_1k v[2:17], v[98:99], v[90:91], 0
  v_exp_f32 v18, v18
  v_exp_f32 v19, v19
  v_exp_f32 v20, v20
  v_cvt_pk_bf16_f32 v74, v18, v19
  v_exp_f32 v21, v21
  v_exp_f32 v22, v22
  v_mfma_f32_32x32x16_bf16 v[2:17], v[94:97], v[82:85], v[2:17]
  v_cvt_pk_bf16_f32 v75, v20, v21
  v_exp_f32 v23, v23
  v_exp_f32 v24, v24
  v_cvt_pk_bf16_f32 v76, v22, v23
  v_exp_f32 v25, v25
  v_exp_f32 v26, v26
  s_waitcnt lgkmcnt(0)
  v_mfma_f32_32x32x16_bf16 v[34:49], v[100:103], v[66:69], v[34:49]
  v_cvt_pk_bf16_f32 v77, v24, v25
  v_exp_f32 v27, v27
  v_exp_f32 v28, v28
  v_cvt_pk_bf16_f32 v78, v26, v27
  v_exp_f32 v29, v29
  v_exp_f32 v30, v30
  v_mfma_f32_32x32x16_bf16 v[34:49], v[104:107], v[70:73], v[34:49]
  v_cvt_pk_bf16_f32 v79, v28, v29
  v_exp_f32 v31, v31
  v_exp_f32 v32, v32
  v_cvt_pk_bf16_f32 v80, v30, v31
  v_exp_f32 v33, v33
  s_nop 0
  v_cvt_pk_bf16_f32 v81, v32, v33
  s_setprio 1
  v_mfma_f32_32x32x8bf16_1k v[18:33], v[98:99], v[92:93], 0
  v_exp_f32 v2, v2
  v_exp_f32 v3, v3
  v_exp_f32 v4, v4
  v_cvt_pk_bf16_f32 v66, v2, v3
  v_exp_f32 v5, v5
  v_exp_f32 v6, v6
  v_mfma_f32_32x32x16_bf16 v[18:33], v[94:97], v[86:89], v[18:33]
  ds_read_b32 v98, v113 offset:4480
  ds_read_b128 v[94:97], v109 offset:3072
  v_cvt_pk_bf16_f32 v67, v4, v5
  v_exp_f32 v7, v7
  v_exp_f32 v8, v8
  v_cvt_pk_bf16_f32 v68, v6, v7
  v_exp_f32 v9, v9
  v_exp_f32 v10, v10
  v_mfma_f32_32x32x16_bf16 v[50:65], v[100:103], v[74:77], v[50:65]
  v_cvt_pk_bf16_f32 v69, v8, v9
  v_exp_f32 v11, v11
  v_exp_f32 v12, v12
  v_cvt_pk_bf16_f32 v70, v10, v11
  v_exp_f32 v13, v13
  v_exp_f32 v14, v14
  v_mfma_f32_32x32x16_bf16 v[50:65], v[104:107], v[78:81], v[50:65]
  s_mov_b64 exec, s[34:35]
  ds_read_b128 v[100:103], v111 offset:8576
  ds_read_b128 v[104:107], v111 offset:9152
  s_mov_b64 exec, -1
  v_cvt_pk_bf16_f32 v71, v12, v13
  v_exp_f32 v15, v15
  v_exp_f32 v16, v16
  v_cvt_pk_bf16_f32 v72, v14, v15
  v_exp_f32 v17, v17
  s_nop 0
  v_cvt_pk_bf16_f32 v73, v16, v17
  s_waitcnt lgkmcnt(2)
  v_mfma_f32_32x32x8bf16_1k v[2:17], v[98:99], v[90:91], 0
  v_exp_f32 v18, v18
  v_exp_f32 v19, v19
  v_exp_f32 v20, v20
  v_cvt_pk_bf16_f32 v74, v18, v19
  v_exp_f32 v21, v21
  v_exp_f32 v22, v22
  v_mfma_f32_32x32x16_bf16 v[2:17], v[94:97], v[82:85], v[2:17]
  v_cvt_pk_bf16_f32 v75, v20, v21
  v_exp_f32 v23, v23
  v_exp_f32 v24, v24
  v_cvt_pk_bf16_f32 v76, v22, v23
  v_exp_f32 v25, v25
  v_exp_f32 v26, v26
  s_waitcnt lgkmcnt(0)
  v_mfma_f32_32x32x16_bf16 v[34:49], v[100:103], v[66:69], v[34:49]
  v_cvt_pk_bf16_f32 v77, v24, v25
  v_exp_f32 v27, v27
  v_exp_f32 v28, v28
  v_cvt_pk_bf16_f32 v78, v26, v27
  v_exp_f32 v29, v29
  v_exp_f32 v30, v30
  v_mfma_f32_32x32x16_bf16 v[34:49], v[104:107], v[70:73], v[34:49]
  v_cvt_pk_bf16_f32 v79, v28, v29
  v_exp_f32 v31, v31
  v_exp_f32 v32, v32
  v_cvt_pk_bf16_f32 v80, v30, v31
  v_exp_f32 v33, v33
  s_nop 0
  v_cvt_pk_bf16_f32 v81, v32, v33
  s_waitcnt vmcnt(0) lgkmcnt(0)
  s_barrier
  s_setprio 3
  v_mfma_f32_32x32x8bf16_1k v[18:33], v[98:99], v[92:93], 0
  v_exp_f32 v2, v2
  v_exp_f32 v3, v3
  v_exp_f32 v4, v4
  v_cvt_pk_bf16_f32 v66, v2, v3
  v_exp_f32 v5, v5
  v_exp_f32 v6, v6
  v_mfma_f32_32x32x16_bf16 v[18:33], v[94:97], v[86:89], v[18:33]
  ds_read_b32 v98, v113 offset:24576
  ds_read_b128 v[94:97], v109 offset:20480
  v_cvt_pk_bf16_f32 v67, v4, v5
  v_exp_f32 v7, v7
  v_exp_f32 v8, v8
  v_cvt_pk_bf16_f32 v68, v6, v7
  v_exp_f32 v9, v9
  v_exp_f32 v10, v10
  v_mfma_f32_32x32x16_bf16 v[50:65], v[100:103], v[74:77], v[50:65]
  v_cvt_pk_bf16_f32 v69, v8, v9
  v_exp_f32 v11, v11
  v_exp_f32 v12, v12
  v_cvt_pk_bf16_f32 v70, v10, v11
  v_exp_f32 v13, v13
  v_exp_f32 v14, v14
  v_mfma_f32_32x32x16_bf16 v[50:65], v[104:107], v[78:81], v[50:65]
  s_mov_b64 exec, s[34:35]
  ds_read_b128 v[100:103], v111 offset:25600
  ds_read_b128 v[104:107], v111 offset:26176
  s_mov_b64 exec, -1
  v_cvt_pk_bf16_f32 v71, v12, v13
  v_exp_f32 v15, v15
  v_exp_f32 v16, v16
  v_cvt_pk_bf16_f32 v72, v14, v15
  v_exp_f32 v17, v17
  s_nop 0
  v_cvt_pk_bf16_f32 v73, v16, v17
  s_waitcnt lgkmcnt(2)
  v_mfma_f32_32x32x8bf16_1k v[2:17], v[98:99], v[90:91], 0
  v_exp_f32 v18, v18
  v_exp_f32 v19, v19
  v_exp_f32 v20, v20
  v_cvt_pk_bf16_f32 v74, v18, v19
  v_exp_f32 v21, v21
  v_exp_f32 v22, v22
  v_mfma_f32_32x32x16_bf16 v[2:17], v[94:97], v[82:85], v[2:17]
  v_cvt_pk_bf16_f32 v75, v20, v21
  v_exp_f32 v23, v23
  v_exp_f32 v24, v24
  v_cvt_pk_bf16_f32 v76, v22, v23
  v_exp_f32 v25, v25
  v_exp_f32 v26, v26
  s_waitcnt lgkmcnt(0)
  v_mfma_f32_32x32x16_bf16 v[34:49], v[100:103], v[66:69], v[34:49]
  v_cvt_pk_bf16_f32 v77, v24, v25
  v_exp_f32 v27, v27
  v_exp_f32 v28, v28
  v_cvt_pk_bf16_f32 v78, v26, v27
  v_exp_f32 v29, v29
  v_exp_f32 v30, v30
  v_mfma_f32_32x32x16_bf16 v[34:49], v[104:107], v[70:73], v[34:49]
  v_cvt_pk_bf16_f32 v79, v28, v29
  v_exp_f32 v31, v31
  v_exp_f32 v32, v32
  v_cvt_pk_bf16_f32 v80, v30, v31
  v_exp_f32 v33, v33
  s_nop 0
  v_cvt_pk_bf16_f32 v81, v32, v33
  s_setprio 2
  v_mfma_f32_32x32x8bf16_1k v[18:33], v[98:99], v[92:93], 0
  v_exp_f32 v2, v2
  v_exp_f32 v3, v3
  v_exp_f32 v4, v4
  v_cvt_pk_bf16_f32 v66, v2, v3
  v_exp_f32 v5, v5
  v_exp_f32 v6, v6
  v_mfma_f32_32x32x16_bf16 v[18:33], v[94:97], v[86:89], v[18:33]
  ds_read_b32 v98, v113 offset:24704
  ds_read_b128 v[94:97], v109 offset:21504
  v_cvt_pk_bf16_f32 v67, v4, v5
  v_exp_f32 v7, v7
  v_exp_f32 v8, v8
  v_cvt_pk_bf16_f32 v68, v6, v7
  v_exp_f32 v9, v9
  v_exp_f32 v10, v10
  v_mfma_f32_32x32x16_bf16 v[50:65], v[100:103], v[74:77], v[50:65]
  v_cvt_pk_bf16_f32 v69, v8, v9
  v_exp_f32 v11, v11
  v_exp_f32 v12, v12
  v_cvt_pk_bf16_f32 v70, v10, v11
  v_exp_f32 v13, v13
  v_exp_f32 v14, v14
  v_mfma_f32_32x32x16_bf16 v[50:65], v[104:107], v[78:81], v[50:65]
  s_mov_b64 exec, s[34:35]
  ds_read_b128 v[100:103], v111 offset:26752
  ds_read_b128 v[104:107], v111 offset:27328
  s_mov_b64 exec, -1
  v_cvt_pk_bf16_f32 v71, v12, v13
  v_exp_f32 v15, v15
  v_exp_f32 v16, v16
  v_cvt_pk_bf16_f32 v72, v14, v15
  v_exp_f32 v17, v17
  s_nop 0
  v_cvt_pk_bf16_f32 v73, v16, v17
  s_waitcnt lgkmcnt(2)
  v_mfma_f32_32x32x8bf16_1k v[2:17], v[98:99], v[90:91], 0
  v_exp_f32 v18, v18
  v_exp_f32 v19, v19
  v_exp_f32 v20, v20
  v_cvt_pk_bf16_f32 v74, v18, v19
  v_exp_f32 v21, v21
  v_exp_f32 v22, v22
  v_mfma_f32_32x32x16_bf16 v[2:17], v[94:97], v[82:85], v[2:17]
  v_cvt_pk_bf16_f32 v75, v20, v21
  v_exp_f32 v23, v23
  v_exp_f32 v24, v24
  v_cvt_pk_bf16_f32 v76, v22, v23
  v_exp_f32 v25, v25
  v_exp_f32 v26, v26
  s_waitcnt lgkmcnt(0)
  v_mfma_f32_32x32x16_bf16 v[34:49], v[100:103], v[66:69], v[34:49]
  v_cvt_pk_bf16_f32 v77, v24, v25
  v_exp_f32 v27, v27
  v_exp_f32 v28, v28
  v_cvt_pk_bf16_f32 v78, v26, v27
  v_exp_f32 v29, v29
  v_exp_f32 v30, v30
  v_mfma_f32_32x32x16_bf16 v[34:49], v[104:107], v[70:73], v[34:49]
  v_cvt_pk_bf16_f32 v79, v28, v29
  v_exp_f32 v31, v31
  v_exp_f32 v32, v32
  v_cvt_pk_bf16_f32 v80, v30, v31
  v_exp_f32 v33, v33
  s_nop 0
  v_cvt_pk_bf16_f32 v81, v32, v33
  s_setprio 1
  v_mfma_f32_32x32x8bf16_1k v[18:33], v[98:99], v[92:93], 0
  v_exp_f32 v2, v2
  v_exp_f32 v3, v3
  v_exp_f32 v4, v4
  v_cvt_pk_bf16_f32 v66, v2, v3
  v_exp_f32 v5, v5
  v_exp_f32 v6, v6
  v_mfma_f32_32x32x16_bf16 v[18:33], v[94:97], v[86:89], v[18:33]
  ds_read_b32 v98, v113 offset:24832
  ds_read_b128 v[94:97], v109 offset:22528
  v_cvt_pk_bf16_f32 v67, v4, v5
  v_exp_f32 v7, v7
  v_exp_f32 v8, v8
  v_cvt_pk_bf16_f32 v68, v6, v7
  v_exp_f32 v9, v9
  v_exp_f32 v10, v10
  v_mfma_f32_32x32x16_bf16 v[50:65], v[100:103], v[74:77], v[50:65]
  v_cvt_pk_bf16_f32 v69, v8, v9
  v_exp_f32 v11, v11
  v_exp_f32 v12, v12
  v_cvt_pk_bf16_f32 v70, v10, v11
  v_exp_f32 v13, v13
  v_exp_f32 v14, v14
  v_mfma_f32_32x32x16_bf16 v[50:65], v[104:107], v[78:81], v[50:65]
  s_mov_b64 exec, s[34:35]
  ds_read_b128 v[100:103], v111 offset:27904
  ds_read_b128 v[104:107], v111 offset:28480
  s_mov_b64 exec, -1
  v_cvt_pk_bf16_f32 v71, v12, v13
  v_exp_f32 v15, v15
  v_exp_f32 v16, v16
  v_cvt_pk_bf16_f32 v72, v14, v15
  v_exp_f32 v17, v17
  s_nop 0
  v_cvt_pk_bf16_f32 v73, v16, v17
  s_waitcnt lgkmcnt(2)
  v_mfma_f32_32x32x8bf16_1k v[2:17], v[98:99], v[90:91], 0
  v_exp_f32 v18, v18
  v_exp_f32 v19, v19
  v_exp_f32 v20, v20
  v_cvt_pk_bf16_f32 v74, v18, v19
  v_exp_f32 v21, v21
  v_exp_f32 v22, v22
  v_mfma_f32_32x32x16_bf16 v[2:17], v[94:97], v[82:85], v[2:17]
  v_cvt_pk_bf16_f32 v75, v20, v21
  v_exp_f32 v23, v23
  v_exp_f32 v24, v24
  v_cvt_pk_bf16_f32 v76, v22, v23
  v_exp_f32 v25, v25
  v_exp_f32 v26, v26
  s_waitcnt lgkmcnt(0)
  v_mfma_f32_32x32x16_bf16 v[34:49], v[100:103], v[66:69], v[34:49]
  v_cvt_pk_bf16_f32 v77, v24, v25
  v_exp_f32 v27, v27
  v_exp_f32 v28, v28
  v_cvt_pk_bf16_f32 v78, v26, v27
  v_exp_f32 v29, v29
  v_exp_f32 v30, v30
  v_mfma_f32_32x32x16_bf16 v[34:49], v[104:107], v[70:73], v[34:49]
  v_cvt_pk_bf16_f32 v79, v28, v29
  v_exp_f32 v31, v31
  v_exp_f32 v32, v32
  v_cvt_pk_bf16_f32 v80, v30, v31
  v_exp_f32 v33, v33
  s_nop 0
  v_cvt_pk_bf16_f32 v81, v32, v33
  s_setprio 1
  v_mfma_f32_32x32x8bf16_1k v[18:33], v[98:99], v[92:93], 0
  v_exp_f32 v2, v2
  v_exp_f32 v3, v3
  v_exp_f32 v4, v4
  v_cvt_pk_bf16_f32 v66, v2, v3
  v_exp_f32 v5, v5
  v_exp_f32 v6, v6
  v_mfma_f32_32x32x16_bf16 v[18:33], v[94:97], v[86:89], v[18:33]
  ds_read_b32 v98, v113 offset:24960
  ds_read_b128 v[94:97], v109 offset:23552
  v_cvt_pk_bf16_f32 v67, v4, v5
  v_exp_f32 v7, v7
  v_exp_f32 v8, v8
  v_cvt_pk_bf16_f32 v68, v6, v7
  v_exp_f32 v9, v9
  v_exp_f32 v10, v10
  v_mfma_f32_32x32x16_bf16 v[50:65], v[100:103], v[74:77], v[50:65]
  v_cvt_pk_bf16_f32 v69, v8, v9
  v_exp_f32 v11, v11
  v_exp_f32 v12, v12
  v_cvt_pk_bf16_f32 v70, v10, v11
  v_exp_f32 v13, v13
  v_exp_f32 v14, v14
  v_mfma_f32_32x32x16_bf16 v[50:65], v[104:107], v[78:81], v[50:65]
  s_mov_b64 exec, s[34:35]
  ds_read_b128 v[100:103], v111 offset:29056
  ds_read_b128 v[104:107], v111 offset:29632
  s_mov_b64 exec, -1
  v_cvt_pk_bf16_f32 v71, v12, v13
  v_exp_f32 v15, v15
  v_exp_f32 v16, v16
  v_cvt_pk_bf16_f32 v72, v14, v15
  v_exp_f32 v17, v17
  s_nop 0
  v_cvt_pk_bf16_f32 v73, v16, v17
  s_waitcnt lgkmcnt(2)
  v_mfma_f32_32x32x8bf16_1k v[2:17], v[98:99], v[90:91], 0
  v_exp_f32 v18, v18
  v_exp_f32 v19, v19
  v_exp_f32 v20, v20
  v_cvt_pk_bf16_f32 v74, v18, v19
  v_exp_f32 v21, v21
  v_exp_f32 v22, v22
  v_mfma_f32_32x32x16_bf16 v[2:17], v[94:97], v[82:85], v[2:17]
  v_cvt_pk_bf16_f32 v75, v20, v21
  v_exp_f32 v23, v23
  v_exp_f32 v24, v24
  v_cvt_pk_bf16_f32 v76, v22, v23
  v_exp_f32 v25, v25
  v_exp_f32 v26, v26
  s_waitcnt lgkmcnt(0)
  v_mfma_f32_32x32x16_bf16 v[34:49], v[100:103], v[66:69], v[34:49]
  v_cvt_pk_bf16_f32 v77, v24, v25
  v_exp_f32 v27, v27
  v_exp_f32 v28, v28
  v_cvt_pk_bf16_f32 v78, v26, v27
  v_exp_f32 v29, v29
  v_exp_f32 v30, v30
  v_mfma_f32_32x32x16_bf16 v[34:49], v[104:107], v[70:73], v[34:49]
  v_cvt_pk_bf16_f32 v79, v28, v29
  v_exp_f32 v31, v31
  v_exp_f32 v32, v32
  v_cvt_pk_bf16_f32 v80, v30, v31
  v_exp_f32 v33, v33
  s_nop 0
  v_cvt_pk_bf16_f32 v81, v32, v33
  s_waitcnt vmcnt(0) lgkmcnt(0)
  s_barrier
  v_mfma_f32_32x32x16_bf16 v[50:65], v[100:103], v[74:77], v[50:65]
  v_mfma_f32_32x32x16_bf16 v[50:65], v[104:107], v[78:81], v[50:65]
  s_lshl_b32 s20, s11, 9
  s_lshl_b32 s21, s12, 2
  s_add_u32 s20, s20, s21
  s_add_u32 s20, s20, 24576
  v_and_b32 v112, 31, v0
  v_lshlrev_b32 v112, 3, v112
  v_add_u32 v112, s20, v112
  s_mul_i32 s20, s10, 3072
  v_add_u32 v2, s20, v108
  s_xor_b32 s21, s10, 4
  s_mul_i32 s21, s21, 3072
  v_add_u32 v3, s21, v108
  s_mov_b32 exec_hi, 0
  ds_write_b32 v112, v44
  ds_write_b32 v112, v60 offset:256
  s_mov_b32 exec_hi, -1
  s_cmp_eq_u32 s12, 0
  s_cbranch_scc0 att_send_a
  ds_write_b128 v2, v[50:53]
  ds_write_b128 v2, v[54:57] offset:1024
  ds_write_b128 v2, v[58:61] offset:2048
  s_branch att_sent
att_send_a:
  ds_write_b128 v2, v[34:37]
  ds_write_b128 v2, v[38:41] offset:1024
  ds_write_b128 v2, v[42:45] offset:2048
  s_waitcnt lgkmcnt(0)
  v_mov_b32 v34, v50
  v_mov_b32 v35, v51
  v_mov_b32 v36, v52
  v_mov_b32 v37, v53
  v_mov_b32 v38, v54
  v_mov_b32 v39, v55
  v_mov_b32 v40, v56
  v_mov_b32 v41, v57
  v_mov_b32 v42, v58
  v_mov_b32 v43, v59
  v_mov_b32 v44, v60
  v_mov_b32 v45, v61
att_sent:
  s_waitcnt lgkmcnt(0)
  s_barrier
  ds_read_b128 v[18:21], v3
  ds_read_b128 v[22:25], v3 offset:1024
  ds_read_b128 v[26:29], v3 offset:2048
  v_lshlrev_b32 v112, 3, v0
  ds_read_b64 v[66:67], v112 offset:24576
  ds_read_b64 v[68:69], v112 offset:25088
  ds_read_b64 v[74:75], v112 offset:25600
  ds_read_b64 v[76:77], v112 offset:26112
  s_waitcnt lgkmcnt(6)
  v_add_f32 v34, v34, v18
  v_add_f32 v35, v35, v19
  v_add_f32 v36, v36, v20
  v_add_f32 v37, v37, v21
  s_waitcnt lgkmcnt(5)
  v_add_f32 v38, v38, v22
  v_add_f32 v39, v39, v23
  v_add_f32 v40, v40, v24
  v_add_f32 v41, v41, v25
  s_waitcnt lgkmcnt(4)
  v_add_f32 v42, v42, v26
  v_add_f32 v43, v43, v27
  v_add_f32 v44, v44, v28
  s_waitcnt lgkmcnt(3)
  v_add_f32 v66, v66, v67
  s_waitcnt lgkmcnt(2)
  v_add_f32 v68, v68, v69
  s_waitcnt lgkmcnt(1)
  v_add_f32 v74, v74, v75
  s_waitcnt lgkmcnt(0)
  v_add_f32 v76, v76, v77
  s_cmp_eq_u32 s19, 1
  s_cbranch_scc1 att_final
  v_mov_b32 v72, 0x1f800000
  v_mov_b32 v73, 0x5f800000
  s_mov_b64 s[24:25], exec
  v_cmp_ge_f32 vcc, v66, v72
  s_nop 3
  s_and_b64 s[24:25], s[24:25], vcc
  v_cmp_le_f32 vcc, v66, v73
  s_nop 3
  s_and_b64 s[24:25], s[24:25], vcc
  v_cmp_ge_f32 vcc, v68, v72
  s_nop 3
  s_and_b64 s[24:25], s[24:25], vcc
  v_cmp_le_f32 vcc, v68, v73
  s_nop 3
  s_and_b64 s[24:25], s[24:25], vcc
  v_cmp_ge_f32 vcc, v74, v72
  s_nop 3
  s_and_b64 s[24:25], s[24:25], vcc
  v_cmp_le_f32 vcc, v74, v73
  s_nop 3
  s_and_b64 s[24:25], s[24:25], vcc
  v_cmp_ge_f32 vcc, v76, v72
  s_nop 3
  s_and_b64 s[24:25], s[24:25], vcc
  v_cmp_le_f32 vcc, v76, v73
  s_nop 3
  s_and_b64 s[24:25], s[24:25], vcc
  s_andn2_b64 s[24:25], exec, s[24:25]
  s_cbranch_scc1 att_maxpass
att_final:
  v_mov_b32 v18, v44
  v_mov_b32 v19, v44
  s_add_u32 s26, s26, s12
  s_mul_i32 s20, s26, 36864
  v_permlane32_swap_b32 v18, v19
  s_add_u32 s20, s20, 8388608
  v_rcp_f32 v18, v18
  v_sub_f32 v19, 1.0, v114
  s_lshl_b32 s21, s8, 10
  s_add_u32 s21, s21, s20
  v_mul_f32 v18, v18, v19
  v_mul_f32 v34, v34, v18
  v_mul_f32 v35, v35, v18
  v_mul_f32 v36, v36, v18
  v_mul_f32 v37, v37, v18
  v_mul_f32 v38, v38, v18
  v_mul_f32 v39, v39, v18
  v_mul_f32 v40, v40, v18
  v_mul_f32 v41, v41, v18
  v_mul_f32 v42, v42, v18
  v_mul_f32 v43, v43, v18
  v_cvt_pk_bf16_f32 v66, v34, v35
  v_cvt_pk_bf16_f32 v67, v36, v37
  v_cvt_pk_bf16_f32 v68, v38, v39
  v_cvt_pk_bf16_f32 v69, v40, v41
  v_cvt_pk_bf16_f32 v70, v42, v43
  buffer_store_dwordx4 v[66:69], v108, s[4:7], s21 offen sc1
  s_lshr_b32 s21, s8, 3
  s_add_u32 s21, s21, 32
  s_lshl_b32 s21, s21, 10
  s_add_u32 s20, s20, s21
  s_lshr_b32 s21, s8, 2
  s_and_b32 s21, s21, 1
  s_lshl_b32 s21, s21, 9
  s_add_u32 s20, s20, s21
  s_and_b32 s21, s8, 3
  s_lshl_b32 s21, s21, 2
  s_add_u32 s20, s20, s21
  s_mov_b32 exec_hi, 0
  buffer_store_dword v70, v108, s[4:7], s20 offen sc1
  s_lshl_b32 s20, s26, 7
  s_lshl_b32 s21, s8, 2
  s_add_u32 s20, s20, s21
  s_add_u32 s20, s20, 22284288
  s_waitcnt vmcnt(0)
  v_mov_b32 v66, 1
  v_mov_b32 v67, 0
  s_mov_b32 exec_lo, 1
  buffer_store_dword v66, v67, s[4:7], s20 offen sc1
att_noflag:
  s_endpgm
att_maxpass:
  s_barrier
  s_mov_b32 s19, 1
  s_mov_b32 s18, 0
  s_mov_b32 s13, s27
  s_mov_b32 s14, s28
  v_mov_b32 v91, 0
  v_mov_b32 v93, 0
  v_mov_b32 v66, 0xff800000
  v_mov_b32 v74, 0xff800000
att_maxloop:
  buffer_load_dwordx4 v[94:97], v108, s[4:7], s13 offen
  buffer_load_dword v98, v110, s[4:7], s14 offen
  s_add_u32 s13, s13, 1024
  s_add_u32 s14, s14, 128
  s_waitcnt vmcnt(0)
  v_mfma_f32_32x32x8bf16_1k v[2:17], v[98:99], v[90:91], 0
  v_mfma_f32_32x32x16_bf16 v[2:17], v[94:97], v[82:85], v[2:17]
  v_mfma_f32_32x32x8bf16_1k v[18:33], v[98:99], v[92:93], 0
  v_mfma_f32_32x32x16_bf16 v[18:33], v[94:97], v[86:89], v[18:33]
  s_nop 9
  v_max3_f32 v66, v2, v3, v66
  v_max3_f32 v66, v4, v5, v66
  v_max3_f32 v66, v6, v7, v66
  v_max3_f32 v66, v8, v9, v66
  v_max3_f32 v66, v10, v11, v66
  v_max3_f32 v66, v12, v13, v66
  v_max3_f32 v66, v14, v15, v66
  v_max3_f32 v66, v16, v17, v66
  v_max3_f32 v74, v18, v19, v74
  v_max3_f32 v74, v20, v21, v74
  v_max3_f32 v74, v22, v23, v74
  v_max3_f32 v74, v24, v25, v74
  v_max3_f32 v74, v26, v27, v74
  v_max3_f32 v74, v28, v29, v74
  v_max3_f32 v74, v30, v31, v74
  v_max3_f32 v74, v32, v33, v74
  s_add_u32 s18, s18, 1
  s_cmp_lt_u32 s18, 32
  s_cbranch_scc1 att_maxloop
  v_mov_b32 v67, v66
  v_mov_b32 v68, v66
  s_nop 1
  v_permlane32_swap_b32 v67, v68
  v_max3_f32 v66, v66, v67, v68
  v_mov_b32 v75, v74
  v_mov_b32 v76, v74
  s_nop 1
  v_permlane32_swap_b32 v75, v76
  v_max3_f32 v74, v74, v75, v76
  s_lshl_b32 s20, s10, 9
  v_lshlrev_b32 v112, 3, v0
  v_add_u32 v2, s20, v112
  s_xor_b32 s20, s10, 4
  s_lshl_b32 s20, s20, 9
  v_add_u32 v3, s20, v112
  v_mov_b32 v67, v74
  ds_write_b64 v2, v[66:67]
  s_waitcnt lgkmcnt(0)
  s_barrier
  ds_read_b64 v[68:69], v3
  v_cmp_gt_u32 vcc, 32, v0
  s_waitcnt lgkmcnt(0)
  v_max_f32 v66, v66, v68
  v_max_f32 v74, v74, v69
  v_sub_f32 v66, 0, v66
  v_and_b32 v67, 0xffff0000, v66
  v_sub_f32 v68, v66, v67
  v_and_b32 v69, 0xffff0000, v68
  v_sub_f32 v70, v68, v69
  v_lshrrev_b32 v71, 16, v67
  v_or_b32 v71, v71, v69
  v_lshrrev_b32 v72, 16, v70
  v_cndmask_b32 v91, v72, v71, vcc
  v_sub_f32 v74, 0, v74
  v_and_b32 v75, 0xffff0000, v74
  v_sub_f32 v76, v74, v75
  v_and_b32 v77, 0xffff0000, v76
  v_sub_f32 v78, v76, v77
  v_lshrrev_b32 v79, 16, v75
  v_or_b32 v79, v79, v77
  v_lshrrev_b32 v80, 16, v78
  v_cndmask_b32 v93, v80, v79, vcc
  s_barrier
  s_branch att_start
l2_svc:
  s_sub_u32 s3, s2, 256
  s_load_dwordx2 s[36:37], s[0:1], 0
  s_mov_b32 s38, 2359296
  s_mov_b32 s39, 0x00020000
  s_load_dwordx2 s[40:41], s[0:1], 104
  s_mov_b32 s42, 4718592
  s_mov_b32 s43, 0x00020000
  v_lshrrev_b32 v2, 6, v0
  v_and_b32 v0, 63, v0
  v_readfirstlane_b32 s10, v2
  v_lshlrev_b32 v1, 4, v0
  s_and_b32 s8, s3, 7
  s_lshl_b32 s8, s8, 1
  s_lshr_b32 s18, s3, 3
  s_and_b32 s18, s18, 1
  s_add_u32 s8, s8, s18
  s_lshr_b32 s9, s3, 4
  s_and_b32 s23, s10, 3
  s_lshr_b32 s22, s10, 2
  s_mov_b32 s21, 1511506921
  s_waitcnt lgkmcnt(0)
  s_add_u32 s32, s4, 22085632
  s_addc_u32 s33, s5, 0
  s_mov_b32 s34, 147456
  s_mov_b32 s35, 0x00020000
  s_lshl_b32 s24, s8, 2
  s_add_u32 s24, s24, s23
  s_and_b32 s18, s8, 1
  s_lshl_b32 s18, s18, 2
  s_add_u32 s48, s9, s18
  s_sub_u32 s18, s48, 9
  s_cmp_ge_u32 s48, 9
  s_cselect_b32 s48, s18, s48
  s_setprio 3
  s_cmp_eq_u32 s22, 0
  s_cbranch_scc0 svc_loader
  s_and_b32 s11, s10, 1
  s_lshr_b32 s12, s10, 1
  s_lshl_b32 s18, s9, 6
  s_lshl_b32 s19, s12, 5
  s_add_u32 s18, s18, s19
  v_and_b32 v118, 31, v0
  v_add_u32 v118, s18, v118
  v_lshlrev_b32 v119, 1, v118
  v_lshlrev_b32 v119, 5, v118
  s_mov_b32 s18, 22036480
  buffer_load_dwordx4 v[102:105], v119, s[4:7], s18 offen
  buffer_load_dwordx2 v[106:107], v119, s[4:7], s18 offen offset:16
  s_lshl_b32 s18, s11, 12
  v_add_u32 v98, s18, v1
  v_add_u32 v99, 0x10000, v98
  s_lshl_b32 s18, s12, 12
  s_add_u32 s18, s18, 8192
  v_add_u32 v100, s18, v1
  v_add_u32 v101, 0x10000, v100
  s_barrier
  s_setprio 0
  ds_read_b128 v[66:69], v98 offset:0
  ds_read_b128 v[82:85], v100 offset:0
  ds_read_b128 v[86:89], v100 offset:2048
  ds_read_b128 v[70:73], v98 offset:2048
  s_waitcnt lgkmcnt(0)
  v_mfma_f32_32x32x16_bf16 v[2:17], v[66:69], v[82:85], 0
  ds_read_b128 v[74:77], v98 offset:1024
  ds_read_b128 v[90:93], v100 offset:1024
  v_mfma_f32_32x32x16_bf16 v[18:33], v[66:69], v[86:89], 0
  ds_read_b128 v[94:97], v100 offset:3072
  ds_read_b128 v[78:81], v98 offset:3072
  v_mfma_f32_32x32x16_bf16 v[34:49], v[70:73], v[82:85], 0
  v_mfma_f32_32x32x16_bf16 v[50:65], v[70:73], v[86:89], 0
  s_waitcnt lgkmcnt(0)
  s_barrier
  v_mfma_f32_32x32x16_bf16 v[2:17], v[74:77], v[90:93], v[2:17]
  ds_read_b128 v[66:69], v98 offset:16384
  ds_read_b128 v[82:85], v100 offset:16384
  v_mfma_f32_32x32x16_bf16 v[18:33], v[74:77], v[94:97], v[18:33]
  ds_read_b128 v[86:89], v100 offset:18432
  ds_read_b128 v[70:73], v98 offset:18432
  v_mfma_f32_32x32x16_bf16 v[34:49], v[78:81], v[90:93], v[34:49]
  v_mfma_f32_32x32x16_bf16 v[50:65], v[78:81], v[94:97], v[50:65]
  s_waitcnt lgkmcnt(0)
  v_mfma_f32_32x32x16_bf16 v[2:17], v[66:69], v[82:85], v[2:17]
  ds_read_b128 v[74:77], v98 offset:17408
  ds_read_b128 v[90:93], v100 offset:17408
  v_mfma_f32_32x32x16_bf16 v[18:33], v[66:69], v[86:89], v[18:33]
  ds_read_b128 v[94:97], v100 offset:19456
  ds_read_b128 v[78:81], v98 offset:19456
  v_mfma_f32_32x32x16_bf16 v[34:49], v[70:73], v[82:85], v[34:49]
  v_mfma_f32_32x32x16_bf16 v[50:65], v[70:73], v[86:89], v[50:65]
  s_waitcnt lgkmcnt(0)
  s_barrier
  v_mfma_f32_32x32x16_bf16 v[2:17], v[74:77], v[90:93], v[2:17]
  ds_read_b128 v[66:69], v98 offset:32768
  ds_read_b128 v[82:85], v100 offset:32768
  v_mfma_f32_32x32x16_bf16 v[18:33], v[74:77], v[94:97], v[18:33]
  ds_read_b128 v[86:89], v100 offset:34816
  ds_read_b128 v[70:73], v98 offset:34816
  v_mfma_f32_32x32x16_bf16 v[34:49], v[78:81], v[90:93], v[34:49]
  v_mfma_f32_32x32x16_bf16 v[50:65], v[78:81], v[94:97], v[50:65]
  s_waitcnt lgkmcnt(0)
  v_mfma_f32_32x32x16_bf16 v[2:17], v[66:69], v[82:85], v[2:17]
  ds_read_b128 v[74:77], v98 offset:33792
  ds_read_b128 v[90:93], v100 offset:33792
  v_mfma_f32_32x32x16_bf16 v[18:33], v[66:69], v[86:89], v[18:33]
  ds_read_b128 v[94:97], v100 offset:35840
  ds_read_b128 v[78:81], v98 offset:35840
  v_mfma_f32_32x32x16_bf16 v[34:49], v[70:73], v[82:85], v[34:49]
  v_mfma_f32_32x32x16_bf16 v[50:65], v[70:73], v[86:89], v[50:65]
  s_waitcnt lgkmcnt(0)
  s_barrier
  v_mfma_f32_32x32x16_bf16 v[2:17], v[74:77], v[90:93], v[2:17]
  ds_read_b128 v[66:69], v98 offset:49152
  ds_read_b128 v[82:85], v100 offset:49152
  v_mfma_f32_32x32x16_bf16 v[18:33], v[74:77], v[94:97], v[18:33]
  ds_read_b128 v[86:89], v100 offset:51200
  ds_read_b128 v[70:73], v98 offset:51200
  v_mfma_f32_32x32x16_bf16 v[34:49], v[78:81], v[90:93], v[34:49]
  v_mfma_f32_32x32x16_bf16 v[50:65], v[78:81], v[94:97], v[50:65]
  s_waitcnt lgkmcnt(0)
  v_mfma_f32_32x32x16_bf16 v[2:17], v[66:69], v[82:85], v[2:17]
  ds_read_b128 v[74:77], v98 offset:50176
  ds_read_b128 v[90:93], v100 offset:50176
  v_mfma_f32_32x32x16_bf16 v[18:33], v[66:69], v[86:89], v[18:33]
  ds_read_b128 v[94:97], v100 offset:52224
  ds_read_b128 v[78:81], v98 offset:52224
  v_mfma_f32_32x32x16_bf16 v[34:49], v[70:73], v[82:85], v[34:49]
  v_mfma_f32_32x32x16_bf16 v[50:65], v[70:73], v[86:89], v[50:65]
  s_waitcnt lgkmcnt(0)
  s_barrier
  v_mfma_f32_32x32x16_bf16 v[2:17], v[74:77], v[90:93], v[2:17]
  ds_read_b128 v[66:69], v99 offset:0
  ds_read_b128 v[82:85], v101 offset:0
  v_mfma_f32_32x32x16_bf16 v[18:33], v[74:77], v[94:97], v[18:33]
  ds_read_b128 v[86:89], v101 offset:2048
  ds_read_b128 v[70:73], v99 offset:2048
  v_mfma_f32_32x32x16_bf16 v[34:49], v[78:81], v[90:93], v[34:49]
  v_mfma_f32_32x32x16_bf16 v[50:65], v[78:81], v[94:97], v[50:65]
  s_waitcnt lgkmcnt(0)
  v_mfma_f32_32x32x16_bf16 v[2:17], v[66:69], v[82:85], v[2:17]
  ds_read_b128 v[74:77], v99 offset:1024
  ds_read_b128 v[90:93], v101 offset:1024
  v_mfma_f32_32x32x16_bf16 v[18:33], v[66:69], v[86:89], v[18:33]
  ds_read_b128 v[94:97], v101 offset:3072
  ds_read_b128 v[78:81], v99 offset:3072
  v_mfma_f32_32x32x16_bf16 v[34:49], v[70:73], v[82:85], v[34:49]
  v_mfma_f32_32x32x16_bf16 v[50:65], v[70:73], v[86:89], v[50:65]
  s_waitcnt lgkmcnt(0)
  s_barrier
  v_mfma_f32_32x32x16_bf16 v[2:17], v[74:77], v[90:93], v[2:17]
  ds_read_b128 v[66:69], v98 offset:0
  ds_read_b128 v[82:85], v100 offset:0
  v_mfma_f32_32x32x16_bf16 v[18:33], v[74:77], v[94:97], v[18:33]
  ds_read_b128 v[86:89], v100 offset:2048
  ds_read_b128 v[70:73], v98 offset:2048
  v_mfma_f32_32x32x16_bf16 v[34:49], v[78:81], v[90:93], v[34:49]
  v_mfma_f32_32x32x16_bf16 v[50:65], v[78:81], v[94:97], v[50:65]
  s_waitcnt lgkmcnt(0)
  v_mfma_f32_32x32x16_bf16 v[2:17], v[66:69], v[82:85], v[2:17]
  ds_read_b128 v[74:77], v98 offset:1024
  ds_read_b128 v[90:93], v100 offset:1024
  v_mfma_f32_32x32x16_bf16 v[18:33], v[66:69], v[86:89], v[18:33]
  ds_read_b128 v[94:97], v100 offset:3072
  ds_read_b128 v[78:81], v98 offset:3072
  v_mfma_f32_32x32x16_bf16 v[34:49], v[70:73], v[82:85], v[34:49]
  v_mfma_f32_32x32x16_bf16 v[50:65], v[70:73], v[86:89], v[50:65]
  s_waitcnt lgkmcnt(0)
  s_barrier
  v_mfma_f32_32x32x16_bf16 v[2:17], v[74:77], v[90:93], v[2:17]
  ds_read_b128 v[66:69], v98 offset:16384
  ds_read_b128 v[82:85], v100 offset:16384
  v_mfma_f32_32x32x16_bf16 v[18:33], v[74:77], v[94:97], v[18:33]
  ds_read_b128 v[86:89], v100 offset:18432
  ds_read_b128 v[70:73], v98 offset:18432
  v_mfma_f32_32x32x16_bf16 v[34:49], v[78:81], v[90:93], v[34:49]
  v_mfma_f32_32x32x16_bf16 v[50:65], v[78:81], v[94:97], v[50:65]
  s_waitcnt lgkmcnt(0)
  v_mfma_f32_32x32x16_bf16 v[2:17], v[66:69], v[82:85], v[2:17]
  ds_read_b128 v[74:77], v98 offset:17408
  ds_read_b128 v[90:93], v100 offset:17408
  v_mfma_f32_32x32x16_bf16 v[18:33], v[66:69], v[86:89], v[18:33]
  ds_read_b128 v[94:97], v100 offset:19456
  ds_read_b128 v[78:81], v98 offset:19456
  v_mfma_f32_32x32x16_bf16 v[34:49], v[70:73], v[82:85], v[34:49]
  v_mfma_f32_32x32x16_bf16 v[50:65], v[70:73], v[86:89], v[50:65]
  s_waitcnt lgkmcnt(0)
  s_barrier
  v_mfma_f32_32x32x16_bf16 v[2:17], v[74:77], v[90:93], v[2:17]
  ds_read_b128 v[66:69], v98 offset:32768
  ds_read_b128 v[82:85], v100 offset:32768
  v_mfma_f32_32x32x16_bf16 v[18:33], v[74:77], v[94:97], v[18:33]
  ds_read_b128 v[86:89], v100 offset:34816
  ds_read_b128 v[70:73], v98 offset:34816
  v_mfma_f32_32x32x16_bf16 v[34:49], v[78:81], v[90:93], v[34:49]
  v_mfma_f32_32x32x16_bf16 v[50:65], v[78:81], v[94:97], v[50:65]
  s_waitcnt lgkmcnt(0)
  v_mfma_f32_32x32x16_bf16 v[2:17], v[66:69], v[82:85], v[2:17]
  ds_read_b128 v[74:77], v98 offset:33792
  ds_read_b128 v[90:93], v100 offset:33792
  v_mfma_f32_32x32x16_bf16 v[18:33], v[66:69], v[86:89], v[18:33]
  ds_read_b128 v[94:97], v100 offset:35840
  ds_read_b128 v[78:81], v98 offset:35840
  v_mfma_f32_32x32x16_bf16 v[34:49], v[70:73], v[82:85], v[34:49]
  v_mfma_f32_32x32x16_bf16 v[50:65], v[70:73], v[86:89], v[50:65]
  s_waitcnt lgkmcnt(0)
  s_barrier
  v_mfma_f32_32x32x16_bf16 v[2:17], v[74:77], v[90:93], v[2:17]
  ds_read_b128 v[66:69], v98 offset:49152
  ds_read_b128 v[82:85], v100 offset:49152
  v_mfma_f32_32x32x16_bf16 v[18:33], v[74:77], v[94:97], v[18:33]
  ds_read_b128 v[86:89], v100 offset:51200
  ds_read_b128 v[70:73], v98 offset:51200
  v_mfma_f32_32x32x16_bf16 v[34:49], v[78:81], v[90:93], v[34:49]
  v_mfma_f32_32x32x16_bf16 v[50:65], v[78:81], v[94:97], v[50:65]
  s_waitcnt lgkmcnt(0)
  v_mfma_f32_32x32x16_bf16 v[2:17], v[66:69], v[82:85], v[2:17]
  ds_read_b128 v[74:77], v98 offset:50176
  ds_read_b128 v[90:93], v100 offset:50176
  v_mfma_f32_32x32x16_bf16 v[18:33], v[66:69], v[86:89], v[18:33]
  ds_read_b128 v[94:97], v100 offset:52224
  ds_read_b128 v[78:81], v98 offset:52224
  v_mfma_f32_32x32x16_bf16 v[34:49], v[70:73], v[82:85], v[34:49]
  v_mfma_f32_32x32x16_bf16 v[50:65], v[70:73], v[86:89], v[50:65]
  s_waitcnt lgkmcnt(0)
  s_barrier
  v_mfma_f32_32x32x16_bf16 v[2:17], v[74:77], v[90:93], v[2:17]
  ds_read_b128 v[66:69], v99 offset:0
  ds_read_b128 v[82:85], v101 offset:0
  v_mfma_f32_32x32x16_bf16 v[18:33], v[74:77], v[94:97], v[18:33]
  ds_read_b128 v[86:89], v101 offset:2048
  ds_read_b128 v[70:73], v99 offset:2048
  v_mfma_f32_32x32x16_bf16 v[34:49], v[78:81], v[90:93], v[34:49]
  v_mfma_f32_32x32x16_bf16 v[50:65], v[78:81], v[94:97], v[50:65]
  s_waitcnt lgkmcnt(0)
  v_mfma_f32_32x32x16_bf16 v[2:17], v[66:69], v[82:85], v[2:17]
  ds_read_b128 v[74:77], v99 offset:1024
  ds_read_b128 v[90:93], v101 offset:1024
  v_mfma_f32_32x32x16_bf16 v[18:33], v[66:69], v[86:89], v[18:33]
  ds_read_b128 v[94:97], v101 offset:3072
  ds_read_b128 v[78:81], v99 offset:3072
  v_mfma_f32_32x32x16_bf16 v[34:49], v[70:73], v[82:85], v[34:49]
  v_mfma_f32_32x32x16_bf16 v[50:65], v[70:73], v[86:89], v[50:65]
  s_waitcnt lgkmcnt(0)
  s_barrier
  v_mfma_f32_32x32x16_bf16 v[2:17], v[74:77], v[90:93], v[2:17]
  ds_read_b128 v[66:69], v98 offset:0
  ds_read_b128 v[82:85], v100 offset:0
  v_mfma_f32_32x32x16_bf16 v[18:33], v[74:77], v[94:97], v[18:33]
  ds_read_b128 v[86:89], v100 offset:2048
  ds_read_b128 v[70:73], v98 offset:2048
  v_mfma_f32_32x32x16_bf16 v[34:49], v[78:81], v[90:93], v[34:49]
  v_mfma_f32_32x32x16_bf16 v[50:65], v[78:81], v[94:97], v[50:65]
  s_waitcnt lgkmcnt(0)
  v_mfma_f32_32x32x16_bf16 v[2:17], v[66:69], v[82:85], v[2:17]
  ds_read_b128 v[74:77], v98 offset:1024
  ds_read_b128 v[90:93], v100 offset:1024
  v_mfma_f32_32x32x16_bf16 v[18:33], v[66:69], v[86:89], v[18:33]
  ds_read_b128 v[94:97], v100 offset:3072
  ds_read_b128 v[78:81], v98 offset:3072
  v_mfma_f32_32x32x16_bf16 v[34:49], v[70:73], v[82:85], v[34:49]
  v_mfma_f32_32x32x16_bf16 v[50:65], v[70:73], v[86:89], v[50:65]
  s_waitcnt lgkmcnt(0)
  s_barrier
  v_mfma_f32_32x32x16_bf16 v[2:17], v[74:77], v[90:93], v[2:17]
  ds_read_b128 v[66:69], v98 offset:16384
  ds_read_b128 v[82:85], v100 offset:16384
  v_mfma_f32_32x32x16_bf16 v[18:33], v[74:77], v[94:97], v[18:33]
  ds_read_b128 v[86:89], v100 offset:18432
  ds_read_b128 v[70:73], v98 offset:18432
  v_mfma_f32_32x32x16_bf16 v[34:49], v[78:81], v[90:93], v[34:49]
  v_mfma_f32_32x32x16_bf16 v[50:65], v[78:81], v[94:97], v[50:65]
  s_waitcnt lgkmcnt(0)
  v_mfma_f32_32x32x16_bf16 v[2:17], v[66:69], v[82:85], v[2:17]
  ds_read_b128 v[74:77], v98 offset:17408
  ds_read_b128 v[90:93], v100 offset:17408
  v_mfma_f32_32x32x16_bf16 v[18:33], v[66:69], v[86:89], v[18:33]
  ds_read_b128 v[94:97], v100 offset:19456
  ds_read_b128 v[78:81], v98 offset:19456
  v_mfma_f32_32x32x16_bf16 v[34:49], v[70:73], v[82:85], v[34:49]
  v_mfma_f32_32x32x16_bf16 v[50:65], v[70:73], v[86:89], v[50:65]
  s_waitcnt lgkmcnt(0)
  s_barrier
  v_mfma_f32_32x32x16_bf16 v[2:17], v[74:77], v[90:93], v[2:17]
  ds_read_b128 v[66:69], v98 offset:32768
  ds_read_b128 v[82:85], v100 offset:32768
  v_mfma_f32_32x32x16_bf16 v[18:33], v[74:77], v[94:97], v[18:33]
  ds_read_b128 v[86:89], v100 offset:34816
  ds_read_b128 v[70:73], v98 offset:34816
  v_mfma_f32_32x32x16_bf16 v[34:49], v[78:81], v[90:93], v[34:49]
  v_mfma_f32_32x32x16_bf16 v[50:65], v[78:81], v[94:97], v[50:65]
  s_waitcnt lgkmcnt(0)
  v_mfma_f32_32x32x16_bf16 v[2:17], v[66:69], v[82:85], v[2:17]
  ds_read_b128 v[74:77], v98 offset:33792
  ds_read_b128 v[90:93], v100 offset:33792
  v_mfma_f32_32x32x16_bf16 v[18:33], v[66:69], v[86:89], v[18:33]
  ds_read_b128 v[94:97], v100 offset:35840
  ds_read_b128 v[78:81], v98 offset:35840
  v_mfma_f32_32x32x16_bf16 v[34:49], v[70:73], v[82:85], v[34:49]
  v_mfma_f32_32x32x16_bf16 v[50:65], v[70:73], v[86:89], v[50:65]
  s_waitcnt lgkmcnt(0)
  s_barrier
  v_mfma_f32_32x32x16_bf16 v[2:17], v[74:77], v[90:93], v[2:17]
  ds_read_b128 v[66:69], v98 offset:49152
  ds_read_b128 v[82:85], v100 offset:49152
  v_mfma_f32_32x32x16_bf16 v[18:33], v[74:77], v[94:97], v[18:33]
  ds_read_b128 v[86:89], v100 offset:51200
  ds_read_b128 v[70:73], v98 offset:51200
  v_mfma_f32_32x32x16_bf16 v[34:49], v[78:81], v[90:93], v[34:49]
  v_mfma_f32_32x32x16_bf16 v[50:65], v[78:81], v[94:97], v[50:65]
  s_waitcnt lgkmcnt(0)
  v_mfma_f32_32x32x16_bf16 v[2:17], v[66:69], v[82:85], v[2:17]
  ds_read_b128 v[74:77], v98 offset:50176
  ds_read_b128 v[90:93], v100 offset:50176
  v_mfma_f32_32x32x16_bf16 v[18:33], v[66:69], v[86:89], v[18:33]
  ds_read_b128 v[94:97], v100 offset:52224
  ds_read_b128 v[78:81], v98 offset:52224
  v_mfma_f32_32x32x16_bf16 v[34:49], v[70:73], v[82:85], v[34:49]
  v_mfma_f32_32x32x16_bf16 v[50:65], v[70:73], v[86:89], v[50:65]
  s_waitcnt lgkmcnt(0)
  s_barrier
  v_mfma_f32_32x32x16_bf16 v[2:17], v[74:77], v[90:93], v[2:17]
  ds_read_b128 v[66:69], v99 offset:0
  ds_read_b128 v[82:85], v101 offset:0
  v_mfma_f32_32x32x16_bf16 v[18:33], v[74:77], v[94:97], v[18:33]
  ds_read_b128 v[86:89], v101 offset:2048
  ds_read_b128 v[70:73], v99 offset:2048
  v_mfma_f32_32x32x16_bf16 v[34:49], v[78:81], v[90:93], v[34:49]
  v_mfma_f32_32x32x16_bf16 v[50:65], v[78:81], v[94:97], v[50:65]
  s_waitcnt lgkmcnt(0)
  v_mfma_f32_32x32x16_bf16 v[2:17], v[66:69], v[82:85], v[2:17]
  ds_read_b128 v[74:77], v99 offset:1024
  ds_read_b128 v[90:93], v101 offset:1024
  v_mfma_f32_32x32x16_bf16 v[18:33], v[66:69], v[86:89], v[18:33]
  ds_read_b128 v[94:97], v101 offset:3072
  ds_read_b128 v[78:81], v99 offset:3072
  v_mfma_f32_32x32x16_bf16 v[34:49], v[70:73], v[82:85], v[34:49]
  v_mfma_f32_32x32x16_bf16 v[50:65], v[70:73], v[86:89], v[50:65]
  s_waitcnt lgkmcnt(0)
  s_barrier
  v_mfma_f32_32x32x16_bf16 v[2:17], v[74:77], v[90:93], v[2:17]
  ds_read_b128 v[66:69], v98 offset:0
  ds_read_b128 v[82:85], v100 offset:0
  v_mfma_f32_32x32x16_bf16 v[18:33], v[74:77], v[94:97], v[18:33]
  ds_read_b128 v[86:89], v100 offset:2048
  ds_read_b128 v[70:73], v98 offset:2048
  v_mfma_f32_32x32x16_bf16 v[34:49], v[78:81], v[90:93], v[34:49]
  v_mfma_f32_32x32x16_bf16 v[50:65], v[78:81], v[94:97], v[50:65]
  s_waitcnt lgkmcnt(0)
  v_mfma_f32_32x32x16_bf16 v[2:17], v[66:69], v[82:85], v[2:17]
  ds_read_b128 v[74:77], v98 offset:1024
  ds_read_b128 v[90:93], v100 offset:1024
  v_mfma_f32_32x32x16_bf16 v[18:33], v[66:69], v[86:89], v[18:33]
  ds_read_b128 v[94:97], v100 offset:3072
  ds_read_b128 v[78:81], v98 offset:3072
  v_mfma_f32_32x32x16_bf16 v[34:49], v[70:73], v[82:85], v[34:49]
  v_mfma_f32_32x32x16_bf16 v[50:65], v[70:73], v[86:89], v[50:65]
  s_waitcnt lgkmcnt(0)
  s_barrier
  v_mfma_f32_32x32x16_bf16 v[2:17], v[74:77], v[90:93], v[2:17]
  ds_read_b128 v[66:69], v98 offset:16384
  ds_read_b128 v[82:85], v100 offset:16384
  v_mfma_f32_32x32x16_bf16 v[18:33], v[74:77], v[94:97], v[18:33]
  ds_read_b128 v[86:89], v100 offset:18432
  ds_read_b128 v[70:73], v98 offset:18432
  v_mfma_f32_32x32x16_bf16 v[34:49], v[78:81], v[90:93], v[34:49]
  v_mfma_f32_32x32x16_bf16 v[50:65], v[78:81], v[94:97], v[50:65]
  s_waitcnt lgkmcnt(0)
  v_mfma_f32_32x32x16_bf16 v[2:17], v[66:69], v[82:85], v[2:17]
  ds_read_b128 v[74:77], v98 offset:17408
  ds_read_b128 v[90:93], v100 offset:17408
  v_mfma_f32_32x32x16_bf16 v[18:33], v[66:69], v[86:89], v[18:33]
  ds_read_b128 v[94:97], v100 offset:19456
  ds_read_b128 v[78:81], v98 offset:19456
  v_mfma_f32_32x32x16_bf16 v[34:49], v[70:73], v[82:85], v[34:49]
  v_mfma_f32_32x32x16_bf16 v[50:65], v[70:73], v[86:89], v[50:65]
  s_waitcnt lgkmcnt(0)
  s_barrier
  v_mfma_f32_32x32x16_bf16 v[2:17], v[74:77], v[90:93], v[2:17]
  ds_read_b128 v[66:69], v98 offset:32768
  ds_read_b128 v[82:85], v100 offset:32768
  v_mfma_f32_32x32x16_bf16 v[18:33], v[74:77], v[94:97], v[18:33]
  ds_read_b128 v[86:89], v100 offset:34816
  ds_read_b128 v[70:73], v98 offset:34816
  v_mfma_f32_32x32x16_bf16 v[34:49], v[78:81], v[90:93], v[34:49]
  v_mfma_f32_32x32x16_bf16 v[50:65], v[78:81], v[94:97], v[50:65]
  s_waitcnt lgkmcnt(0)
  v_mfma_f32_32x32x16_bf16 v[2:17], v[66:69], v[82:85], v[2:17]
  ds_read_b128 v[74:77], v98 offset:33792
  ds_read_b128 v[90:93], v100 offset:33792
  v_mfma_f32_32x32x16_bf16 v[18:33], v[66:69], v[86:89], v[18:33]
  ds_read_b128 v[94:97], v100 offset:35840
  ds_read_b128 v[78:81], v98 offset:35840
  v_mfma_f32_32x32x16_bf16 v[34:49], v[70:73], v[82:85], v[34:49]
  v_mfma_f32_32x32x16_bf16 v[50:65], v[70:73], v[86:89], v[50:65]
  s_waitcnt lgkmcnt(0)
  v_mfma_f32_32x32x16_bf16 v[2:17], v[74:77], v[90:93], v[2:17]
  v_mfma_f32_32x32x16_bf16 v[18:33], v[74:77], v[94:97], v[18:33]
  v_mfma_f32_32x32x16_bf16 v[34:49], v[78:81], v[90:93], v[34:49]
  v_mfma_f32_32x32x16_bf16 v[50:65], v[78:81], v[94:97], v[50:65]
  s_setprio 3
  s_waitcnt vmcnt(0)
  v_sub_f32 v108, 0, v103
  s_nop 5
  v_fma_f32 v110, v102, v2, v3
  v_fma_f32 v111, v102, v18, v19
  v_fmac_f32 v110, v108, v18
  v_fmac_f32 v111, v103, v2
  v_fma_f32 v112, v102, v110, v4
  v_fma_f32 v113, v102, v111, v20
  v_fmac_f32 v112, v108, v111
  v_fmac_f32 v113, v103, v110
  v_fma_f32 v110, v102, v112, v5
  v_fma_f32 v111, v102, v113, v21
  v_fmac_f32 v110, v108, v113
  v_fmac_f32 v111, v103, v112
  v_fma_f32 v112, v102, v110, v6
  v_fma_f32 v113, v102, v111, v22
  v_fmac_f32 v112, v108, v111
  v_fmac_f32 v113, v103, v110
  v_fma_f32 v110, v102, v112, v7
  v_fma_f32 v111, v102, v113, v23
  v_fmac_f32 v110, v108, v113
  v_fmac_f32 v111, v103, v112
  v_fma_f32 v112, v102, v110, v8
  v_fma_f32 v113, v102, v111, v24
  v_fmac_f32 v112, v108, v111
  v_fmac_f32 v113, v103, v110
  v_fma_f32 v110, v102, v112, v9
  v_fma_f32 v111, v102, v113, v25
  v_fmac_f32 v110, v108, v113
  v_fmac_f32 v111, v103, v112
  v_fma_f32 v112, v102, v110, v10
  v_fma_f32 v113, v102, v111, v26
  v_fmac_f32 v112, v108, v111
  v_fmac_f32 v113, v103, v110
  v_fma_f32 v110, v102, v112, v11
  v_fma_f32 v111, v102, v113, v27
  v_fmac_f32 v110, v108, v113
  v_fmac_f32 v111, v103, v112
  v_fma_f32 v112, v102, v110, v12
  v_fma_f32 v113, v102, v111, v28
  v_fmac_f32 v112, v108, v111
  v_fmac_f32 v113, v103, v110
  v_fma_f32 v110, v102, v112, v13
  v_fma_f32 v111, v102, v113, v29
  v_fmac_f32 v110, v108, v113
  v_fmac_f32 v111, v103, v112
  v_fma_f32 v112, v102, v110, v14
  v_fma_f32 v113, v102, v111, v30
  v_fmac_f32 v112, v108, v111
  v_fmac_f32 v113, v103, v110
  v_fma_f32 v110, v102, v112, v15
  v_fma_f32 v111, v102, v113, v31
  v_fmac_f32 v110, v108, v113
  v_fmac_f32 v111, v103, v112
  v_fma_f32 v112, v102, v110, v16
  v_fma_f32 v113, v102, v111, v32
  v_fmac_f32 v112, v108, v111
  v_fmac_f32 v113, v103, v110
  v_fma_f32 v110, v102, v112, v17
  v_fma_f32 v111, v102, v113, v33
  v_fmac_f32 v110, v108, v113
  v_fmac_f32 v111, v103, v112
  v_fma_f32 v112, v102, v110, v34
  v_fma_f32 v113, v102, v111, v50
  v_fmac_f32 v112, v108, v111
  v_fmac_f32 v113, v103, v110
  v_fma_f32 v110, v102, v112, v35
  v_fma_f32 v111, v102, v113, v51
  v_fmac_f32 v110, v108, v113
  v_fmac_f32 v111, v103, v112
  v_fma_f32 v112, v102, v110, v36
  v_fma_f32 v113, v102, v111, v52
  v_fmac_f32 v112, v108, v111
  v_fmac_f32 v113, v103, v110
  v_fma_f32 v110, v102, v112, v37
  v_fma_f32 v111, v102, v113, v53
  v_fmac_f32 v110, v108, v113
  v_fmac_f32 v111, v103, v112
  v_fma_f32 v112, v102, v110, v38
  v_fma_f32 v113, v102, v111, v54
  v_fmac_f32 v112, v108, v111
  v_fmac_f32 v113, v103, v110
  v_fma_f32 v110, v102, v112, v39
  v_fma_f32 v111, v102, v113, v55
  v_fmac_f32 v110, v108, v113
  v_fmac_f32 v111, v103, v112
  v_fma_f32 v112, v102, v110, v40
  v_fma_f32 v113, v102, v111, v56
  v_fmac_f32 v112, v108, v111
  v_fmac_f32 v113, v103, v110
  v_fma_f32 v110, v102, v112, v41
  v_fma_f32 v111, v102, v113, v57
  v_fmac_f32 v110, v108, v113
  v_fmac_f32 v111, v103, v112
  v_fma_f32 v112, v102, v110, v42
  v_fma_f32 v113, v102, v111, v58
  v_fmac_f32 v112, v108, v111
  v_fmac_f32 v113, v103, v110
  v_fma_f32 v110, v102, v112, v43
  v_fma_f32 v111, v102, v113, v59
  v_fmac_f32 v110, v108, v113
  v_fmac_f32 v111, v103, v112
  v_fma_f32 v112, v102, v110, v44
  v_fma_f32 v113, v102, v111, v60
  v_fmac_f32 v112, v108, v111
  v_fmac_f32 v113, v103, v110
  v_fma_f32 v110, v102, v112, v45
  v_fma_f32 v111, v102, v113, v61
  v_fmac_f32 v110, v108, v113
  v_fmac_f32 v111, v103, v112
  v_fma_f32 v112, v102, v110, v46
  v_fma_f32 v113, v102, v111, v62
  v_fmac_f32 v112, v108, v111
  v_fmac_f32 v113, v103, v110
  v_fma_f32 v110, v102, v112, v47
  v_fma_f32 v111, v102, v113, v63
  v_fmac_f32 v110, v108, v113
  v_fmac_f32 v111, v103, v112
  v_fma_f32 v112, v102, v110, v48
  v_fma_f32 v113, v102, v111, v64
  v_fmac_f32 v112, v108, v111
  v_fmac_f32 v113, v103, v110
  v_fma_f32 v110, v102, v112, v49
  v_fma_f32 v111, v102, v113, v65
  v_fmac_f32 v110, v108, v113
  v_fmac_f32 v111, v103, v112
  v_lshrrev_b32 v114, 5, v0
  v_lshlrev_b32 v114, 9, v114
  v_and_b32 v115, 31, v0
  v_lshlrev_b32 v115, 3, v115
  s_lshl_b32 s18, s12, 8
  s_add_u32 s18, s18, 79872
  v_add_u32 v115, s18, v115
  s_lshl_b32 s18, s11, 10
  v_add_u32 v114, s18, v114
  v_add_u32 v114, v114, v115
  ds_write_b64 v114, v[110:111]
  s_waitcnt lgkmcnt(0)
  s_barrier
  ds_read_b64 v[98:99], v115 offset:0
  ds_read_b64 v[100:101], v115 offset:512
  ds_read_b64 v[122:123], v115 offset:1024
  ds_read_b64 v[124:125], v115 offset:1536
  s_waitcnt lgkmcnt(2)
  v_fma_f32 v116, v104, v98, v100
  v_fma_f32 v117, v104, v99, v101
  v_fma_f32 v110, -v105, v99, v116
  v_fma_f32 v111, v105, v98, v117
  s_waitcnt lgkmcnt(1)
  v_fma_f32 v116, v104, v110, v122
  v_fma_f32 v117, v104, v111, v123
  v_fma_f32 v112, -v105, v111, v116
  v_fma_f32 v113, v105, v110, v117
  s_waitcnt lgkmcnt(0)
  v_fma_f32 v116, v104, v112, v124
  v_fma_f32 v117, v104, v113, v125
  v_fma_f32 v66, -v105, v113, v116
  v_fma_f32 v68, v105, v112, v117
  v_mov_b32 v67, s21
  v_mov_b32 v69, s21
  s_mul_i32 s18, s8, 576
  v_add_u32 v110, s18, v118
  v_lshlrev_b32 v110, 4, v110
  s_cmp_eq_u32 s11, 0
  s_cbranch_scc0 svc_nopub_9
  s_mov_b32 exec_hi, 0
  buffer_store_dwordx4 v[66:69], v110, s[32:35], 0 offen sc1
  s_mov_b32 exec_hi, -1
svc_nopub_9:
  v_lshrrev_b32 v112, 5, v0
  v_lshlrev_b32 v112, 3, v112
  s_sub_i32 s18, s8, 16
  v_add_u32 v112, s18, v112
  s_movk_i32 s18, 576
  v_mul_lo_u32 v113, v112, s18
  v_add_u32 v113, v113, v118
  v_lshlrev_b32 v113, 4, v113
svc_epoll_10:
  v_add_u32 v110, 0, v113
  buffer_load_dwordx4 v[66:69], v110, s[32:35], 0 offen sc1
  v_add_u32 v110, 9216, v113
  buffer_load_dwordx4 v[70:73], v110, s[32:35], 0 offen sc1
  v_add_u32 v110, 18432, v113
  buffer_load_dwordx4 v[74:77], v110, s[32:35], 0 offen sc1
  v_add_u32 v110, 27648, v113
  buffer_load_dwordx4 v[78:81], v110, s[32:35], 0 offen sc1
  v_add_u32 v110, 36864, v113
  buffer_load_dwordx4 v[82:85], v110, s[32:35], 0 offen sc1
  v_add_u32 v110, 46080, v113
  buffer_load_dwordx4 v[86:89], v110, s[32:35], 0 offen sc1
  v_add_u32 v110, 55296, v113
  buffer_load_dwordx4 v[90:93], v110, s[32:35], 0 offen sc1
  v_add_u32 v110, 64512, v113
  buffer_load_dwordx4 v[94:97], v110, s[32:35], 0 offen sc1
  s_mov_b64 s[28:29], 0
  s_waitcnt vmcnt(7)
  v_cmp_eq_u32 vcc, s21, v67
  v_cmp_eq_u32 s[26:27], s21, v69
  s_nop 3
  s_and_b64 s[26:27], s[26:27], vcc
  v_cmp_gt_i32 vcc, 0, v112
  s_nop 3
  s_or_b64 s[26:27], s[26:27], vcc
  s_orn2_b64 s[28:29], s[28:29], s[26:27]
  s_waitcnt vmcnt(6)
  v_cmp_eq_u32 vcc, s21, v71
  v_cmp_eq_u32 s[26:27], s21, v73
  s_nop 3
  s_and_b64 s[26:27], s[26:27], vcc
  v_cmp_gt_i32 vcc, -1, v112
  s_nop 3
  s_or_b64 s[26:27], s[26:27], vcc
  s_orn2_b64 s[28:29], s[28:29], s[26:27]
  s_waitcnt vmcnt(5)
  v_cmp_eq_u32 vcc, s21, v75
  v_cmp_eq_u32 s[26:27], s21, v77
  s_nop 3
  s_and_b64 s[26:27], s[26:27], vcc
  v_cmp_gt_i32 vcc, -2, v112
  s_nop 3
  s_or_b64 s[26:27], s[26:27], vcc
  s_orn2_b64 s[28:29], s[28:29], s[26:27]
  s_waitcnt vmcnt(4)
  v_cmp_eq_u32 vcc, s21, v79
  v_cmp_eq_u32 s[26:27], s21, v81
  s_nop 3
  s_and_b64 s[26:27], s[26:27], vcc
  v_cmp_gt_i32 vcc, -3, v112
  s_nop 3
  s_or_b64 s[26:27], s[26:27], vcc
  s_orn2_b64 s[28:29], s[28:29], s[26:27]
  s_waitcnt vmcnt(3)
  v_cmp_eq_u32 vcc, s21, v83
  v_cmp_eq_u32 s[26:27], s21, v85
  s_nop 3
  s_and_b64 s[26:27], s[26:27], vcc
  v_cmp_gt_i32 vcc, -4, v112
  s_nop 3
  s_or_b64 s[26:27], s[26:27], vcc
  s_orn2_b64 s[28:29], s[28:29], s[26:27]
  s_waitcnt vmcnt(2)
  v_cmp_eq_u32 vcc, s21, v87
  v_cmp_eq_u32 s[26:27], s21, v89
  s_nop 3
  s_and_b64 s[26:27], s[26:27], vcc
  v_cmp_gt_i32 vcc, -5, v112
  s_nop 3
  s_or_b64 s[26:27], s[26:27], vcc
  s_orn2_b64 s[28:29], s[28:29], s[26:27]
  s_waitcnt vmcnt(1)
  v_cmp_eq_u32 vcc, s21, v91
  v_cmp_eq_u32 s[26:27], s21, v93
  s_nop 3
  s_and_b64 s[26:27], s[26:27], vcc
  v_cmp_gt_i32 vcc, -6, v112
  s_nop 3
  s_or_b64 s[26:27], s[26:27], vcc
  s_orn2_b64 s[28:29], s[28:29], s[26:27]
  s_waitcnt vmcnt(0)
  v_cmp_eq_u32 vcc, s21, v95
  v_cmp_eq_u32 s[26:27], s21, v97
  s_nop 3
  s_and_b64 s[26:27], s[26:27], vcc
  v_cmp_gt_i32 vcc, -7, v112
  s_nop 3
  s_or_b64 s[26:27], s[26:27], vcc
  s_orn2_b64 s[28:29], s[28:29], s[26:27]
  s_cmp_eq_u64 s[28:29], 0
  s_cbranch_scc1 svc_edone_11
  s_sleep 2
  s_branch svc_epoll_10
svc_edone_11:
  v_fma_f32 v116, v106, v66, v70
  v_fma_f32 v117, v106, v68, v72
  v_fma_f32 v114, -v107, v68, v116
  v_fma_f32 v115, v107, v66, v117
  v_fma_f32 v116, v106, v114, v74
  v_fma_f32 v117, v106, v115, v76
  v_fma_f32 v117, v107, v114, v117
  v_fma_f32 v114, -v107, v115, v116
  v_mov_b32 v115, v117
  v_fma_f32 v116, v106, v114, v78
  v_fma_f32 v117, v106, v115, v80
  v_fma_f32 v117, v107, v114, v117
  v_fma_f32 v114, -v107, v115, v116
  v_mov_b32 v115, v117
  v_fma_f32 v116, v106, v114, v82
  v_fma_f32 v117, v106, v115, v84
  v_fma_f32 v117, v107, v114, v117
  v_fma_f32 v114, -v107, v115, v116
  v_mov_b32 v115, v117
  v_fma_f32 v116, v106, v114, v86
  v_fma_f32 v117, v106, v115, v88
  v_fma_f32 v117, v107, v114, v117
  v_fma_f32 v114, -v107, v115, v116
  v_mov_b32 v115, v117
  v_fma_f32 v116, v106, v114, v90
  v_fma_f32 v117, v106, v115, v92
  v_fma_f32 v117, v107, v114, v117
  v_fma_f32 v114, -v107, v115, v116
  v_mov_b32 v115, v117
  v_fma_f32 v116, v106, v114, v94
  v_fma_f32 v117, v106, v115, v96
  v_fma_f32 v117, v107, v114, v117
  v_fma_f32 v114, -v107, v115, v116
  v_mov_b32 v115, v117
  v_mul_f32 v110, v107, v107
  v_add_f32 v111, v106, v106
  v_fma_f32 v106, v106, v106, -v110
  v_mul_f32 v107, v111, v107
  v_mul_f32 v110, v107, v107
  v_add_f32 v111, v106, v106
  v_fma_f32 v106, v106, v106, -v110
  v_mul_f32 v107, v111, v107
  v_mul_f32 v110, v107, v107
  v_add_f32 v111, v106, v106
  v_fma_f32 v106, v106, v106, -v110
  v_mul_f32 v107, v111, v107
  v_mov_b32 v66, v114
  v_mov_b32 v68, v114
  v_mov_b32 v67, v115
  v_mov_b32 v69, v115
  v_permlane32_swap_b32 v66, v68
  s_nop 0
  v_permlane32_swap_b32 v67, v69
  v_fma_f32 v116, v106, v66, v68
  v_fma_f32 v117, v106, v67, v69
  v_fma_f32 v82, -v107, v67, v116
  v_fma_f32 v83, v107, v66, v117
  v_fma_f32 v116, v104, v82, v98
  v_fma_f32 v117, v104, v83, v99
  v_fma_f32 v84, -v105, v83, v116
  v_fma_f32 v85, v105, v82, v117
  v_cmp_le_u32 vcc, 32, v0
  s_cmp_eq_u32 s11, 0
  s_cbranch_scc0 svc_wm1_12
  v_cndmask_b32 v110, v82, v84, vcc
  v_cndmask_b32 v111, v83, v85, vcc
  s_branch svc_gsel_13
svc_wm1_12:
  v_fma_f32 v116, v104, v84, v100
  v_fma_f32 v117, v104, v85, v101
  v_fma_f32 v86, -v105, v85, v116
  v_fma_f32 v87, v105, v84, v117
  v_fma_f32 v116, v104, v86, v122
  v_fma_f32 v117, v104, v87, v123
  v_fma_f32 v88, -v105, v87, v116
  v_fma_f32 v89, v105, v86, v117
  v_cndmask_b32 v110, v86, v88, vcc
  v_cndmask_b32 v111, v87, v89, vcc
svc_gsel_13:
  v_fmac_f32 v2, v102, v110
  v_fmac_f32 v18, v102, v111
  v_fmac_f32 v2, v108, v111
  v_fmac_f32 v18, v103, v110
  v_fmac_f32 v3, v102, v2
  v_fmac_f32 v19, v102, v18
  v_fmac_f32 v3, v108, v18
  v_fmac_f32 v19, v103, v2
  v_fmac_f32 v4, v102, v3
  v_fmac_f32 v20, v102, v19
  v_fmac_f32 v4, v108, v19
  v_fmac_f32 v20, v103, v3
  v_fmac_f32 v5, v102, v4
  v_fmac_f32 v21, v102, v20
  v_fmac_f32 v5, v108, v20
  v_fmac_f32 v21, v103, v4
  v_fmac_f32 v6, v102, v5
  v_fmac_f32 v22, v102, v21
  v_fmac_f32 v6, v108, v21
  v_fmac_f32 v22, v103, v5
  v_fmac_f32 v7, v102, v6
  v_fmac_f32 v23, v102, v22
  v_fmac_f32 v7, v108, v22
  v_fmac_f32 v23, v103, v6
  v_fmac_f32 v8, v102, v7
  v_fmac_f32 v24, v102, v23
  v_fmac_f32 v8, v108, v23
  v_fmac_f32 v24, v103, v7
  v_fmac_f32 v9, v102, v8
  v_fmac_f32 v25, v102, v24
  v_fmac_f32 v9, v108, v24
  v_fmac_f32 v25, v103, v8
  v_fmac_f32 v10, v102, v9
  v_fmac_f32 v26, v102, v25
  v_fmac_f32 v10, v108, v25
  v_fmac_f32 v26, v103, v9
  v_fmac_f32 v11, v102, v10
  v_fmac_f32 v27, v102, v26
  v_fmac_f32 v11, v108, v26
  v_fmac_f32 v27, v103, v10
  v_fmac_f32 v12, v102, v11
  v_fmac_f32 v28, v102, v27
  v_fmac_f32 v12, v108, v27
  v_fmac_f32 v28, v103, v11
  v_fmac_f32 v13, v102, v12
  v_fmac_f32 v29, v102, v28
  v_fmac_f32 v13, v108, v28
  v_fmac_f32 v29, v103, v12
  v_fmac_f32 v14, v102, v13
  v_fmac_f32 v30, v102, v29
  v_fmac_f32 v14, v108, v29
  v_fmac_f32 v30, v103, v13
  v_fmac_f32 v15, v102, v14
  v_fmac_f32 v31, v102, v30
  v_fmac_f32 v15, v108, v30
  v_fmac_f32 v31, v103, v14
  v_fmac_f32 v16, v102, v15
  v_fmac_f32 v32, v102, v31
  v_fmac_f32 v16, v108, v31
  v_fmac_f32 v32, v103, v15
  v_fmac_f32 v17, v102, v16
  v_fmac_f32 v33, v102, v32
  v_fmac_f32 v17, v108, v32
  v_fmac_f32 v33, v103, v16
  v_fmac_f32 v34, v102, v17
  v_fmac_f32 v50, v102, v33
  v_fmac_f32 v34, v108, v33
  v_fmac_f32 v50, v103, v17
  v_fmac_f32 v35, v102, v34
  v_fmac_f32 v51, v102, v50
  v_fmac_f32 v35, v108, v50
  v_fmac_f32 v51, v103, v34
  v_fmac_f32 v36, v102, v35
  v_fmac_f32 v52, v102, v51
  v_fmac_f32 v36, v108, v51
  v_fmac_f32 v52, v103, v35
  v_fmac_f32 v37, v102, v36
  v_fmac_f32 v53, v102, v52
  v_fmac_f32 v37, v108, v52
  v_fmac_f32 v53, v103, v36
  v_fmac_f32 v38, v102, v37
  v_fmac_f32 v54, v102, v53
  v_fmac_f32 v38, v108, v53
  v_fmac_f32 v54, v103, v37
  v_fmac_f32 v39, v102, v38
  v_fmac_f32 v55, v102, v54
  v_fmac_f32 v39, v108, v54
  v_fmac_f32 v55, v103, v38
  v_fmac_f32 v40, v102, v39
  v_fmac_f32 v56, v102, v55
  v_fmac_f32 v40, v108, v55
  v_fmac_f32 v56, v103, v39
  v_fmac_f32 v41, v102, v40
  v_fmac_f32 v57, v102, v56
  v_fmac_f32 v41, v108, v56
  v_fmac_f32 v57, v103, v40
  v_fmac_f32 v42, v102, v41
  v_fmac_f32 v58, v102, v57
  v_fmac_f32 v42, v108, v57
  v_fmac_f32 v58, v103, v41
  v_fmac_f32 v43, v102, v42
  v_fmac_f32 v59, v102, v58
  v_fmac_f32 v43, v108, v58
  v_fmac_f32 v59, v103, v42
  v_fmac_f32 v44, v102, v43
  v_fmac_f32 v60, v102, v59
  v_fmac_f32 v44, v108, v59
  v_fmac_f32 v60, v103, v43
  v_fmac_f32 v45, v102, v44
  v_fmac_f32 v61, v102, v60
  v_fmac_f32 v45, v108, v60
  v_fmac_f32 v61, v103, v44
  v_fmac_f32 v46, v102, v45
  v_fmac_f32 v62, v102, v61
  v_fmac_f32 v46, v108, v61
  v_fmac_f32 v62, v103, v45
  v_fmac_f32 v47, v102, v46
  v_fmac_f32 v63, v102, v62
  v_fmac_f32 v47, v108, v62
  v_fmac_f32 v63, v103, v46
  v_fmac_f32 v48, v102, v47
  v_fmac_f32 v64, v102, v63
  v_fmac_f32 v48, v108, v63
  v_fmac_f32 v64, v103, v47
  v_fmac_f32 v49, v102, v48
  v_fmac_f32 v65, v102, v64
  v_fmac_f32 v49, v108, v64
  v_fmac_f32 v65, v103, v48
  v_and_b32 v114, 31, v0
  v_lshrrev_b32 v115, 1, v114
  v_and_b32 v115, 1, v115
  v_lshlrev_b32 v115, 2, v115
  v_lshrrev_b32 v116, 2, v114
  v_and_b32 v116, 1, v116
  v_lshlrev_b32 v116, 1, v116
  v_or_b32 v115, v115, v116
  v_and_b32 v116, 1, v114
  v_or_b32 v115, v115, v116
  v_lshrrev_b32 v116, 5, v0
  v_lshlrev_b32 v116, 2, v116
  v_xor_b32 v115, v115, v116
  v_lshlrev_b32 v115, 4, v115
  v_lshlrev_b32 v114, 7, v114
  v_add_u32 v110, v114, v115
  s_lshl_b32 s18, s10, 13
  v_add_u32 v110, s18, v110
  v_cvt_pk_bf16_f32 v66, v2, v3
  v_cvt_pk_bf16_f32 v67, v4, v5
  v_cvt_pk_bf16_f32 v68, v6, v7
  v_cvt_pk_bf16_f32 v69, v8, v9
  v_cvt_pk_bf16_f32 v70, v10, v11
  v_cvt_pk_bf16_f32 v71, v12, v13
  v_cvt_pk_bf16_f32 v72, v14, v15
  v_cvt_pk_bf16_f32 v73, v16, v17
  v_cvt_pk_bf16_f32 v74, v34, v35
  v_cvt_pk_bf16_f32 v75, v36, v37
  v_cvt_pk_bf16_f32 v76, v38, v39
  v_cvt_pk_bf16_f32 v77, v40, v41
  v_cvt_pk_bf16_f32 v78, v42, v43
  v_cvt_pk_bf16_f32 v79, v44, v45
  v_cvt_pk_bf16_f32 v80, v46, v47
  v_cvt_pk_bf16_f32 v81, v48, v49
  v_xor_b32 v112, 0, v110
  ds_write_b128 v112, v[66:69] offset:0
  v_xor_b32 v112, 16, v110
  ds_write_b128 v112, v[70:73] offset:0
  v_xor_b32 v112, 32, v110
  ds_write_b128 v112, v[74:77] offset:0
  v_xor_b32 v112, 48, v110
  ds_write_b128 v112, v[78:81] offset:0
  v_cvt_pk_bf16_f32 v82, v18, v19
  v_cvt_pk_bf16_f32 v83, v20, v21
  v_cvt_pk_bf16_f32 v84, v22, v23
  v_cvt_pk_bf16_f32 v85, v24, v25
  v_cvt_pk_bf16_f32 v86, v26, v27
  v_cvt_pk_bf16_f32 v87, v28, v29
  v_cvt_pk_bf16_f32 v88, v30, v31
  v_cvt_pk_bf16_f32 v89, v32, v33
  v_cvt_pk_bf16_f32 v90, v50, v51
  v_cvt_pk_bf16_f32 v91, v52, v53
  v_cvt_pk_bf16_f32 v92, v54, v55
  v_cvt_pk_bf16_f32 v93, v56, v57
  v_cvt_pk_bf16_f32 v94, v58, v59
  v_cvt_pk_bf16_f32 v95, v60, v61
  v_cvt_pk_bf16_f32 v96, v62, v63
  v_cvt_pk_bf16_f32 v97, v64, v65
  v_xor_b32 v112, 0, v110
  ds_write_b128 v112, v[82:85] offset:4096
  v_xor_b32 v112, 16, v110
  ds_write_b128 v112, v[86:89] offset:4096
  v_xor_b32 v112, 32, v110
  ds_write_b128 v112, v[90:93] offset:4096
  v_xor_b32 v112, 48, v110
  ds_write_b128 v112, v[94:97] offset:4096
  v_lshrrev_b32 v114, 5, v0
  v_lshlrev_b32 v114, 3, v114
  v_lshrrev_b32 v115, 2, v0
  v_and_b32 v115, 3, v115
  v_add_u32 v114, v114, v115
  v_lshlrev_b32 v114, 7, v114
  v_lshrrev_b32 v115, 4, v0
  v_and_b32 v115, 1, v115
  v_lshlrev_b32 v115, 1, v115
  v_lshrrev_b32 v116, 1, v0
  v_and_b32 v116, 1, v116
  v_or_b32 v115, v115, v116
  v_lshrrev_b32 v116, 3, v0
  v_and_b32 v116, 1, v116
  v_lshlrev_b32 v116, 2, v116
  v_xor_b32 v115, v115, v116
  v_lshrrev_b32 v116, 2, v0
  v_and_b32 v116, 1, v116
  v_xor_b32 v115, v115, v116
  v_lshlrev_b32 v115, 4, v115
  v_and_b32 v116, 1, v0
  v_lshlrev_b32 v116, 3, v116
  v_add_u32 v114, v114, v115
  v_add_u32 v114, v114, v116
  v_add_u32 v111, s18, v114
  s_lshl_b32 s18, s8, 2
  s_lshl_b32 s19, s11, 1
  s_add_u32 s18, s18, s19
  s_mul_i32 s18, s18, 72
  s_lshl_b32 s19, s9, 2
  s_add_u32 s18, s18, s19
  s_lshl_b32 s19, s12, 1
  s_add_u32 s18, s18, s19
  s_lshl_b32 s18, s18, 10
  s_add_u32 s18, s18, 11534336
  s_waitcnt lgkmcnt(0)
  v_xor_b32 v114, 0, v111
  v_xor_b32 v115, 32, v111
  v_xor_b32 v116, 64, v111
  v_xor_b32 v117, 96, v111
  ds_read_b64_tr_b16 v[2:3], v114 offset:0
  ds_read_b64_tr_b16 v[4:5], v115 offset:512
  ds_read_b64_tr_b16 v[6:7], v114 offset:2048
  ds_read_b64_tr_b16 v[8:9], v115 offset:2560
  ds_read_b64_tr_b16 v[10:11], v114 offset:4096
  ds_read_b64_tr_b16 v[12:13], v115 offset:4608
  ds_read_b64_tr_b16 v[14:15], v114 offset:6144
  ds_read_b64_tr_b16 v[16:17], v115 offset:6656
  ds_read_b64_tr_b16 v[18:19], v116 offset:0
  ds_read_b64_tr_b16 v[20:21], v117 offset:512
  ds_read_b64_tr_b16 v[22:23], v116 offset:2048
  ds_read_b64_tr_b16 v[24:25], v117 offset:2560
  ds_read_b64_tr_b16 v[26:27], v116 offset:4096
  ds_read_b64_tr_b16 v[28:29], v117 offset:4608
  ds_read_b64_tr_b16 v[30:31], v116 offset:6144
  ds_read_b64_tr_b16 v[32:33], v117 offset:6656
  s_add_u32 s19, s18, 0
  s_waitcnt lgkmcnt(14)
  buffer_store_dwordx4 v[2:5], v1, s[4:7], s19 offen offset:0 sc1
  s_waitcnt lgkmcnt(12)
  buffer_store_dwordx4 v[6:9], v1, s[4:7], s19 offen offset:1024 sc1
  s_add_u32 s19, s18, 36864
  s_waitcnt lgkmcnt(10)
  buffer_store_dwordx4 v[10:13], v1, s[4:7], s19 offen offset:0 sc1
  s_waitcnt lgkmcnt(8)
  buffer_store_dwordx4 v[14:17], v1, s[4:7], s19 offen offset:1024 sc1
  s_add_u32 s19, s18, 73728
  s_waitcnt lgkmcnt(6)
  buffer_store_dwordx4 v[18:21], v1, s[4:7], s19 offen offset:0 sc1
  s_waitcnt lgkmcnt(4)
  buffer_store_dwordx4 v[22:25], v1, s[4:7], s19 offen offset:1024 sc1
  s_add_u32 s19, s18, 110592
  s_waitcnt lgkmcnt(2)
  buffer_store_dwordx4 v[26:29], v1, s[4:7], s19 offen offset:0 sc1
  s_waitcnt lgkmcnt(0)
  buffer_store_dwordx4 v[30:33], v1, s[4:7], s19 offen offset:1024 sc1
  s_waitcnt vmcnt(0)
  s_barrier
  s_cmp_eq_u32 s10, 0
  s_cbranch_scc0 svc_noflag_14
  s_lshl_b32 s18, s8, 6
  s_lshl_b32 s19, s9, 2
  s_add_u32 s18, s18, s19
  s_add_u32 s18, s18, 22282240
  v_mov_b32 v2, 1
  v_mov_b32 v3, 0
  s_mov_b32 exec_hi, 0
  s_mov_b32 exec_lo, 1
  buffer_store_dword v2, v3, s[4:7], s18 offen sc1
  s_mov_b64 exec, -1
svc_noflag_14:
  s_mul_i32 s17, s24, 73728
  s_mul_i32 s18, s22, 36864
  s_add_u32 s17, s17, s18
  s_add_u32 s17, s17, 11534336
  s_lshl_b32 s18, s22, 13
  v_add_u32 v114, s18, v1
  v_add_u32 v115, 0x10000, v114
  s_barrier
  buffer_load_dwordx4 v[34:37], v1, s[4:7], s17 offen offset:0 sc1
  buffer_load_dwordx4 v[38:41], v1, s[4:7], s17 offen offset:1024 sc1
  buffer_load_dwordx4 v[42:45], v1, s[4:7], s17 offen offset:2048 sc1
  buffer_load_dwordx4 v[46:49], v1, s[4:7], s17 offen offset:3072 sc1
  s_add_u32 s17, s17, 4096
  buffer_load_dwordx4 v[50:53], v1, s[4:7], s17 offen offset:0 sc1
  buffer_load_dwordx4 v[54:57], v1, s[4:7], s17 offen offset:1024 sc1
  buffer_load_dwordx4 v[58:61], v1, s[4:7], s17 offen offset:2048 sc1
  buffer_load_dwordx4 v[62:65], v1, s[4:7], s17 offen offset:3072 sc1
  s_add_u32 s17, s17, 4096
  buffer_load_dwordx4 v[66:69], v1, s[4:7], s17 offen offset:0 sc1
  buffer_load_dwordx4 v[70:73], v1, s[4:7], s17 offen offset:1024 sc1
  buffer_load_dwordx4 v[74:77], v1, s[4:7], s17 offen offset:2048 sc1
  buffer_load_dwordx4 v[78:81], v1, s[4:7], s17 offen offset:3072 sc1
  s_setprio 0
  s_load_dwordx2 s[44:45], s[0:1], 64
  s_mov_b32 s46, 1152
  s_mov_b32 s47, 0x00020000
  s_barrier
  ds_read_b128 v[98:101], v114 offset:32768
  ds_read_b128 v[102:105], v114 offset:36864
  ds_read_b128 v[106:109], v114 offset:33792
  ds_read_b128 v[110:113], v114 offset:37888
  s_waitcnt vmcnt(11) lgkmcnt(0)
  v_mfma_f32_32x32x16_bf16 v[2:17], v[98:101], v[34:37], 0
  v_mfma_f32_32x32x16_bf16 v[18:33], v[102:105], v[34:37], 0
  s_add_u32 s17, s17, 4096
  buffer_load_dwordx4 v[34:37], v1, s[4:7], s17 offen offset:0 sc1
  ds_read_b128 v[98:101], v114 offset:34816
  ds_read_b128 v[102:105], v114 offset:38912
  s_waitcnt vmcnt(11)
  v_mfma_f32_32x32x16_bf16 v[2:17], v[106:109], v[38:41], v[2:17]
  v_mfma_f32_32x32x16_bf16 v[18:33], v[110:113], v[38:41], v[18:33]
  buffer_load_dwordx4 v[38:41], v1, s[4:7], s17 offen offset:1024 sc1
  ds_read_b128 v[106:109], v114 offset:35840
  ds_read_b128 v[110:113], v114 offset:39936
  s_waitcnt vmcnt(11) lgkmcnt(3)
  v_mfma_f32_32x32x16_bf16 v[2:17], v[98:101], v[42:45], v[2:17]
  s_waitcnt lgkmcnt(2)
  v_mfma_f32_32x32x16_bf16 v[18:33], v[102:105], v[42:45], v[18:33]
  buffer_load_dwordx4 v[42:45], v1, s[4:7], s17 offen offset:2048 sc1
  s_waitcnt vmcnt(11) lgkmcnt(1)
  v_mfma_f32_32x32x16_bf16 v[2:17], v[106:109], v[46:49], v[2:17]
  s_waitcnt lgkmcnt(0)
  v_mfma_f32_32x32x16_bf16 v[18:33], v[110:113], v[46:49], v[18:33]
  buffer_load_dwordx4 v[46:49], v1, s[4:7], s17 offen offset:3072 sc1
  s_waitcnt lgkmcnt(0)
  s_barrier
  ds_read_b128 v[98:101], v114 offset:49152
  ds_read_b128 v[102:105], v114 offset:53248
  ds_read_b128 v[106:109], v114 offset:50176
  ds_read_b128 v[110:113], v114 offset:54272
  s_waitcnt vmcnt(11) lgkmcnt(3)
  v_mfma_f32_32x32x16_bf16 v[2:17], v[98:101], v[50:53], v[2:17]
  s_waitcnt lgkmcnt(2)
  v_mfma_f32_32x32x16_bf16 v[18:33], v[102:105], v[50:53], v[18:33]
  s_add_u32 s17, s17, 4096
  buffer_load_dwordx4 v[50:53], v1, s[4:7], s17 offen offset:0 sc1
  ds_read_b128 v[98:101], v114 offset:51200
  ds_read_b128 v[102:105], v114 offset:55296
  s_waitcnt vmcnt(11) lgkmcnt(3)
  v_mfma_f32_32x32x16_bf16 v[2:17], v[106:109], v[54:57], v[2:17]
  s_waitcnt lgkmcnt(2)
  v_mfma_f32_32x32x16_bf16 v[18:33], v[110:113], v[54:57], v[18:33]
  buffer_load_dwordx4 v[54:57], v1, s[4:7], s17 offen offset:1024 sc1
  ds_read_b128 v[106:109], v114 offset:52224
  ds_read_b128 v[110:113], v114 offset:56320
  s_waitcnt vmcnt(11) lgkmcnt(3)
  v_mfma_f32_32x32x16_bf16 v[2:17], v[98:101], v[58:61], v[2:17]
  s_waitcnt lgkmcnt(2)
  v_mfma_f32_32x32x16_bf16 v[18:33], v[102:105], v[58:61], v[18:33]
  buffer_load_dwordx4 v[58:61], v1, s[4:7], s17 offen offset:2048 sc1
  s_waitcnt vmcnt(11) lgkmcnt(1)
  v_mfma_f32_32x32x16_bf16 v[2:17], v[106:109], v[62:65], v[2:17]
  s_waitcnt lgkmcnt(0)
  v_mfma_f32_32x32x16_bf16 v[18:33], v[110:113], v[62:65], v[18:33]
  buffer_load_dwordx4 v[62:65], v1, s[4:7], s17 offen offset:3072 sc1
  s_waitcnt lgkmcnt(0)
  s_barrier
  s_setprio 3
  v_lshrrev_b32 v120, 3, v0
  v_xor_b32 v119, v120, v0
  v_and_b32 v119, 7, v119
  v_mul_u32_u24 v117, 1152, v120
  v_lshlrev_b32 v118, 3, v119
  v_add_u32 v117, v117, v118
  s_mul_i32 s18, s24, 36864
  s_lshl_b32 s19, s9, 7
  s_lshl_b32 s20, s22, 6
  s_add_u32 s19, s19, s20
  s_add_u32 s18, s18, s19
  buffer_load_dwordx2 v[82:83], v117, s[36:39], s18 offen
  s_add_u32 s18, s18, 9216
  buffer_load_dwordx2 v[84:85], v117, s[36:39], s18 offen
  s_add_u32 s18, s18, 9216
  buffer_load_dwordx2 v[86:87], v117, s[36:39], s18 offen
  s_add_u32 s18, s18, 9216
  buffer_load_dwordx2 v[88:89], v117, s[36:39], s18 offen
  buffer_load_dwordx2 v[90:91], v118, s[44:47], s19 offen
  v_lshlrev_b32 v118, 2, v120
  s_lshl_b32 s18, s24, 7
  s_add_u32 s18, s18, 22020096
  buffer_load_dword v92, v118, s[4:7], s18 offen offset:0
  buffer_load_dword v93, v118, s[4:7], s18 offen offset:32
  buffer_load_dword v94, v118, s[4:7], s18 offen offset:64
  buffer_load_dword v95, v118, s[4:7], s18 offen offset:96
  v_and_b32 v117, 31, v0
  v_lshlrev_b32 v117, 2, v117
  buffer_load_dword v116, v117, s[4:7], s18 offen
  v_mul_u32_u24 v120, 2304, v120
  v_lshlrev_b32 v119, 4, v119
  v_add_u32 v119, v119, v120
  s_setprio 0
  ds_read_b128 v[98:101], v115 offset:0
  ds_read_b128 v[102:105], v115 offset:4096
  ds_read_b128 v[106:109], v115 offset:1024
  ds_read_b128 v[110:113], v115 offset:5120
  s_waitcnt vmcnt(21) lgkmcnt(3)
  v_mfma_f32_32x32x16_bf16 v[2:17], v[98:101], v[66:69], v[2:17]
  s_waitcnt lgkmcnt(2)
  v_mfma_f32_32x32x16_bf16 v[18:33], v[102:105], v[66:69], v[18:33]
  s_add_u32 s17, s17, 4096
  buffer_load_dwordx4 v[66:69], v1, s[4:7], s17 offen offset:0 sc1
  ds_read_b128 v[98:101], v115 offset:2048
  ds_read_b128 v[102:105], v115 offset:6144
  s_waitcnt vmcnt(21) lgkmcnt(3)
  v_mfma_f32_32x32x16_bf16 v[2:17], v[106:109], v[70:73], v[2:17]
  s_waitcnt lgkmcnt(2)
  v_mfma_f32_32x32x16_bf16 v[18:33], v[110:113], v[70:73], v[18:33]
  buffer_load_dwordx4 v[70:73], v1, s[4:7], s17 offen offset:1024 sc1
  ds_read_b128 v[106:109], v115 offset:3072
  ds_read_b128 v[110:113], v115 offset:7168
  s_waitcnt vmcnt(21) lgkmcnt(3)
  v_mfma_f32_32x32x16_bf16 v[2:17], v[98:101], v[74:77], v[2:17]
  s_waitcnt lgkmcnt(2)
  v_mfma_f32_32x32x16_bf16 v[18:33], v[102:105], v[74:77], v[18:33]
  buffer_load_dwordx4 v[74:77], v1, s[4:7], s17 offen offset:2048 sc1
  s_waitcnt vmcnt(21) lgkmcnt(1)
  v_mfma_f32_32x32x16_bf16 v[2:17], v[106:109], v[78:81], v[2:17]
  s_waitcnt lgkmcnt(0)
  v_mfma_f32_32x32x16_bf16 v[18:33], v[110:113], v[78:81], v[18:33]
  buffer_load_dwordx4 v[78:81], v1, s[4:7], s17 offen offset:3072 sc1
  s_waitcnt lgkmcnt(0)
  s_barrier
  ds_read_b128 v[98:101], v114 offset:0
  ds_read_b128 v[102:105], v114 offset:4096
  ds_read_b128 v[106:109], v114 offset:1024
  ds_read_b128 v[110:113], v114 offset:5120
  s_waitcnt vmcnt(21) lgkmcnt(3)
  v_mfma_f32_32x32x16_bf16 v[2:17], v[98:101], v[34:37], v[2:17]
  s_waitcnt lgkmcnt(2)
  v_mfma_f32_32x32x16_bf16 v[18:33], v[102:105], v[34:37], v[18:33]
  s_add_u32 s17, s17, 4096
  buffer_load_dwordx4 v[34:37], v1, s[4:7], s17 offen offset:0 sc1
  ds_read_b128 v[98:101], v114 offset:2048
  ds_read_b128 v[102:105], v114 offset:6144
  s_waitcnt vmcnt(21) lgkmcnt(3)
  v_mfma_f32_32x32x16_bf16 v[2:17], v[106:109], v[38:41], v[2:17]
  s_waitcnt lgkmcnt(2)
  v_mfma_f32_32x32x16_bf16 v[18:33], v[110:113], v[38:41], v[18:33]
  buffer_load_dwordx4 v[38:41], v1, s[4:7], s17 offen offset:1024 sc1
  ds_read_b128 v[106:109], v114 offset:3072
  ds_read_b128 v[110:113], v114 offset:7168
  s_waitcnt vmcnt(21) lgkmcnt(3)
  v_mfma_f32_32x32x16_bf16 v[2:17], v[98:101], v[42:45], v[2:17]
  s_waitcnt lgkmcnt(2)
  v_mfma_f32_32x32x16_bf16 v[18:33], v[102:105], v[42:45], v[18:33]
  buffer_load_dwordx4 v[42:45], v1, s[4:7], s17 offen offset:2048 sc1
  s_waitcnt vmcnt(21) lgkmcnt(1)
  v_mfma_f32_32x32x16_bf16 v[2:17], v[106:109], v[46:49], v[2:17]
  s_waitcnt lgkmcnt(0)
  v_mfma_f32_32x32x16_bf16 v[18:33], v[110:113], v[46:49], v[18:33]
  buffer_load_dwordx4 v[46:49], v1, s[4:7], s17 offen offset:3072 sc1
  s_waitcnt lgkmcnt(0)
  s_barrier
  ds_read_b128 v[98:101], v114 offset:16384
  ds_read_b128 v[102:105], v114 offset:20480
  ds_read_b128 v[106:109], v114 offset:17408
  ds_read_b128 v[110:113], v114 offset:21504
  s_waitcnt vmcnt(21) lgkmcnt(3)
  v_mfma_f32_32x32x16_bf16 v[2:17], v[98:101], v[50:53], v[2:17]
  s_waitcnt lgkmcnt(2)
  v_mfma_f32_32x32x16_bf16 v[18:33], v[102:105], v[50:53], v[18:33]
  s_add_u32 s17, s17, 4096
  buffer_load_dwordx4 v[50:53], v1, s[4:7], s17 offen offset:0 sc1
  ds_read_b128 v[98:101], v114 offset:18432
  ds_read_b128 v[102:105], v114 offset:22528
  s_waitcnt vmcnt(21) lgkmcnt(3)
  v_mfma_f32_32x32x16_bf16 v[2:17], v[106:109], v[54:57], v[2:17]
  s_waitcnt lgkmcnt(2)
  v_mfma_f32_32x32x16_bf16 v[18:33], v[110:113], v[54:57], v[18:33]
  buffer_load_dwordx4 v[54:57], v1, s[4:7], s17 offen offset:1024 sc1
  ds_read_b128 v[106:109], v114 offset:19456
  ds_read_b128 v[110:113], v114 offset:23552
  s_waitcnt vmcnt(21) lgkmcnt(3)
  v_mfma_f32_32x32x16_bf16 v[2:17], v[98:101], v[58:61], v[2:17]
  s_waitcnt lgkmcnt(2)
  v_mfma_f32_32x32x16_bf16 v[18:33], v[102:105], v[58:61], v[18:33]
  buffer_load_dwordx4 v[58:61], v1, s[4:7], s17 offen offset:2048 sc1
  s_waitcnt vmcnt(21) lgkmcnt(1)
  v_mfma_f32_32x32x16_bf16 v[2:17], v[106:109], v[62:65], v[2:17]
  s_waitcnt lgkmcnt(0)
  v_mfma_f32_32x32x16_bf16 v[18:33], v[110:113], v[62:65], v[18:33]
  buffer_load_dwordx4 v[62:65], v1, s[4:7], s17 offen offset:3072 sc1
  s_waitcnt lgkmcnt(0)
  s_barrier
  ds_read_b128 v[98:101], v114 offset:32768
  ds_read_b128 v[102:105], v114 offset:36864
  ds_read_b128 v[106:109], v114 offset:33792
  ds_read_b128 v[110:113], v114 offset:37888
  s_waitcnt vmcnt(11) lgkmcnt(3)
  v_mfma_f32_32x32x16_bf16 v[2:17], v[98:101], v[66:69], v[2:17]
  s_waitcnt lgkmcnt(2)
  v_mfma_f32_32x32x16_bf16 v[18:33], v[102:105], v[66:69], v[18:33]
  s_add_u32 s17, s17, 4096
  buffer_load_dwordx4 v[66:69], v1, s[4:7], s17 offen offset:0 sc1
  ds_read_b128 v[98:101], v114 offset:34816
  ds_read_b128 v[102:105], v114 offset:38912
  s_waitcnt vmcnt(11) lgkmcnt(3)
  v_mfma_f32_32x32x16_bf16 v[2:17], v[106:109], v[70:73], v[2:17]
  s_waitcnt lgkmcnt(2)
  v_mfma_f32_32x32x16_bf16 v[18:33], v[110:113], v[70:73], v[18:33]
  buffer_load_dwordx4 v[70:73], v1, s[4:7], s17 offen offset:1024 sc1
  ds_read_b128 v[106:109], v114 offset:35840
  ds_read_b128 v[110:113], v114 offset:39936
  s_waitcnt vmcnt(11) lgkmcnt(3)
  v_mfma_f32_32x32x16_bf16 v[2:17], v[98:101], v[74:77], v[2:17]
  s_waitcnt lgkmcnt(2)
  v_mfma_f32_32x32x16_bf16 v[18:33], v[102:105], v[74:77], v[18:33]
  buffer_load_dwordx4 v[74:77], v1, s[4:7], s17 offen offset:2048 sc1
  s_waitcnt vmcnt(11) lgkmcnt(1)
  v_mfma_f32_32x32x16_bf16 v[2:17], v[106:109], v[78:81], v[2:17]
  s_waitcnt lgkmcnt(0)
  v_mfma_f32_32x32x16_bf16 v[18:33], v[110:113], v[78:81], v[18:33]
  buffer_load_dwordx4 v[78:81], v1, s[4:7], s17 offen offset:3072 sc1
  s_waitcnt lgkmcnt(0)
  s_barrier
  ds_read_b128 v[98:101], v114 offset:49152
  ds_read_b128 v[102:105], v114 offset:53248
  ds_read_b128 v[106:109], v114 offset:50176
  ds_read_b128 v[110:113], v114 offset:54272
  s_waitcnt vmcnt(11) lgkmcnt(3)
  v_mfma_f32_32x32x16_bf16 v[2:17], v[98:101], v[34:37], v[2:17]
  s_waitcnt lgkmcnt(2)
  v_mfma_f32_32x32x16_bf16 v[18:33], v[102:105], v[34:37], v[18:33]
  ds_read_b128 v[98:101], v114 offset:51200
  ds_read_b128 v[102:105], v114 offset:55296
  s_waitcnt vmcnt(10) lgkmcnt(3)
  v_mfma_f32_32x32x16_bf16 v[2:17], v[106:109], v[38:41], v[2:17]
  s_waitcnt lgkmcnt(2)
  v_mfma_f32_32x32x16_bf16 v[18:33], v[110:113], v[38:41], v[18:33]
  ds_read_b128 v[106:109], v114 offset:52224
  ds_read_b128 v[110:113], v114 offset:56320
  s_waitcnt vmcnt(9) lgkmcnt(3)
  v_mfma_f32_32x32x16_bf16 v[2:17], v[98:101], v[42:45], v[2:17]
  s_waitcnt lgkmcnt(2)
  v_mfma_f32_32x32x16_bf16 v[18:33], v[102:105], v[42:45], v[18:33]
  s_waitcnt vmcnt(8) lgkmcnt(1)
  v_mfma_f32_32x32x16_bf16 v[2:17], v[106:109], v[46:49], v[2:17]
  s_waitcnt lgkmcnt(0)
  v_mfma_f32_32x32x16_bf16 v[18:33], v[110:113], v[46:49], v[18:33]
  s_waitcnt lgkmcnt(0)
  s_barrier
  ds_read_b128 v[98:101], v115 offset:0
  ds_read_b128 v[102:105], v115 offset:4096
  ds_read_b128 v[106:109], v115 offset:1024
  ds_read_b128 v[110:113], v115 offset:5120
  s_waitcnt vmcnt(7) lgkmcnt(3)
  v_mfma_f32_32x32x16_bf16 v[2:17], v[98:101], v[50:53], v[2:17]
  s_waitcnt lgkmcnt(2)
  v_mfma_f32_32x32x16_bf16 v[18:33], v[102:105], v[50:53], v[18:33]
  ds_read_b128 v[98:101], v115 offset:2048
  ds_read_b128 v[102:105], v115 offset:6144
  s_waitcnt vmcnt(6) lgkmcnt(3)
  v_mfma_f32_32x32x16_bf16 v[2:17], v[106:109], v[54:57], v[2:17]
  s_waitcnt lgkmcnt(2)
  v_mfma_f32_32x32x16_bf16 v[18:33], v[110:113], v[54:57], v[18:33]
  ds_read_b128 v[106:109], v115 offset:3072
  ds_read_b128 v[110:113], v115 offset:7168
  s_waitcnt vmcnt(5) lgkmcnt(3)
  v_mfma_f32_32x32x16_bf16 v[2:17], v[98:101], v[58:61], v[2:17]
  s_waitcnt lgkmcnt(2)
  v_mfma_f32_32x32x16_bf16 v[18:33], v[102:105], v[58:61], v[18:33]
  s_waitcnt vmcnt(4) lgkmcnt(1)
  v_mfma_f32_32x32x16_bf16 v[2:17], v[106:109], v[62:65], v[2:17]
  s_waitcnt lgkmcnt(0)
  v_mfma_f32_32x32x16_bf16 v[18:33], v[110:113], v[62:65], v[18:33]
  s_waitcnt lgkmcnt(0)
  s_barrier
  ds_read_b128 v[98:101], v114 offset:0
  ds_read_b128 v[102:105], v114 offset:4096
  ds_read_b128 v[106:109], v114 offset:1024
  ds_read_b128 v[110:113], v114 offset:5120
  s_waitcnt vmcnt(3) lgkmcnt(3)
  v_mfma_f32_32x32x16_bf16 v[2:17], v[98:101], v[66:69], v[2:17]
  s_waitcnt lgkmcnt(2)
  v_mfma_f32_32x32x16_bf16 v[18:33], v[102:105], v[66:69], v[18:33]
  ds_read_b128 v[98:101], v114 offset:2048
  ds_read_b128 v[102:105], v114 offset:6144
  s_waitcnt vmcnt(2) lgkmcnt(3)
  v_mfma_f32_32x32x16_bf16 v[2:17], v[106:109], v[70:73], v[2:17]
  s_waitcnt lgkmcnt(2)
  v_mfma_f32_32x32x16_bf16 v[18:33], v[110:113], v[70:73], v[18:33]
  ds_read_b128 v[106:109], v114 offset:3072
  ds_read_b128 v[110:113], v114 offset:7168
  s_waitcnt vmcnt(1) lgkmcnt(3)
  v_mfma_f32_32x32x16_bf16 v[2:17], v[98:101], v[74:77], v[2:17]
  s_waitcnt lgkmcnt(2)
  v_mfma_f32_32x32x16_bf16 v[18:33], v[102:105], v[74:77], v[18:33]
  s_waitcnt vmcnt(0) lgkmcnt(1)
  v_mfma_f32_32x32x16_bf16 v[2:17], v[106:109], v[78:81], v[2:17]
  s_waitcnt lgkmcnt(0)
  v_mfma_f32_32x32x16_bf16 v[18:33], v[110:113], v[78:81], v[18:33]
  s_waitcnt lgkmcnt(0)
  s_setprio 3
  s_barrier
  s_lshl_b32 s18, s24, 7
  s_add_u32 s26, s18, 22284288
  v_and_b32 v121, 31, v0
  v_min_u32 v121, 17, v121
  v_lshlrev_b32 v121, 2, v121
  buffer_load_dword v122, v121, s[4:7], s26 offen sc1
  v_lshlrev_b32 v98, 16, v90
  v_and_b32 v99, 0xffff0000, v90
  v_lshlrev_b32 v100, 16, v91
  v_and_b32 v101, 0xffff0000, v91
  v_lshlrev_b32 v34, 16, v82
  v_and_b32 v35, 0xffff0000, v82
  v_lshlrev_b32 v36, 16, v83
  v_and_b32 v37, 0xffff0000, v83
  v_mul_f32 v34, v34, v98
  v_mul_f32 v35, v35, v99
  v_mul_f32 v36, v36, v100
  v_mul_f32 v37, v37, v101
  v_mul_f32 v34, v34, v92
  v_mul_f32 v35, v35, v92
  v_mul_f32 v36, v36, v92
  v_mul_f32 v37, v37, v92
  v_lshlrev_b32 v38, 16, v84
  v_and_b32 v39, 0xffff0000, v84
  v_lshlrev_b32 v40, 16, v85
  v_and_b32 v41, 0xffff0000, v85
  v_mul_f32 v38, v38, v98
  v_mul_f32 v39, v39, v99
  v_mul_f32 v40, v40, v100
  v_mul_f32 v41, v41, v101
  v_mul_f32 v38, v38, v93
  v_mul_f32 v39, v39, v93
  v_mul_f32 v40, v40, v93
  v_mul_f32 v41, v41, v93
  v_lshlrev_b32 v42, 16, v86
  v_and_b32 v43, 0xffff0000, v86
  v_lshlrev_b32 v44, 16, v87
  v_and_b32 v45, 0xffff0000, v87
  v_mul_f32 v42, v42, v98
  v_mul_f32 v43, v43, v99
  v_mul_f32 v44, v44, v100
  v_mul_f32 v45, v45, v101
  v_mul_f32 v42, v42, v94
  v_mul_f32 v43, v43, v94
  v_mul_f32 v44, v44, v94
  v_mul_f32 v45, v45, v94
  v_lshlrev_b32 v46, 16, v88
  v_and_b32 v47, 0xffff0000, v88
  v_lshlrev_b32 v48, 16, v89
  v_and_b32 v49, 0xffff0000, v89
  v_mul_f32 v46, v46, v98
  v_mul_f32 v47, v47, v99
  v_mul_f32 v48, v48, v100
  v_mul_f32 v49, v49, v101
  v_mul_f32 v46, v46, v95
  v_mul_f32 v47, v47, v95
  v_mul_f32 v48, v48, v95
  v_mul_f32 v49, v49, v95
  v_mul_f32 v2, v116, v2
  v_mul_f32 v3, v116, v3
  v_mul_f32 v4, v116, v4
  v_mul_f32 v5, v116, v5
  v_mul_f32 v6, v116, v6
  v_mul_f32 v7, v116, v7
  v_mul_f32 v8, v116, v8
  v_mul_f32 v9, v116, v9
  v_mul_f32 v10, v116, v10
  v_mul_f32 v11, v116, v11
  v_mul_f32 v12, v116, v12
  v_mul_f32 v13, v116, v13
  v_mul_f32 v14, v116, v14
  v_mul_f32 v15, v116, v15
  v_mul_f32 v16, v116, v16
  v_mul_f32 v17, v116, v17
  v_mul_f32 v18, v116, v18
  v_mul_f32 v19, v116, v19
  v_mul_f32 v20, v116, v20
  v_mul_f32 v21, v116, v21
  v_mul_f32 v22, v116, v22
  v_mul_f32 v23, v116, v23
  v_mul_f32 v24, v116, v24
  v_mul_f32 v25, v116, v25
  v_mul_f32 v26, v116, v26
  v_mul_f32 v27, v116, v27
  v_mul_f32 v28, v116, v28
  v_mul_f32 v29, v116, v29
  v_mul_f32 v30, v116, v30
  v_mul_f32 v31, v116, v31
  v_mul_f32 v32, v116, v32
  v_mul_f32 v33, v116, v33
  v_and_b32 v120, 31, v0
  v_lshrrev_b32 v117, 5, v0
  v_xor_b32 v117, v117, v120
  v_and_b32 v117, 7, v117
  v_lshlrev_b32 v117, 4, v117
  v_lshlrev_b32 v120, 7, v120
  v_add_u32 v117, v117, v120
  s_lshl_b32 s18, s23, 14
  s_lshl_b32 s19, s22, 12
  s_add_u32 s19, s19, s18
  v_add_u32 v117, s19, v117
  s_lshl_b32 s19, s22, 13
  s_add_u32 s19, s19, s18
  v_add_u32 v118, s19, v1
  s_mul_i32 s18, s22, 18432
  s_mul_i32 s17, s24, 36864
  s_add_u32 s17, s17, s18
  s_add_u32 s17, s17, 8388608
  s_waitcnt vmcnt(0)
  s_barrier
svc_apoll_15:
  s_waitcnt vmcnt(0)
  v_cmp_ne_u32 vcc, 1, v122
  s_nop 4
  s_cbranch_vccz svc_adone_16
  s_sleep 1
  buffer_load_dword v122, v121, s[4:7], s26 offen sc1
  s_branch svc_apoll_15
svc_adone_16:
  buffer_load_dwordx4 v[50:53], v1, s[4:7], s17 offen offset:0
  buffer_load_dwordx4 v[54:57], v1, s[4:7], s17 offen offset:1024
  buffer_load_dwordx4 v[58:61], v1, s[4:7], s17 offen offset:2048
  buffer_load_dwordx4 v[62:65], v1, s[4:7], s17 offen offset:3072
  s_add_u32 s17, s17, 4096
  buffer_load_dwordx4 v[66:69], v1, s[4:7], s17 offen offset:0
  buffer_load_dwordx4 v[70:73], v1, s[4:7], s17 offen offset:1024
  buffer_load_dwordx4 v[74:77], v1, s[4:7], s17 offen offset:2048
  buffer_load_dwordx4 v[78:81], v1, s[4:7], s17 offen offset:3072
  s_add_u32 s17, s17, 4096
  buffer_load_dwordx4 v[82:85], v1, s[4:7], s17 offen offset:0
  buffer_load_dwordx4 v[86:89], v1, s[4:7], s17 offen offset:1024
  buffer_load_dwordx4 v[90:93], v1, s[4:7], s17 offen offset:2048
  buffer_load_dwordx4 v[94:97], v1, s[4:7], s17 offen offset:3072
  ds_read_b128 v[98:101], v114 offset:16384
  ds_read_b128 v[102:105], v114 offset:20480
  ds_read_b128 v[106:109], v114 offset:17408
  ds_read_b128 v[110:113], v114 offset:21504
  s_waitcnt vmcnt(11) lgkmcnt(3)
  v_mfma_f32_32x32x16_bf16 v[2:17], v[98:101], v[50:53], v[2:17]
  s_waitcnt lgkmcnt(2)
  v_mfma_f32_32x32x16_bf16 v[18:33], v[102:105], v[50:53], v[18:33]
  s_add_u32 s17, s17, 4096
  buffer_load_dwordx4 v[50:53], v1, s[4:7], s17 offen offset:0
  ds_read_b128 v[98:101], v114 offset:18432
  ds_read_b128 v[102:105], v114 offset:22528
  s_waitcnt vmcnt(11) lgkmcnt(3)
  v_mfma_f32_32x32x16_bf16 v[2:17], v[106:109], v[54:57], v[2:17]
  s_waitcnt lgkmcnt(2)
  v_mfma_f32_32x32x16_bf16 v[18:33], v[110:113], v[54:57], v[18:33]
  buffer_load_dwordx4 v[54:57], v1, s[4:7], s17 offen offset:1024
  ds_read_b128 v[106:109], v114 offset:19456
  ds_read_b128 v[110:113], v114 offset:23552
  s_waitcnt vmcnt(11) lgkmcnt(3)
  v_mfma_f32_32x32x16_bf16 v[2:17], v[98:101], v[58:61], v[2:17]
  s_waitcnt lgkmcnt(2)
  v_mfma_f32_32x32x16_bf16 v[18:33], v[102:105], v[58:61], v[18:33]
  buffer_load_dwordx4 v[58:61], v1, s[4:7], s17 offen offset:2048
  ds_read_b128 v[98:101], v114 offset:32768
  ds_read_b128 v[102:105], v114 offset:36864
  s_waitcnt vmcnt(11) lgkmcnt(3)
  v_mfma_f32_32x32x16_bf16 v[2:17], v[106:109], v[62:65], v[2:17]
  s_waitcnt lgkmcnt(2)
  v_mfma_f32_32x32x16_bf16 v[18:33], v[110:113], v[62:65], v[18:33]
  buffer_load_dwordx4 v[62:65], v1, s[4:7], s17 offen offset:3072
  ds_read_b128 v[106:109], v114 offset:33792
  ds_read_b128 v[110:113], v114 offset:37888
  s_waitcnt vmcnt(11) lgkmcnt(3)
  v_mfma_f32_32x32x16_bf16 v[2:17], v[98:101], v[66:69], v[2:17]
  s_waitcnt lgkmcnt(2)
  v_mfma_f32_32x32x16_bf16 v[18:33], v[102:105], v[66:69], v[18:33]
  s_add_u32 s17, s17, 4096
  buffer_load_dwordx4 v[66:69], v1, s[4:7], s17 offen offset:0
  ds_read_b128 v[98:101], v114 offset:34816
  ds_read_b128 v[102:105], v114 offset:38912
  s_waitcnt vmcnt(11) lgkmcnt(3)
  v_mfma_f32_32x32x16_bf16 v[2:17], v[106:109], v[70:73], v[2:17]
  s_waitcnt lgkmcnt(2)
  v_mfma_f32_32x32x16_bf16 v[18:33], v[110:113], v[70:73], v[18:33]
  buffer_load_dwordx4 v[70:73], v1, s[4:7], s17 offen offset:1024
  ds_read_b128 v[106:109], v114 offset:35840
  ds_read_b128 v[110:113], v114 offset:39936
  s_waitcnt vmcnt(11) lgkmcnt(3)
  v_mfma_f32_32x32x16_bf16 v[2:17], v[98:101], v[74:77], v[2:17]
  s_waitcnt lgkmcnt(2)
  v_mfma_f32_32x32x16_bf16 v[18:33], v[102:105], v[74:77], v[18:33]
  ds_read_b128 v[98:101], v114 offset:49152
  ds_read_b128 v[102:105], v114 offset:53248
  s_waitcnt vmcnt(10) lgkmcnt(3)
  v_mfma_f32_32x32x16_bf16 v[2:17], v[106:109], v[78:81], v[2:17]
  s_waitcnt lgkmcnt(2)
  v_mfma_f32_32x32x16_bf16 v[18:33], v[110:113], v[78:81], v[18:33]
  ds_read_b128 v[106:109], v114 offset:50176
  ds_read_b128 v[110:113], v114 offset:54272
  s_waitcnt vmcnt(9) lgkmcnt(3)
  v_mfma_f32_32x32x16_bf16 v[2:17], v[98:101], v[82:85], v[2:17]
  s_waitcnt lgkmcnt(2)
  v_mfma_f32_32x32x16_bf16 v[18:33], v[102:105], v[82:85], v[18:33]
  ds_read_b128 v[98:101], v114 offset:51200
  ds_read_b128 v[102:105], v114 offset:55296
  s_waitcnt vmcnt(8) lgkmcnt(3)
  v_mfma_f32_32x32x16_bf16 v[2:17], v[106:109], v[86:89], v[2:17]
  s_waitcnt lgkmcnt(2)
  v_mfma_f32_32x32x16_bf16 v[18:33], v[110:113], v[86:89], v[18:33]
  ds_read_b128 v[106:109], v114 offset:52224
  ds_read_b128 v[110:113], v114 offset:56320
  s_waitcnt vmcnt(7) lgkmcnt(3)
  v_mfma_f32_32x32x16_bf16 v[2:17], v[98:101], v[90:93], v[2:17]
  s_waitcnt lgkmcnt(2)
  v_mfma_f32_32x32x16_bf16 v[18:33], v[102:105], v[90:93], v[18:33]
  ds_read_b128 v[98:101], v115 offset:0
  ds_read_b128 v[102:105], v115 offset:4096
  s_waitcnt vmcnt(6) lgkmcnt(3)
  v_mfma_f32_32x32x16_bf16 v[2:17], v[106:109], v[94:97], v[2:17]
  s_waitcnt lgkmcnt(2)
  v_mfma_f32_32x32x16_bf16 v[18:33], v[110:113], v[94:97], v[18:33]
  ds_read_b128 v[106:109], v115 offset:1024
  ds_read_b128 v[110:113], v115 offset:5120
  s_waitcnt vmcnt(5) lgkmcnt(3)
  v_mfma_f32_32x32x16_bf16 v[2:17], v[98:101], v[50:53], v[2:17]
  s_waitcnt lgkmcnt(2)
  v_mfma_f32_32x32x16_bf16 v[18:33], v[102:105], v[50:53], v[18:33]
  ds_read_b128 v[98:101], v115 offset:2048
  ds_read_b128 v[102:105], v115 offset:6144
  s_waitcnt vmcnt(4) lgkmcnt(3)
  v_mfma_f32_32x32x16_bf16 v[2:17], v[106:109], v[54:57], v[2:17]
  s_waitcnt lgkmcnt(2)
  v_mfma_f32_32x32x16_bf16 v[18:33], v[110:113], v[54:57], v[18:33]
  ds_read_b128 v[106:109], v115 offset:3072
  ds_read_b128 v[110:113], v115 offset:7168
  s_waitcnt vmcnt(3) lgkmcnt(3)
  v_mfma_f32_32x32x16_bf16 v[2:17], v[98:101], v[58:61], v[2:17]
  s_waitcnt lgkmcnt(2)
  v_mfma_f32_32x32x16_bf16 v[18:33], v[102:105], v[58:61], v[18:33]
  ds_read_b128 v[98:101], v114 offset:0
  ds_read_b128 v[102:105], v114 offset:4096
  s_waitcnt vmcnt(2) lgkmcnt(3)
  v_mfma_f32_32x32x16_bf16 v[2:17], v[106:109], v[62:65], v[2:17]
  s_waitcnt lgkmcnt(2)
  v_mfma_f32_32x32x16_bf16 v[18:33], v[110:113], v[62:65], v[18:33]
  ds_read_b128 v[106:109], v114 offset:1024
  ds_read_b128 v[110:113], v114 offset:5120
  s_waitcnt vmcnt(1) lgkmcnt(3)
  v_mfma_f32_32x32x16_bf16 v[2:17], v[98:101], v[66:69], v[2:17]
  s_waitcnt lgkmcnt(2)
  v_mfma_f32_32x32x16_bf16 v[18:33], v[102:105], v[66:69], v[18:33]
  s_waitcnt vmcnt(0) lgkmcnt(1)
  v_mfma_f32_32x32x16_bf16 v[2:17], v[106:109], v[70:73], v[2:17]
  s_waitcnt lgkmcnt(0)
  v_mfma_f32_32x32x16_bf16 v[18:33], v[110:113], v[70:73], v[18:33]
  s_barrier
  s_nop 8
  ds_write_b128 v117, v[2:5] offset:0
  v_xor_b32 v120, 32, v117
  ds_write_b128 v120, v[6:9] offset:0
  v_xor_b32 v120, 64, v117
  ds_write_b128 v120, v[10:13] offset:0
  v_xor_b32 v120, 96, v117
  ds_write_b128 v120, v[14:17] offset:0
  ds_write_b128 v117, v[18:21] offset:8192
  v_xor_b32 v120, 32, v117
  ds_write_b128 v120, v[22:25] offset:8192
  v_xor_b32 v120, 64, v117
  ds_write_b128 v120, v[26:29] offset:8192
  v_xor_b32 v120, 96, v117
  ds_write_b128 v120, v[30:33] offset:8192
  s_mul_i32 s18, s24, 73728
  s_lshl_b32 s19, s9, 8
  s_add_u32 s18, s18, s19
  s_lshl_b32 s19, s22, 7
  s_add_u32 s18, s18, s19
  s_waitcnt lgkmcnt(0)
  s_barrier
  ds_read_b128 v[50:53], v118 offset:0
  ds_read_b128 v[54:57], v118 offset:4096
  ds_read_b128 v[58:61], v118 offset:1024
  ds_read_b128 v[62:65], v118 offset:5120
  ds_read_b128 v[66:69], v118 offset:2048
  ds_read_b128 v[70:73], v118 offset:6144
  ds_read_b128 v[74:77], v118 offset:3072
  ds_read_b128 v[78:81], v118 offset:7168
  s_waitcnt lgkmcnt(7)
  v_add_f32 v34, v34, v50
  s_waitcnt lgkmcnt(6)
  v_add_f32 v34, v34, v54
  v_add_f32 v35, v35, v51
  v_add_f32 v35, v35, v55
  v_add_f32 v36, v36, v52
  v_add_f32 v36, v36, v56
  v_add_f32 v37, v37, v53
  v_add_f32 v37, v37, v57
  buffer_store_dwordx4 v[34:37], v119, s[40:43], s18 offen sc1
  s_add_u32 s18, s18, 18432
  s_waitcnt lgkmcnt(5)
  v_add_f32 v38, v38, v58
  s_waitcnt lgkmcnt(4)
  v_add_f32 v38, v38, v62
  v_add_f32 v39, v39, v59
  v_add_f32 v39, v39, v63
  v_add_f32 v40, v40, v60
  v_add_f32 v40, v40, v64
  v_add_f32 v41, v41, v61
  v_add_f32 v41, v41, v65
  buffer_store_dwordx4 v[38:41], v119, s[40:43], s18 offen sc1
  s_add_u32 s18, s18, 18432
  s_waitcnt lgkmcnt(3)
  v_add_f32 v42, v42, v66
  s_waitcnt lgkmcnt(2)
  v_add_f32 v42, v42, v70
  v_add_f32 v43, v43, v67
  v_add_f32 v43, v43, v71
  v_add_f32 v44, v44, v68
  v_add_f32 v44, v44, v72
  v_add_f32 v45, v45, v69
  v_add_f32 v45, v45, v73
  buffer_store_dwordx4 v[42:45], v119, s[40:43], s18 offen sc1
  s_add_u32 s18, s18, 18432
  s_waitcnt lgkmcnt(1)
  v_add_f32 v46, v46, v74
  s_waitcnt lgkmcnt(0)
  v_add_f32 v46, v46, v78
  v_add_f32 v47, v47, v75
  v_add_f32 v47, v47, v79
  v_add_f32 v48, v48, v76
  v_add_f32 v48, v48, v80
  v_add_f32 v49, v49, v77
  v_add_f32 v49, v49, v81
  buffer_store_dwordx4 v[46:49], v119, s[40:43], s18 offen sc1
  s_endpgm
svc_loader:
  s_lshl_b32 s18, s8, 2
  s_add_u32 s18, s18, s23
  s_mul_i32 s14, s18, 36864
  s_add_u32 s14, s14, 16777216
  s_lshl_b32 s18, s9, 2
  s_add_u32 s18, s18, s23
  s_mul_i32 s15, s18, 36864
  s_add_u32 s15, s15, 19136512
  s_lshl_b32 s13, s23, 11
  s_add_u32 m0, s13, 0
  s_nop 0
  buffer_load_dwordx4 v1, s[4:7], s14 offen lds
  buffer_load_dwordx4 v1, s[4:7], s14 offen offset:1024 lds
  s_add_u32 m0, s13, 8192
  s_add_u32 s14, s14, 2048
  buffer_load_dwordx4 v1, s[4:7], s15 offen lds
  buffer_load_dwordx4 v1, s[4:7], s15 offen offset:1024 lds
  s_add_u32 s15, s15, 2048
  s_add_u32 m0, s13, 16384
  s_nop 0
  buffer_load_dwordx4 v1, s[4:7], s14 offen lds
  buffer_load_dwordx4 v1, s[4:7], s14 offen offset:1024 lds
  s_add_u32 m0, s13, 24576
  s_add_u32 s14, s14, 2048
  buffer_load_dwordx4 v1, s[4:7], s15 offen lds
  buffer_load_dwordx4 v1, s[4:7], s15 offen offset:1024 lds
  s_add_u32 s15, s15, 2048
  s_add_u32 m0, s13, 32768
  s_nop 0
  buffer_load_dwordx4 v1, s[4:7], s14 offen lds
  buffer_load_dwordx4 v1, s[4:7], s14 offen offset:1024 lds
  s_add_u32 m0, s13, 40960
  s_add_u32 s14, s14, 2048
  buffer_load_dwordx4 v1, s[4:7], s15 offen lds
  buffer_load_dwordx4 v1, s[4:7], s15 offen offset:1024 lds
  s_add_u32 s15, s15, 2048
  s_add_u32 m0, s13, 49152
  s_nop 0
  buffer_load_dwordx4 v1, s[4:7], s14 offen lds
  buffer_load_dwordx4 v1, s[4:7], s14 offen offset:1024 lds
  s_add_u32 m0, s13, 57344
  s_add_u32 s14, s14, 2048
  buffer_load_dwordx4 v1, s[4:7], s15 offen lds
  buffer_load_dwordx4 v1, s[4:7], s15 offen offset:1024 lds
  s_add_u32 s15, s15, 2048
  s_add_u32 m0, s13, 65536
  s_nop 0
  buffer_load_dwordx4 v1, s[4:7], s14 offen lds
  buffer_load_dwordx4 v1, s[4:7], s14 offen offset:1024 lds
  s_add_u32 m0, s13, 73728
  s_add_u32 s14, s14, 2048
  buffer_load_dwordx4 v1, s[4:7], s15 offen lds
  buffer_load_dwordx4 v1, s[4:7], s15 offen offset:1024 lds
  s_add_u32 s15, s15, 2048
  s_setprio 3
  s_waitcnt vmcnt(16)
  s_barrier
  s_waitcnt vmcnt(12)
  s_barrier
  s_add_u32 m0, s13, 0
  s_nop 0
  buffer_load_dwordx4 v1, s[4:7], s14 offen lds
  buffer_load_dwordx4 v1, s[4:7], s14 offen offset:1024 lds
  s_add_u32 m0, s13, 8192
  s_add_u32 s14, s14, 2048
  buffer_load_dwordx4 v1, s[4:7], s15 offen lds
  buffer_load_dwordx4 v1, s[4:7], s15 offen offset:1024 lds
  s_add_u32 s15, s15, 2048
  s_waitcnt vmcnt(12)
  s_barrier
  s_add_u32 m0, s13, 16384
  s_nop 0
  buffer_load_dwordx4 v1, s[4:7], s14 offen lds
  buffer_load_dwordx4 v1, s[4:7], s14 offen offset:1024 lds
  s_add_u32 m0, s13, 24576
  s_add_u32 s14, s14, 2048
  buffer_load_dwordx4 v1, s[4:7], s15 offen lds
  buffer_load_dwordx4 v1, s[4:7], s15 offen offset:1024 lds
  s_add_u32 s15, s15, 2048
  s_waitcnt vmcnt(12)
  s_barrier
  s_add_u32 m0, s13, 32768
  s_nop 0
  buffer_load_dwordx4 v1, s[4:7], s14 offen lds
  buffer_load_dwordx4 v1, s[4:7], s14 offen offset:1024 lds
  s_add_u32 m0, s13, 40960
  s_add_u32 s14, s14, 2048
  buffer_load_dwordx4 v1, s[4:7], s15 offen lds
  buffer_load_dwordx4 v1, s[4:7], s15 offen offset:1024 lds
  s_add_u32 s15, s15, 2048
  s_waitcnt vmcnt(12)
  s_barrier
  s_add_u32 m0, s13, 49152
  s_nop 0
  buffer_load_dwordx4 v1, s[4:7], s14 offen lds
  buffer_load_dwordx4 v1, s[4:7], s14 offen offset:1024 lds
  s_add_u32 m0, s13, 57344
  s_add_u32 s14, s14, 2048
  buffer_load_dwordx4 v1, s[4:7], s15 offen lds
  buffer_load_dwordx4 v1, s[4:7], s15 offen offset:1024 lds
  s_add_u32 s15, s15, 2048
  s_waitcnt vmcnt(12)
  s_barrier
  s_add_u32 m0, s13, 65536
  s_nop 0
  buffer_load_dwordx4 v1, s[4:7], s14 offen lds
  buffer_load_dwordx4 v1, s[4:7], s14 offen offset:1024 lds
  s_add_u32 m0, s13, 73728
  s_add_u32 s14, s14, 2048
  buffer_load_dwordx4 v1, s[4:7], s15 offen lds
  buffer_load_dwordx4 v1, s[4:7], s15 offen offset:1024 lds
  s_add_u32 s15, s15, 2048
  s_waitcnt vmcnt(12)
  s_barrier
  s_add_u32 m0, s13, 0
  s_nop 0
  buffer_load_dwordx4 v1, s[4:7], s14 offen lds
  buffer_load_dwordx4 v1, s[4:7], s14 offen offset:1024 lds
  s_add_u32 m0, s13, 8192
  s_add_u32 s14, s14, 2048
  buffer_load_dwordx4 v1, s[4:7], s15 offen lds
  buffer_load_dwordx4 v1, s[4:7], s15 offen offset:1024 lds
  s_add_u32 s15, s15, 2048
  s_waitcnt vmcnt(12)
  s_barrier
  s_add_u32 m0, s13, 16384
  s_nop 0
  buffer_load_dwordx4 v1, s[4:7], s14 offen lds
  buffer_load_dwordx4 v1, s[4:7], s14 offen offset:1024 lds
  s_add_u32 m0, s13, 24576
  s_add_u32 s14, s14, 2048
  buffer_load_dwordx4 v1, s[4:7], s15 offen lds
  buffer_load_dwordx4 v1, s[4:7], s15 offen offset:1024 lds
  s_add_u32 s15, s15, 2048
  s_waitcnt vmcnt(12)
  s_barrier
  s_add_u32 m0, s13, 32768
  s_nop 0
  buffer_load_dwordx4 v1, s[4:7], s14 offen lds
  buffer_load_dwordx4 v1, s[4:7], s14 offen offset:1024 lds
  s_add_u32 m0, s13, 40960
  s_add_u32 s14, s14, 2048
  buffer_load_dwordx4 v1, s[4:7], s15 offen lds
  buffer_load_dwordx4 v1, s[4:7], s15 offen offset:1024 lds
  s_add_u32 s15, s15, 2048
  s_waitcnt vmcnt(12)
  s_barrier
  s_add_u32 m0, s13, 49152
  s_nop 0
  buffer_load_dwordx4 v1, s[4:7], s14 offen lds
  buffer_load_dwordx4 v1, s[4:7], s14 offen offset:1024 lds
  s_add_u32 m0, s13, 57344
  s_add_u32 s14, s14, 2048
  buffer_load_dwordx4 v1, s[4:7], s15 offen lds
  buffer_load_dwordx4 v1, s[4:7], s15 offen offset:1024 lds
  s_add_u32 s15, s15, 2048
  s_waitcnt vmcnt(12)
  s_barrier
  s_add_u32 m0, s13, 65536
  s_nop 0
  buffer_load_dwordx4 v1, s[4:7], s14 offen lds
  buffer_load_dwordx4 v1, s[4:7], s14 offen offset:1024 lds
  s_add_u32 m0, s13, 73728
  s_add_u32 s14, s14, 2048
  buffer_load_dwordx4 v1, s[4:7], s15 offen lds
  buffer_load_dwordx4 v1, s[4:7], s15 offen offset:1024 lds
  s_add_u32 s15, s15, 2048
  s_waitcnt vmcnt(12)
  s_barrier
  s_add_u32 m0, s13, 0
  s_nop 0
  buffer_load_dwordx4 v1, s[4:7], s14 offen lds
  buffer_load_dwordx4 v1, s[4:7], s14 offen offset:1024 lds
  s_add_u32 m0, s13, 8192
  s_add_u32 s14, s14, 2048
  buffer_load_dwordx4 v1, s[4:7], s15 offen lds
  buffer_load_dwordx4 v1, s[4:7], s15 offen offset:1024 lds
  s_add_u32 s15, s15, 2048
  s_waitcnt vmcnt(12)
  s_barrier
  s_add_u32 m0, s13, 16384
  s_nop 0
  buffer_load_dwordx4 v1, s[4:7], s14 offen lds
  buffer_load_dwordx4 v1, s[4:7], s14 offen offset:1024 lds
  s_add_u32 m0, s13, 24576
  s_add_u32 s14, s14, 2048
  buffer_load_dwordx4 v1, s[4:7], s15 offen lds
  buffer_load_dwordx4 v1, s[4:7], s15 offen offset:1024 lds
  s_add_u32 s15, s15, 2048
  s_waitcnt vmcnt(12)
  s_barrier
  s_add_u32 m0, s13, 32768
  s_nop 0
  buffer_load_dwordx4 v1, s[4:7], s14 offen lds
  buffer_load_dwordx4 v1, s[4:7], s14 offen offset:1024 lds
  s_add_u32 m0, s13, 40960
  s_add_u32 s14, s14, 2048
  buffer_load_dwordx4 v1, s[4:7], s15 offen lds
  buffer_load_dwordx4 v1, s[4:7], s15 offen offset:1024 lds
  s_add_u32 s15, s15, 2048
  s_waitcnt vmcnt(12)
  s_barrier
  s_waitcnt vmcnt(8)
  s_barrier
  s_waitcnt vmcnt(4)
  s_barrier
  s_waitcnt vmcnt(0)
  s_barrier
  s_lshl_b32 s18, s9, 1
  s_and_b32 s19, s23, 1
  s_add_u32 s18, s18, s19
  s_mul_i32 s16, s18, 73728
  s_lshr_b32 s19, s23, 1
  s_mul_i32 s19, s19, 36864
  s_add_u32 s16, s16, s19
  s_add_u32 s16, s16, 20512768
  s_mul_i32 s30, s18, 36864
  s_lshr_b32 s19, s23, 1
  s_mul_i32 s19, s19, 18432
  s_add_u32 s30, s30, s19
  s_add_u32 s30, s30, 23068672
  s_lshl_b32 s13, s23, 12
  s_barrier
  s_add_u32 m0, s13, 32768
  s_nop 0
  buffer_load_dwordx4 v1, s[4:7], s16 offen lds
  buffer_load_dwordx4 v1, s[4:7], s16 offen offset:1024 lds
  buffer_load_dwordx4 v1, s[4:7], s16 offen offset:2048 lds
  buffer_load_dwordx4 v1, s[4:7], s16 offen offset:3072 lds
  s_add_u32 s16, s16, 4096
  s_add_u32 m0, s13, 49152
  s_nop 0
  buffer_load_dwordx4 v1, s[4:7], s16 offen lds
  buffer_load_dwordx4 v1, s[4:7], s16 offen offset:1024 lds
  buffer_load_dwordx4 v1, s[4:7], s16 offen offset:2048 lds
  buffer_load_dwordx4 v1, s[4:7], s16 offen offset:3072 lds
  s_add_u32 s16, s16, 4096
  s_barrier
  s_add_u32 m0, s13, 65536
  s_nop 0
  buffer_load_dwordx4 v1, s[4:7], s16 offen lds
  buffer_load_dwordx4 v1, s[4:7], s16 offen offset:1024 lds
  buffer_load_dwordx4 v1, s[4:7], s16 offen offset:2048 lds
  buffer_load_dwordx4 v1, s[4:7], s16 offen offset:3072 lds
  s_add_u32 s16, s16, 4096
  s_add_u32 m0, s13, 0
  s_nop 0
  buffer_load_dwordx4 v1, s[4:7], s16 offen lds
  buffer_load_dwordx4 v1, s[4:7], s16 offen offset:1024 lds
  buffer_load_dwordx4 v1, s[4:7], s16 offen offset:2048 lds
  buffer_load_dwordx4 v1, s[4:7], s16 offen offset:3072 lds
  s_add_u32 s16, s16, 4096
  s_add_u32 m0, s13, 16384
  s_nop 0
  buffer_load_dwordx4 v1, s[4:7], s16 offen lds
  buffer_load_dwordx4 v1, s[4:7], s16 offen offset:1024 lds
  buffer_load_dwordx4 v1, s[4:7], s16 offen offset:2048 lds
  buffer_load_dwordx4 v1, s[4:7], s16 offen offset:3072 lds
  s_add_u32 s16, s16, 4096
  s_cmp_eq_u32 s10, 4
  s_cbranch_scc0 svc_hdone_18
  s_lshl_b32 s18, s8, 6
  s_add_u32 s18, s18, 22282240
  v_lshlrev_b32 v2, 2, v0
  s_mov_b32 exec_hi, 0
  s_mov_b32 exec_lo, 0x1ff
svc_hpoll_17:
  buffer_load_dword v3, v2, s[4:7], s18 offen sc1
  s_waitcnt vmcnt(0)
  v_cmp_ne_u32 vcc, 1, v3
  s_nop 4
  s_cbranch_vccz svc_hdone_18
  s_sleep 2
  s_branch svc_hpoll_17
svc_hdone_18:
  s_mov_b64 exec, -1
  s_waitcnt vmcnt(0)
  s_mul_i32 s17, s24, 73728
  s_mul_i32 s18, s22, 36864
  s_add_u32 s17, s17, s18
  s_add_u32 s17, s17, 11534336
  s_lshl_b32 s18, s22, 13
  v_add_u32 v114, s18, v1
  v_add_u32 v115, 0x10000, v114
  s_barrier
  buffer_load_dwordx4 v[34:37], v1, s[4:7], s17 offen offset:0 sc1
  buffer_load_dwordx4 v[38:41], v1, s[4:7], s17 offen offset:1024 sc1
  buffer_load_dwordx4 v[42:45], v1, s[4:7], s17 offen offset:2048 sc1
  buffer_load_dwordx4 v[46:49], v1, s[4:7], s17 offen offset:3072 sc1
  s_add_u32 s17, s17, 4096
  buffer_load_dwordx4 v[50:53], v1, s[4:7], s17 offen offset:0 sc1
  buffer_load_dwordx4 v[54:57], v1, s[4:7], s17 offen offset:1024 sc1
  buffer_load_dwordx4 v[58:61], v1, s[4:7], s17 offen offset:2048 sc1
  buffer_load_dwordx4 v[62:65], v1, s[4:7], s17 offen offset:3072 sc1
  s_add_u32 s17, s17, 4096
  buffer_load_dwordx4 v[66:69], v1, s[4:7], s17 offen offset:0 sc1
  buffer_load_dwordx4 v[70:73], v1, s[4:7], s17 offen offset:1024 sc1
  buffer_load_dwordx4 v[74:77], v1, s[4:7], s17 offen offset:2048 sc1
  buffer_load_dwordx4 v[78:81], v1, s[4:7], s17 offen offset:3072 sc1
  s_setprio 0
  s_load_dwordx2 s[44:45], s[0:1], 64
  s_mov_b32 s46, 1152
  s_mov_b32 s47, 0x00020000
  s_barrier
  ds_read_b128 v[98:101], v114 offset:32768
  ds_read_b128 v[102:105], v114 offset:36864
  ds_read_b128 v[106:109], v114 offset:33792
  ds_read_b128 v[110:113], v114 offset:37888
  s_waitcnt vmcnt(11) lgkmcnt(0)
  v_mfma_f32_32x32x16_bf16 v[2:17], v[98:101], v[34:37], 0
  v_mfma_f32_32x32x16_bf16 v[18:33], v[102:105], v[34:37], 0
  s_add_u32 s17, s17, 4096
  buffer_load_dwordx4 v[34:37], v1, s[4:7], s17 offen offset:0 sc1
  ds_read_b128 v[98:101], v114 offset:34816
  ds_read_b128 v[102:105], v114 offset:38912
  s_waitcnt vmcnt(11)
  v_mfma_f32_32x32x16_bf16 v[2:17], v[106:109], v[38:41], v[2:17]
  v_mfma_f32_32x32x16_bf16 v[18:33], v[110:113], v[38:41], v[18:33]
  buffer_load_dwordx4 v[38:41], v1, s[4:7], s17 offen offset:1024 sc1
  ds_read_b128 v[106:109], v114 offset:35840
  ds_read_b128 v[110:113], v114 offset:39936
  s_waitcnt vmcnt(11) lgkmcnt(3)
  v_mfma_f32_32x32x16_bf16 v[2:17], v[98:101], v[42:45], v[2:17]
  s_waitcnt lgkmcnt(2)
  v_mfma_f32_32x32x16_bf16 v[18:33], v[102:105], v[42:45], v[18:33]
  buffer_load_dwordx4 v[42:45], v1, s[4:7], s17 offen offset:2048 sc1
  s_waitcnt vmcnt(11) lgkmcnt(1)
  v_mfma_f32_32x32x16_bf16 v[2:17], v[106:109], v[46:49], v[2:17]
  s_waitcnt lgkmcnt(0)
  v_mfma_f32_32x32x16_bf16 v[18:33], v[110:113], v[46:49], v[18:33]
  buffer_load_dwordx4 v[46:49], v1, s[4:7], s17 offen offset:3072 sc1
  s_waitcnt lgkmcnt(0)
  s_barrier
  s_add_u32 m0, s13, 32768
  s_nop 0
  buffer_load_dwordx4 v1, s[4:7], s16 offen lds
  buffer_load_dwordx4 v1, s[4:7], s16 offen offset:1024 lds
  buffer_load_dwordx4 v1, s[4:7], s16 offen offset:2048 lds
  buffer_load_dwordx4 v1, s[4:7], s16 offen offset:3072 lds
  s_add_u32 s16, s16, 4096
  ds_read_b128 v[98:101], v114 offset:49152
  ds_read_b128 v[102:105], v114 offset:53248
  ds_read_b128 v[106:109], v114 offset:50176
  ds_read_b128 v[110:113], v114 offset:54272
  s_waitcnt vmcnt(15) lgkmcnt(3)
  v_mfma_f32_32x32x16_bf16 v[2:17], v[98:101], v[50:53], v[2:17]
  s_waitcnt lgkmcnt(2)
  v_mfma_f32_32x32x16_bf16 v[18:33], v[102:105], v[50:53], v[18:33]
  s_add_u32 s17, s17, 4096
  buffer_load_dwordx4 v[50:53], v1, s[4:7], s17 offen offset:0 sc1
  ds_read_b128 v[98:101], v114 offset:51200
  ds_read_b128 v[102:105], v114 offset:55296
  s_waitcnt vmcnt(15) lgkmcnt(3)
  v_mfma_f32_32x32x16_bf16 v[2:17], v[106:109], v[54:57], v[2:17]
  s_waitcnt lgkmcnt(2)
  v_mfma_f32_32x32x16_bf16 v[18:33], v[110:113], v[54:57], v[18:33]
  buffer_load_dwordx4 v[54:57], v1, s[4:7], s17 offen offset:1024 sc1
  ds_read_b128 v[106:109], v114 offset:52224
  ds_read_b128 v[110:113], v114 offset:56320
  s_waitcnt vmcnt(15) lgkmcnt(3)
  v_mfma_f32_32x32x16_bf16 v[2:17], v[98:101], v[58:61], v[2:17]
  s_waitcnt lgkmcnt(2)
  v_mfma_f32_32x32x16_bf16 v[18:33], v[102:105], v[58:61], v[18:33]
  buffer_load_dwordx4 v[58:61], v1, s[4:7], s17 offen offset:2048 sc1
  s_waitcnt vmcnt(15) lgkmcnt(1)
  v_mfma_f32_32x32x16_bf16 v[2:17], v[106:109], v[62:65], v[2:17]
  s_waitcnt lgkmcnt(0)
  v_mfma_f32_32x32x16_bf16 v[18:33], v[110:113], v[62:65], v[18:33]
  buffer_load_dwordx4 v[62:65], v1, s[4:7], s17 offen offset:3072 sc1
  s_waitcnt lgkmcnt(0)
  s_barrier
  s_add_u32 m0, s13, 49152
  s_nop 0
  buffer_load_dwordx4 v1, s[4:7], s16 offen lds
  buffer_load_dwordx4 v1, s[4:7], s16 offen offset:1024 lds
  buffer_load_dwordx4 v1, s[4:7], s16 offen offset:2048 lds
  buffer_load_dwordx4 v1, s[4:7], s16 offen offset:3072 lds
  s_add_u32 s16, s16, 4096
  s_setprio 3
  v_lshrrev_b32 v120, 3, v0
  v_xor_b32 v119, v120, v0
  v_and_b32 v119, 7, v119
  v_mul_u32_u24 v117, 1152, v120
  v_lshlrev_b32 v118, 3, v119
  v_add_u32 v117, v117, v118
  s_mul_i32 s18, s24, 36864
  s_lshl_b32 s19, s9, 7
  s_lshl_b32 s20, s22, 6
  s_add_u32 s19, s19, s20
  s_add_u32 s18, s18, s19
  buffer_load_dwordx2 v[82:83], v117, s[36:39], s18 offen
  s_add_u32 s18, s18, 9216
  buffer_load_dwordx2 v[84:85], v117, s[36:39], s18 offen
  s_add_u32 s18, s18, 9216
  buffer_load_dwordx2 v[86:87], v117, s[36:39], s18 offen
  s_add_u32 s18, s18, 9216
  buffer_load_dwordx2 v[88:89], v117, s[36:39], s18 offen
  buffer_load_dwordx2 v[90:91], v118, s[44:47], s19 offen
  v_lshlrev_b32 v118, 2, v120
  s_lshl_b32 s18, s24, 7
  s_add_u32 s18, s18, 22020096
  buffer_load_dword v92, v118, s[4:7], s18 offen offset:0
  buffer_load_dword v93, v118, s[4:7], s18 offen offset:32
  buffer_load_dword v94, v118, s[4:7], s18 offen offset:64
  buffer_load_dword v95, v118, s[4:7], s18 offen offset:96
  v_and_b32 v117, 31, v0
  v_lshlrev_b32 v117, 2, v117
  buffer_load_dword v116, v117, s[4:7], s18 offen
  v_mul_u32_u24 v120, 2304, v120
  v_lshlrev_b32 v119, 4, v119
  v_add_u32 v119, v119, v120
  s_setprio 0
  ds_read_b128 v[98:101], v115 offset:0
  ds_read_b128 v[102:105], v115 offset:4096
  ds_read_b128 v[106:109], v115 offset:1024
  ds_read_b128 v[110:113], v115 offset:5120
  s_waitcnt vmcnt(29) lgkmcnt(3)
  v_mfma_f32_32x32x16_bf16 v[2:17], v[98:101], v[66:69], v[2:17]
  s_waitcnt lgkmcnt(2)
  v_mfma_f32_32x32x16_bf16 v[18:33], v[102:105], v[66:69], v[18:33]
  s_add_u32 s17, s17, 4096
  buffer_load_dwordx4 v[66:69], v1, s[4:7], s17 offen offset:0 sc1
  ds_read_b128 v[98:101], v115 offset:2048
  ds_read_b128 v[102:105], v115 offset:6144
  s_waitcnt vmcnt(29) lgkmcnt(3)
  v_mfma_f32_32x32x16_bf16 v[2:17], v[106:109], v[70:73], v[2:17]
  s_waitcnt lgkmcnt(2)
  v_mfma_f32_32x32x16_bf16 v[18:33], v[110:113], v[70:73], v[18:33]
  buffer_load_dwordx4 v[70:73], v1, s[4:7], s17 offen offset:1024 sc1
  ds_read_b128 v[106:109], v115 offset:3072
  ds_read_b128 v[110:113], v115 offset:7168
  s_waitcnt vmcnt(29) lgkmcnt(3)
  v_mfma_f32_32x32x16_bf16 v[2:17], v[98:101], v[74:77], v[2:17]
  s_waitcnt lgkmcnt(2)
  v_mfma_f32_32x32x16_bf16 v[18:33], v[102:105], v[74:77], v[18:33]
  buffer_load_dwordx4 v[74:77], v1, s[4:7], s17 offen offset:2048 sc1
  s_waitcnt vmcnt(29) lgkmcnt(1)
  v_mfma_f32_32x32x16_bf16 v[2:17], v[106:109], v[78:81], v[2:17]
  s_waitcnt lgkmcnt(0)
  v_mfma_f32_32x32x16_bf16 v[18:33], v[110:113], v[78:81], v[18:33]
  buffer_load_dwordx4 v[78:81], v1, s[4:7], s17 offen offset:3072 sc1
  s_waitcnt lgkmcnt(0)
  s_barrier
  s_add_u32 m0, s13, 65536
  s_nop 0
  buffer_load_dwordx4 v1, s[4:7], s16 offen lds
  buffer_load_dwordx4 v1, s[4:7], s16 offen offset:1024 lds
  buffer_load_dwordx4 v1, s[4:7], s16 offen offset:2048 lds
  buffer_load_dwordx4 v1, s[4:7], s16 offen offset:3072 lds
  s_add_u32 s16, s16, 4096
  ds_read_b128 v[98:101], v114 offset:0
  ds_read_b128 v[102:105], v114 offset:4096
  ds_read_b128 v[106:109], v114 offset:1024
  ds_read_b128 v[110:113], v114 offset:5120
  s_waitcnt vmcnt(33) lgkmcnt(3)
  v_mfma_f32_32x32x16_bf16 v[2:17], v[98:101], v[34:37], v[2:17]
  s_waitcnt lgkmcnt(2)
  v_mfma_f32_32x32x16_bf16 v[18:33], v[102:105], v[34:37], v[18:33]
  s_add_u32 s17, s17, 4096
  buffer_load_dwordx4 v[34:37], v1, s[4:7], s17 offen offset:0 sc1
  ds_read_b128 v[98:101], v114 offset:2048
  ds_read_b128 v[102:105], v114 offset:6144
  s_waitcnt vmcnt(33) lgkmcnt(3)
  v_mfma_f32_32x32x16_bf16 v[2:17], v[106:109], v[38:41], v[2:17]
  s_waitcnt lgkmcnt(2)
  v_mfma_f32_32x32x16_bf16 v[18:33], v[110:113], v[38:41], v[18:33]
  buffer_load_dwordx4 v[38:41], v1, s[4:7], s17 offen offset:1024 sc1
  ds_read_b128 v[106:109], v114 offset:3072
  ds_read_b128 v[110:113], v114 offset:7168
  s_waitcnt vmcnt(33) lgkmcnt(3)
  v_mfma_f32_32x32x16_bf16 v[2:17], v[98:101], v[42:45], v[2:17]
  s_waitcnt lgkmcnt(2)
  v_mfma_f32_32x32x16_bf16 v[18:33], v[102:105], v[42:45], v[18:33]
  buffer_load_dwordx4 v[42:45], v1, s[4:7], s17 offen offset:2048 sc1
  s_waitcnt vmcnt(33) lgkmcnt(1)
  v_mfma_f32_32x32x16_bf16 v[2:17], v[106:109], v[46:49], v[2:17]
  s_waitcnt lgkmcnt(0)
  v_mfma_f32_32x32x16_bf16 v[18:33], v[110:113], v[46:49], v[18:33]
  buffer_load_dwordx4 v[46:49], v1, s[4:7], s17 offen offset:3072 sc1
  s_waitcnt lgkmcnt(0)
  s_barrier
  s_add_u32 m0, s13, 0
  s_nop 0
  buffer_load_dwordx4 v1, s[4:7], s16 offen lds
  buffer_load_dwordx4 v1, s[4:7], s16 offen offset:1024 lds
  buffer_load_dwordx4 v1, s[4:7], s16 offen offset:2048 lds
  buffer_load_dwordx4 v1, s[4:7], s16 offen offset:3072 lds
  s_add_u32 s16, s16, 4096
  ds_read_b128 v[98:101], v114 offset:16384
  ds_read_b128 v[102:105], v114 offset:20480
  ds_read_b128 v[106:109], v114 offset:17408
  ds_read_b128 v[110:113], v114 offset:21504
  s_waitcnt vmcnt(33) lgkmcnt(3)
  v_mfma_f32_32x32x16_bf16 v[2:17], v[98:101], v[50:53], v[2:17]
  s_waitcnt lgkmcnt(2)
  v_mfma_f32_32x32x16_bf16 v[18:33], v[102:105], v[50:53], v[18:33]
  s_add_u32 s17, s17, 4096
  buffer_load_dwordx4 v[50:53], v1, s[4:7], s17 offen offset:0 sc1
  ds_read_b128 v[98:101], v114 offset:18432
  ds_read_b128 v[102:105], v114 offset:22528
  s_waitcnt vmcnt(33) lgkmcnt(3)
  v_mfma_f32_32x32x16_bf16 v[2:17], v[106:109], v[54:57], v[2:17]
  s_waitcnt lgkmcnt(2)
  v_mfma_f32_32x32x16_bf16 v[18:33], v[110:113], v[54:57], v[18:33]
  buffer_load_dwordx4 v[54:57], v1, s[4:7], s17 offen offset:1024 sc1
  ds_read_b128 v[106:109], v114 offset:19456
  ds_read_b128 v[110:113], v114 offset:23552
  s_waitcnt vmcnt(33) lgkmcnt(3)
  v_mfma_f32_32x32x16_bf16 v[2:17], v[98:101], v[58:61], v[2:17]
  s_waitcnt lgkmcnt(2)
  v_mfma_f32_32x32x16_bf16 v[18:33], v[102:105], v[58:61], v[18:33]
  buffer_load_dwordx4 v[58:61], v1, s[4:7], s17 offen offset:2048 sc1
  s_waitcnt vmcnt(33) lgkmcnt(1)
  v_mfma_f32_32x32x16_bf16 v[2:17], v[106:109], v[62:65], v[2:17]
  s_waitcnt lgkmcnt(0)
  v_mfma_f32_32x32x16_bf16 v[18:33], v[110:113], v[62:65], v[18:33]
  buffer_load_dwordx4 v[62:65], v1, s[4:7], s17 offen offset:3072 sc1
  s_waitcnt lgkmcnt(0)
  s_waitcnt vmcnt(38)
  s_barrier
  s_add_u32 m0, s13, 16384
  s_nop 0
  buffer_load_dwordx4 v1, s[4:7], s30 offen offset:0 lds
  buffer_load_dwordx4 v1, s[4:7], s30 offen offset:1024 lds
  buffer_load_dwordx4 v1, s[4:7], s30 offen offset:2048 lds
  buffer_load_dwordx4 v1, s[4:7], s30 offen offset:3072 lds
  s_add_u32 s30, s30, 4096
  ds_read_b128 v[98:101], v114 offset:32768
  ds_read_b128 v[102:105], v114 offset:36864
  ds_read_b128 v[106:109], v114 offset:33792
  ds_read_b128 v[110:113], v114 offset:37888
  s_waitcnt vmcnt(23) lgkmcnt(3)
  v_mfma_f32_32x32x16_bf16 v[2:17], v[98:101], v[66:69], v[2:17]
  s_waitcnt lgkmcnt(2)
  v_mfma_f32_32x32x16_bf16 v[18:33], v[102:105], v[66:69], v[18:33]
  s_add_u32 s17, s17, 4096
  buffer_load_dwordx4 v[66:69], v1, s[4:7], s17 offen offset:0 sc1
  ds_read_b128 v[98:101], v114 offset:34816
  ds_read_b128 v[102:105], v114 offset:38912
  s_waitcnt vmcnt(23) lgkmcnt(3)
  v_mfma_f32_32x32x16_bf16 v[2:17], v[106:109], v[70:73], v[2:17]
  s_waitcnt lgkmcnt(2)
  v_mfma_f32_32x32x16_bf16 v[18:33], v[110:113], v[70:73], v[18:33]
  buffer_load_dwordx4 v[70:73], v1, s[4:7], s17 offen offset:1024 sc1
  ds_read_b128 v[106:109], v114 offset:35840
  ds_read_b128 v[110:113], v114 offset:39936
  s_waitcnt vmcnt(23) lgkmcnt(3)
  v_mfma_f32_32x32x16_bf16 v[2:17], v[98:101], v[74:77], v[2:17]
  s_waitcnt lgkmcnt(2)
  v_mfma_f32_32x32x16_bf16 v[18:33], v[102:105], v[74:77], v[18:33]
  buffer_load_dwordx4 v[74:77], v1, s[4:7], s17 offen offset:2048 sc1
  s_waitcnt vmcnt(23) lgkmcnt(1)
  v_mfma_f32_32x32x16_bf16 v[2:17], v[106:109], v[78:81], v[2:17]
  s_waitcnt lgkmcnt(0)
  v_mfma_f32_32x32x16_bf16 v[18:33], v[110:113], v[78:81], v[18:33]
  buffer_load_dwordx4 v[78:81], v1, s[4:7], s17 offen offset:3072 sc1
  s_waitcnt lgkmcnt(0)
  s_waitcnt vmcnt(38)
  s_barrier
  s_add_u32 m0, s13, 32768
  s_nop 0
  buffer_load_dwordx4 v1, s[4:7], s30 offen offset:0 lds
  buffer_load_dwordx4 v1, s[4:7], s30 offen offset:1024 lds
  buffer_load_dwordx4 v1, s[4:7], s30 offen offset:2048 lds
  buffer_load_dwordx4 v1, s[4:7], s30 offen offset:3072 lds
  s_add_u32 s30, s30, 4096
  ds_read_b128 v[98:101], v114 offset:49152
  ds_read_b128 v[102:105], v114 offset:53248
  ds_read_b128 v[106:109], v114 offset:50176
  ds_read_b128 v[110:113], v114 offset:54272
  s_waitcnt vmcnt(23) lgkmcnt(3)
  v_mfma_f32_32x32x16_bf16 v[2:17], v[98:101], v[34:37], v[2:17]
  s_waitcnt lgkmcnt(2)
  v_mfma_f32_32x32x16_bf16 v[18:33], v[102:105], v[34:37], v[18:33]
  ds_read_b128 v[98:101], v114 offset:51200
  ds_read_b128 v[102:105], v114 offset:55296
  s_waitcnt vmcnt(22) lgkmcnt(3)
  v_mfma_f32_32x32x16_bf16 v[2:17], v[106:109], v[38:41], v[2:17]
  s_waitcnt lgkmcnt(2)
  v_mfma_f32_32x32x16_bf16 v[18:33], v[110:113], v[38:41], v[18:33]
  ds_read_b128 v[106:109], v114 offset:52224
  ds_read_b128 v[110:113], v114 offset:56320
  s_waitcnt vmcnt(21) lgkmcnt(3)
  v_mfma_f32_32x32x16_bf16 v[2:17], v[98:101], v[42:45], v[2:17]
  s_waitcnt lgkmcnt(2)
  v_mfma_f32_32x32x16_bf16 v[18:33], v[102:105], v[42:45], v[18:33]
  s_waitcnt vmcnt(20) lgkmcnt(1)
  v_mfma_f32_32x32x16_bf16 v[2:17], v[106:109], v[46:49], v[2:17]
  s_waitcnt lgkmcnt(0)
  v_mfma_f32_32x32x16_bf16 v[18:33], v[110:113], v[46:49], v[18:33]
  s_waitcnt lgkmcnt(0)
  s_waitcnt vmcnt(24)
  s_barrier
  s_add_u32 m0, s13, 49152
  s_nop 0
  buffer_load_dwordx4 v1, s[4:7], s30 offen offset:0 lds
  buffer_load_dwordx4 v1, s[4:7], s30 offen offset:1024 lds
  buffer_load_dwordx4 v1, s[4:7], s30 offen offset:2048 lds
  buffer_load_dwordx4 v1, s[4:7], s30 offen offset:3072 lds
  s_add_u32 s30, s30, 4096
  ds_read_b128 v[98:101], v115 offset:0
  ds_read_b128 v[102:105], v115 offset:4096
  ds_read_b128 v[106:109], v115 offset:1024
  ds_read_b128 v[110:113], v115 offset:5120
  s_waitcnt vmcnt(19) lgkmcnt(3)
  v_mfma_f32_32x32x16_bf16 v[2:17], v[98:101], v[50:53], v[2:17]
  s_waitcnt lgkmcnt(2)
  v_mfma_f32_32x32x16_bf16 v[18:33], v[102:105], v[50:53], v[18:33]
  ds_read_b128 v[98:101], v115 offset:2048
  ds_read_b128 v[102:105], v115 offset:6144
  s_waitcnt vmcnt(18) lgkmcnt(3)
  v_mfma_f32_32x32x16_bf16 v[2:17], v[106:109], v[54:57], v[2:17]
  s_waitcnt lgkmcnt(2)
  v_mfma_f32_32x32x16_bf16 v[18:33], v[110:113], v[54:57], v[18:33]
  ds_read_b128 v[106:109], v115 offset:3072
  ds_read_b128 v[110:113], v115 offset:7168
  s_waitcnt vmcnt(17) lgkmcnt(3)
  v_mfma_f32_32x32x16_bf16 v[2:17], v[98:101], v[58:61], v[2:17]
  s_waitcnt lgkmcnt(2)
  v_mfma_f32_32x32x16_bf16 v[18:33], v[102:105], v[58:61], v[18:33]
  s_waitcnt vmcnt(16) lgkmcnt(1)
  v_mfma_f32_32x32x16_bf16 v[2:17], v[106:109], v[62:65], v[2:17]
  s_waitcnt lgkmcnt(0)
  v_mfma_f32_32x32x16_bf16 v[18:33], v[110:113], v[62:65], v[18:33]
  s_waitcnt lgkmcnt(0)
  s_waitcnt vmcnt(20)
  s_barrier
  s_add_u32 m0, s13, 65536
  s_nop 0
  buffer_load_dwordx4 v1, s[4:7], s30 offen offset:0 lds
  buffer_load_dwordx4 v1, s[4:7], s30 offen offset:1024 lds
  buffer_load_dwordx4 v1, s[4:7], s30 offen offset:2048 lds
  buffer_load_dwordx4 v1, s[4:7], s30 offen offset:3072 lds
  s_add_u32 s30, s30, 4096
  ds_read_b128 v[98:101], v114 offset:0
  ds_read_b128 v[102:105], v114 offset:4096
  ds_read_b128 v[106:109], v114 offset:1024
  ds_read_b128 v[110:113], v114 offset:5120
  s_waitcnt vmcnt(15) lgkmcnt(3)
  v_mfma_f32_32x32x16_bf16 v[2:17], v[98:101], v[66:69], v[2:17]
  s_waitcnt lgkmcnt(2)
  v_mfma_f32_32x32x16_bf16 v[18:33], v[102:105], v[66:69], v[18:33]
  ds_read_b128 v[98:101], v114 offset:2048
  ds_read_b128 v[102:105], v114 offset:6144
  s_waitcnt vmcnt(14) lgkmcnt(3)
  v_mfma_f32_32x32x16_bf16 v[2:17], v[106:109], v[70:73], v[2:17]
  s_waitcnt lgkmcnt(2)
  v_mfma_f32_32x32x16_bf16 v[18:33], v[110:113], v[70:73], v[18:33]
  ds_read_b128 v[106:109], v114 offset:3072
  ds_read_b128 v[110:113], v114 offset:7168
  s_waitcnt vmcnt(13) lgkmcnt(3)
  v_mfma_f32_32x32x16_bf16 v[2:17], v[98:101], v[74:77], v[2:17]
  s_waitcnt lgkmcnt(2)
  v_mfma_f32_32x32x16_bf16 v[18:33], v[102:105], v[74:77], v[18:33]
  s_waitcnt vmcnt(12) lgkmcnt(1)
  v_mfma_f32_32x32x16_bf16 v[2:17], v[106:109], v[78:81], v[2:17]
  s_waitcnt lgkmcnt(0)
  v_mfma_f32_32x32x16_bf16 v[18:33], v[110:113], v[78:81], v[18:33]
  s_waitcnt lgkmcnt(0)
  s_setprio 3
  s_barrier
  s_add_u32 m0, s13, 0
  s_nop 0
  buffer_load_dwordx4 v1, s[4:7], s30 offen offset:0 lds
  buffer_load_dwordx4 v1, s[4:7], s30 offen offset:1024 lds
  s_add_u32 s30, s30, 4096
  s_lshl_b32 s18, s24, 7
  s_add_u32 s26, s18, 22284288
  v_and_b32 v121, 31, v0
  v_lshlrev_b32 v121, 2, v121
  buffer_load_dword v122, v121, s[4:7], s26 offen sc1
  v_lshlrev_b32 v98, 16, v90
  v_and_b32 v99, 0xffff0000, v90
  v_lshlrev_b32 v100, 16, v91
  v_and_b32 v101, 0xffff0000, v91
  v_lshlrev_b32 v34, 16, v82
  v_and_b32 v35, 0xffff0000, v82
  v_lshlrev_b32 v36, 16, v83
  v_and_b32 v37, 0xffff0000, v83
  v_mul_f32 v34, v34, v98
  v_mul_f32 v35, v35, v99
  v_mul_f32 v36, v36, v100
  v_mul_f32 v37, v37, v101
  v_mul_f32 v34, v34, v92
  v_mul_f32 v35, v35, v92
  v_mul_f32 v36, v36, v92
  v_mul_f32 v37, v37, v92
  v_lshlrev_b32 v38, 16, v84
  v_and_b32 v39, 0xffff0000, v84
  v_lshlrev_b32 v40, 16, v85
  v_and_b32 v41, 0xffff0000, v85
  v_mul_f32 v38, v38, v98
  v_mul_f32 v39, v39, v99
  v_mul_f32 v40, v40, v100
  v_mul_f32 v41, v41, v101
  v_mul_f32 v38, v38, v93
  v_mul_f32 v39, v39, v93
  v_mul_f32 v40, v40, v93
  v_mul_f32 v41, v41, v93
  v_lshlrev_b32 v42, 16, v86
  v_and_b32 v43, 0xffff0000, v86
  v_lshlrev_b32 v44, 16, v87
  v_and_b32 v45, 0xffff0000, v87
  v_mul_f32 v42, v42, v98
  v_mul_f32 v43, v43, v99
  v_mul_f32 v44, v44, v100
  v_mul_f32 v45, v45, v101
  v_mul_f32 v42, v42, v94
  v_mul_f32 v43, v43, v94
  v_mul_f32 v44, v44, v94
  v_mul_f32 v45, v45, v94
  v_lshlrev_b32 v46, 16, v88
  v_and_b32 v47, 0xffff0000, v88
  v_lshlrev_b32 v48, 16, v89
  v_and_b32 v49, 0xffff0000, v89
  v_mul_f32 v46, v46, v98
  v_mul_f32 v47, v47, v99
  v_mul_f32 v48, v48, v100
  v_mul_f32 v49, v49, v101
  v_mul_f32 v46, v46, v95
  v_mul_f32 v47, v47, v95
  v_mul_f32 v48, v48, v95
  v_mul_f32 v49, v49, v95
  v_mul_f32 v2, v116, v2
  v_mul_f32 v3, v116, v3
  v_mul_f32 v4, v116, v4
  v_mul_f32 v5, v116, v5
  v_mul_f32 v6, v116, v6
  v_mul_f32 v7, v116, v7
  v_mul_f32 v8, v116, v8
  v_mul_f32 v9, v116, v9
  v_mul_f32 v10, v116, v10
  v_mul_f32 v11, v116, v11
  v_mul_f32 v12, v116, v12
  v_mul_f32 v13, v116, v13
  v_mul_f32 v14, v116, v14
  v_mul_f32 v15, v116, v15
  v_mul_f32 v16, v116, v16
  v_mul_f32 v17, v116, v17
  v_mul_f32 v18, v116, v18
  v_mul_f32 v19, v116, v19
  v_mul_f32 v20, v116, v20
  v_mul_f32 v21, v116, v21
  v_mul_f32 v22, v116, v22
  v_mul_f32 v23, v116, v23
  v_mul_f32 v24, v116, v24
  v_mul_f32 v25, v116, v25
  v_mul_f32 v26, v116, v26
  v_mul_f32 v27, v116, v27
  v_mul_f32 v28, v116, v28
  v_mul_f32 v29, v116, v29
  v_mul_f32 v30, v116, v30
  v_mul_f32 v31, v116, v31
  v_mul_f32 v32, v116, v32
  v_mul_f32 v33, v116, v33
  v_and_b32 v120, 31, v0
  v_lshrrev_b32 v117, 5, v0
  v_xor_b32 v117, v117, v120
  v_and_b32 v117, 7, v117
  v_lshlrev_b32 v117, 4, v117
  v_lshlrev_b32 v120, 7, v120
  v_add_u32 v117, v117, v120
  s_lshl_b32 s18, s23, 14
  s_lshl_b32 s19, s22, 12
  s_add_u32 s19, s19, s18
  v_add_u32 v117, s19, v117
  s_lshl_b32 s19, s22, 13
  s_add_u32 s19, s19, s18
  v_add_u32 v118, s19, v1
  s_mul_i32 s18, s22, 18432
  s_mul_i32 s17, s24, 36864
  s_add_u32 s17, s17, s18
  s_add_u32 s17, s17, 8388608
  s_waitcnt vmcnt(0)
  s_barrier
svc_apoll_19:
  s_waitcnt vmcnt(0)
  v_cmp_ne_u32 vcc, 1, v122
  s_nop 4
  s_cbranch_vccz svc_adone_20
  s_sleep 1
  buffer_load_dword v122, v121, s[4:7], s26 offen sc1
  s_branch svc_apoll_19
svc_adone_20:
  buffer_load_dwordx4 v[50:53], v1, s[4:7], s17 offen offset:0
  buffer_load_dwordx4 v[54:57], v1, s[4:7], s17 offen offset:1024
  buffer_load_dwordx4 v[58:61], v1, s[4:7], s17 offen offset:2048
  buffer_load_dwordx4 v[62:65], v1, s[4:7], s17 offen offset:3072
  s_add_u32 s17, s17, 4096
  buffer_load_dwordx4 v[66:69], v1, s[4:7], s17 offen offset:0
  buffer_load_dwordx4 v[70:73], v1, s[4:7], s17 offen offset:1024
  buffer_load_dwordx4 v[74:77], v1, s[4:7], s17 offen offset:2048
  buffer_load_dwordx4 v[78:81], v1, s[4:7], s17 offen offset:3072
  s_add_u32 s17, s17, 4096
  buffer_load_dwordx4 v[82:85], v1, s[4:7], s17 offen offset:0
  buffer_load_dwordx4 v[86:89], v1, s[4:7], s17 offen offset:1024
  buffer_load_dwordx4 v[90:93], v1, s[4:7], s17 offen offset:2048
  buffer_load_dwordx4 v[94:97], v1, s[4:7], s17 offen offset:3072
  ds_read_b128 v[98:101], v114 offset:16384
  ds_read_b128 v[102:105], v114 offset:20480
  ds_read_b128 v[106:109], v114 offset:17408
  ds_read_b128 v[110:113], v114 offset:21504
  s_waitcnt vmcnt(11) lgkmcnt(3)
  v_mfma_f32_32x32x16_bf16 v[2:17], v[98:101], v[50:53], v[2:17]
  s_waitcnt lgkmcnt(2)
  v_mfma_f32_32x32x16_bf16 v[18:33], v[102:105], v[50:53], v[18:33]
  s_add_u32 s17, s17, 4096
  buffer_load_dwordx4 v[50:53], v1, s[4:7], s17 offen offset:0
  ds_read_b128 v[98:101], v114 offset:18432
  ds_read_b128 v[102:105], v114 offset:22528
  s_waitcnt vmcnt(11) lgkmcnt(3)
  v_mfma_f32_32x32x16_bf16 v[2:17], v[106:109], v[54:57], v[2:17]
  s_waitcnt lgkmcnt(2)
  v_mfma_f32_32x32x16_bf16 v[18:33], v[110:113], v[54:57], v[18:33]
  buffer_load_dwordx4 v[54:57], v1, s[4:7], s17 offen offset:1024
  ds_read_b128 v[106:109], v114 offset:19456
  ds_read_b128 v[110:113], v114 offset:23552
  s_waitcnt vmcnt(11) lgkmcnt(3)
  v_mfma_f32_32x32x16_bf16 v[2:17], v[98:101], v[58:61], v[2:17]
  s_waitcnt lgkmcnt(2)
  v_mfma_f32_32x32x16_bf16 v[18:33], v[102:105], v[58:61], v[18:33]
  buffer_load_dwordx4 v[58:61], v1, s[4:7], s17 offen offset:2048 sc1
  ds_read_b128 v[98:101], v114 offset:32768
  ds_read_b128 v[102:105], v114 offset:36864
  s_waitcnt vmcnt(11) lgkmcnt(3)
  v_mfma_f32_32x32x16_bf16 v[2:17], v[106:109], v[62:65], v[2:17]
  s_waitcnt lgkmcnt(2)
  v_mfma_f32_32x32x16_bf16 v[18:33], v[110:113], v[62:65], v[18:33]
  buffer_load_dwordx4 v[62:65], v1, s[4:7], s17 offen offset:3072 sc1
  ds_read_b128 v[106:109], v114 offset:33792
  ds_read_b128 v[110:113], v114 offset:37888
  s_waitcnt vmcnt(11) lgkmcnt(3)
  v_mfma_f32_32x32x16_bf16 v[2:17], v[98:101], v[66:69], v[2:17]
  s_waitcnt lgkmcnt(2)
  v_mfma_f32_32x32x16_bf16 v[18:33], v[102:105], v[66:69], v[18:33]
  s_add_u32 s17, s17, 4096
  buffer_load_dwordx4 v[66:69], v1, s[4:7], s17 offen offset:0 sc1
  ds_read_b128 v[98:101], v114 offset:34816
  ds_read_b128 v[102:105], v114 offset:38912
  s_waitcnt vmcnt(11) lgkmcnt(3)
  v_mfma_f32_32x32x16_bf16 v[2:17], v[106:109], v[70:73], v[2:17]
  s_waitcnt lgkmcnt(2)
  v_mfma_f32_32x32x16_bf16 v[18:33], v[110:113], v[70:73], v[18:33]
  buffer_load_dwordx4 v[70:73], v1, s[4:7], s17 offen offset:1024 sc1
  ds_read_b128 v[106:109], v114 offset:35840
  ds_read_b128 v[110:113], v114 offset:39936
  s_waitcnt vmcnt(11) lgkmcnt(3)
  v_mfma_f32_32x32x16_bf16 v[2:17], v[98:101], v[74:77], v[2:17]
  s_waitcnt lgkmcnt(2)
  v_mfma_f32_32x32x16_bf16 v[18:33], v[102:105], v[74:77], v[18:33]
  ds_read_b128 v[98:101], v114 offset:49152
  ds_read_b128 v[102:105], v114 offset:53248
  s_waitcnt vmcnt(10) lgkmcnt(3)
  v_mfma_f32_32x32x16_bf16 v[2:17], v[106:109], v[78:81], v[2:17]
  s_waitcnt lgkmcnt(2)
  v_mfma_f32_32x32x16_bf16 v[18:33], v[110:113], v[78:81], v[18:33]
  ds_read_b128 v[106:109], v114 offset:50176
  ds_read_b128 v[110:113], v114 offset:54272
  s_waitcnt vmcnt(9) lgkmcnt(3)
  v_mfma_f32_32x32x16_bf16 v[2:17], v[98:101], v[82:85], v[2:17]
  s_waitcnt lgkmcnt(2)
  v_mfma_f32_32x32x16_bf16 v[18:33], v[102:105], v[82:85], v[18:33]
  ds_read_b128 v[98:101], v114 offset:51200
  ds_read_b128 v[102:105], v114 offset:55296
  s_waitcnt vmcnt(8) lgkmcnt(3)
  v_mfma_f32_32x32x16_bf16 v[2:17], v[106:109], v[86:89], v[2:17]
  s_waitcnt lgkmcnt(2)
  v_mfma_f32_32x32x16_bf16 v[18:33], v[110:113], v[86:89], v[18:33]
  ds_read_b128 v[106:109], v114 offset:52224
  ds_read_b128 v[110:113], v114 offset:56320
  s_waitcnt vmcnt(7) lgkmcnt(3)
  v_mfma_f32_32x32x16_bf16 v[2:17], v[98:101], v[90:93], v[2:17]
  s_waitcnt lgkmcnt(2)
  v_mfma_f32_32x32x16_bf16 v[18:33], v[102:105], v[90:93], v[18:33]
  ds_read_b128 v[98:101], v115 offset:0
  ds_read_b128 v[102:105], v115 offset:4096
  s_waitcnt vmcnt(6) lgkmcnt(3)
  v_mfma_f32_32x32x16_bf16 v[2:17], v[106:109], v[94:97], v[2:17]
  s_waitcnt lgkmcnt(2)
  v_mfma_f32_32x32x16_bf16 v[18:33], v[110:113], v[94:97], v[18:33]
  ds_read_b128 v[106:109], v115 offset:1024
  ds_read_b128 v[110:113], v115 offset:5120
  s_waitcnt vmcnt(5) lgkmcnt(3)
  v_mfma_f32_32x32x16_bf16 v[2:17], v[98:101], v[50:53], v[2:17]
  s_waitcnt lgkmcnt(2)
  v_mfma_f32_32x32x16_bf16 v[18:33], v[102:105], v[50:53], v[18:33]
  ds_read_b128 v[98:101], v115 offset:2048
  ds_read_b128 v[102:105], v115 offset:6144
  s_waitcnt vmcnt(4) lgkmcnt(3)
  v_mfma_f32_32x32x16_bf16 v[2:17], v[106:109], v[54:57], v[2:17]
  s_waitcnt lgkmcnt(2)
  v_mfma_f32_32x32x16_bf16 v[18:33], v[110:113], v[54:57], v[18:33]
  ds_read_b128 v[106:109], v115 offset:3072
  ds_read_b128 v[110:113], v115 offset:7168
  s_waitcnt vmcnt(3) lgkmcnt(3)
  v_mfma_f32_32x32x16_bf16 v[2:17], v[98:101], v[58:61], v[2:17]
  s_waitcnt lgkmcnt(2)
  v_mfma_f32_32x32x16_bf16 v[18:33], v[102:105], v[58:61], v[18:33]
  ds_read_b128 v[98:101], v114 offset:0
  ds_read_b128 v[102:105], v114 offset:4096
  s_waitcnt vmcnt(2) lgkmcnt(3)
  v_mfma_f32_32x32x16_bf16 v[2:17], v[106:109], v[62:65], v[2:17]
  s_waitcnt lgkmcnt(2)
  v_mfma_f32_32x32x16_bf16 v[18:33], v[110:113], v[62:65], v[18:33]
  ds_read_b128 v[106:109], v114 offset:1024
  ds_read_b128 v[110:113], v114 offset:5120
  s_waitcnt vmcnt(1) lgkmcnt(3)
  v_mfma_f32_32x32x16_bf16 v[2:17], v[98:101], v[66:69], v[2:17]
  s_waitcnt lgkmcnt(2)
  v_mfma_f32_32x32x16_bf16 v[18:33], v[102:105], v[66:69], v[18:33]
  s_waitcnt vmcnt(0) lgkmcnt(1)
  v_mfma_f32_32x32x16_bf16 v[2:17], v[106:109], v[70:73], v[2:17]
  s_waitcnt lgkmcnt(0)
  v_mfma_f32_32x32x16_bf16 v[18:33], v[110:113], v[70:73], v[18:33]
  s_barrier
  s_nop 8
  ds_write_b128 v117, v[2:5] offset:0
  v_xor_b32 v120, 32, v117
  ds_write_b128 v120, v[6:9] offset:0
  v_xor_b32 v120, 64, v117
  ds_write_b128 v120, v[10:13] offset:0
  v_xor_b32 v120, 96, v117
  ds_write_b128 v120, v[14:17] offset:0
  ds_write_b128 v117, v[18:21] offset:8192
  v_xor_b32 v120, 32, v117
  ds_write_b128 v120, v[22:25] offset:8192
  v_xor_b32 v120, 64, v117
  ds_write_b128 v120, v[26:29] offset:8192
  v_xor_b32 v120, 96, v117
  ds_write_b128 v120, v[30:33] offset:8192
  s_mul_i32 s18, s24, 73728
  s_lshl_b32 s19, s9, 8
  s_add_u32 s18, s18, s19
  s_lshl_b32 s19, s22, 7
  s_add_u32 s18, s18, s19
  s_waitcnt lgkmcnt(0)
  s_barrier
  ds_read_b128 v[50:53], v118 offset:0
  ds_read_b128 v[54:57], v118 offset:4096
  ds_read_b128 v[58:61], v118 offset:1024
  ds_read_b128 v[62:65], v118 offset:5120
  ds_read_b128 v[66:69], v118 offset:2048
  ds_read_b128 v[70:73], v118 offset:6144
  ds_read_b128 v[74:77], v118 offset:3072
  ds_read_b128 v[78:81], v118 offset:7168
  s_waitcnt lgkmcnt(7)
  v_add_f32 v34, v34, v50
  s_waitcnt lgkmcnt(6)
  v_add_f32 v34, v34, v54
  v_add_f32 v35, v35, v51
  v_add_f32 v35, v35, v55
  v_add_f32 v36, v36, v52
  v_add_f32 v36, v36, v56
  v_add_f32 v37, v37, v53
  v_add_f32 v37, v37, v57
  buffer_store_dwordx4 v[34:37], v119, s[40:43], s18 offen sc1
  s_add_u32 s18, s18, 18432
  s_waitcnt lgkmcnt(5)
  v_add_f32 v38, v38, v58
  s_waitcnt lgkmcnt(4)
  v_add_f32 v38, v38, v62
  v_add_f32 v39, v39, v59
  v_add_f32 v39, v39, v63
  v_add_f32 v40, v40, v60
  v_add_f32 v40, v40, v64
  v_add_f32 v41, v41, v61
  v_add_f32 v41, v41, v65
  buffer_store_dwordx4 v[38:41], v119, s[40:43], s18 offen sc1
  s_add_u32 s18, s18, 18432
  s_waitcnt lgkmcnt(3)
  v_add_f32 v42, v42, v66
  s_waitcnt lgkmcnt(2)
  v_add_f32 v42, v42, v70
  v_add_f32 v43, v43, v67
  v_add_f32 v43, v43, v71
  v_add_f32 v44, v44, v68
  v_add_f32 v44, v44, v72
  v_add_f32 v45, v45, v69
  v_add_f32 v45, v45, v73
  buffer_store_dwordx4 v[42:45], v119, s[40:43], s18 offen sc1
  s_add_u32 s18, s18, 18432
  s_waitcnt lgkmcnt(1)
  v_add_f32 v46, v46, v74
  s_waitcnt lgkmcnt(0)
  v_add_f32 v46, v46, v78
  v_add_f32 v47, v47, v75
  v_add_f32 v47, v47, v79
  v_add_f32 v48, v48, v76
  v_add_f32 v48, v48, v80
  v_add_f32 v49, v49, v77
  v_add_f32 v49, v49, v81
  buffer_store_dwordx4 v[46:49], v119, s[40:43], s18 offen sc1
  s_endpgm
l2_exit:
  s_endpgm
.section .rodata,"a"
.p2align 6
.amdhsa_kernel k1_kernel
  .amdhsa_next_free_vgpr 136
  .amdhsa_next_free_sgpr 102
  .amdhsa_accum_offset 136
  .amdhsa_group_segment_fixed_size 0
  .amdhsa_kernarg_size 128
  .amdhsa_user_sgpr_count 2
  .amdhsa_user_sgpr_kernarg_segment_ptr 1
  .amdhsa_system_sgpr_workgroup_id_x 1
.end_amdhsa_kernel
.amdhsa_kernel l2_kernel
  .amdhsa_next_free_vgpr 128
  .amdhsa_next_free_sgpr 102
  .amdhsa_accum_offset 128
  .amdhsa_group_segment_fixed_size 0
  .amdhsa_kernarg_size 128
  .amdhsa_user_sgpr_count 2
  .amdhsa_user_sgpr_kernarg_segment_ptr 1
  .amdhsa_system_sgpr_workgroup_id_x 1
.end_amdhsa_kernel
```
